```python
import torch

def _softmax(x, axis=-1):
    return torch.softmax(x, dim=axis)
def _gelu(x):
    return torch.nn.functional.gelu(x, approximate="tanh")
def _silu(x):
    return torch.nn.functional.silu(x)
def _sigmoid(x):
    return torch.sigmoid(x)
def _layernorm(x, axis=-1, eps=1e-5):
    m = x.mean(dim=axis, keepdim=True)
    v = x.var(dim=axis, keepdim=True, unbiased=False)
    return (x - m) / torch.sqrt(v + eps)
def _scatter_add(tgt, idx, src, axis=0):
    return tgt.clone().index_add_(axis, idx, src)
def _segment_sum(src, seg, n):
    out = torch.zeros((n,) + src.shape[1:], dtype=src.dtype)
    return out.index_add_(0, seg, src)
def _pad(x, pw):
    flat = tuple(v for pair in reversed(pw) for v in pair)
    return torch.nn.functional.pad(x, flat)

kernel_name = 'parallel_sum__ssm_conv_s5__glu_gated_swiglu__prompt'

def setup_inputs():

    _w = (lambda a: (lambda t: t.to(torch.bfloat16) if t.is_floating_point() else t)(torch.as_tensor(a)))
    def _A_setup():
        B, S, D = 1, 2048, 640
        P = D
        Lambda_re = -0.5 * (lambda _x: torch.exp(torch.as_tensor(_x)))((lambda *s: torch.randn(*s, dtype=torch.bfloat16) * 0.2)(P))
        Lambda_im = (lambda *s: torch.randn(*s, dtype=torch.bfloat16) * 0.8)(P) * 1.0
        B_re = (lambda *s: torch.randn(*s, dtype=torch.bfloat16) * 0.2)(P, D) * (D ** -0.5)
        B_im = (lambda *s: torch.randn(*s, dtype=torch.bfloat16) * 0.2)(P, D) * (D ** -0.5)
        C_re = (lambda *s: torch.randn(*s, dtype=torch.bfloat16) * 0.2)(D, P) * (P ** -0.5)
        C_im = (lambda *s: torch.randn(*s, dtype=torch.bfloat16) * 0.2)(D, P) * (P ** -0.5)
        log_dt = (lambda *s: torch.randn(*s, dtype=torch.bfloat16) * 0.2)(P) * 0.3 - 2.0
        Dskip = (lambda *s: torch.randn(*s, dtype=torch.bfloat16) * 0.05)(D)
        return {
            "x": _w((lambda *s: torch.randn(*s, dtype=torch.bfloat16) * 0.05)(B, S, D)),
            "Lambda_re": _w(Lambda_re),
            "Lambda_im": _w(Lambda_im),
            "B_re": _w(B_re),
            "B_im": _w(B_im),
            "C_re": _w(C_re),
            "C_im": _w(C_im),
            "log_dt": _w(log_dt),
            "Dskip": _w(Dskip),
        }
    _A_in = _A_setup()

    def _B_setup():
        B, S, D, F = 1, 2048, 640, 1536
        return {
            "x": _w((lambda *s: torch.randn(*s, dtype=torch.bfloat16) * 0.05)(B, S, D)),
            "w1": _w((lambda *s: torch.randn(*s, dtype=torch.bfloat16) * 0.4)(D, F) * (2.0 / D) ** 0.5),
            "w3": _w((lambda *s: torch.randn(*s, dtype=torch.bfloat16) * 0.4)(D, F) * (2.0 / D) ** 0.5),
            "w2": _w((lambda *s: torch.randn(*s, dtype=torch.bfloat16) * 0.4)(F, D) * (2.0 / F) ** 0.5),
        }
    _B_in = _B_setup()

    return {
        "A_x": _A_in["x"],
        "A_Lambda_re": _A_in["Lambda_re"],
        "A_Lambda_im": _A_in["Lambda_im"],
        "A_B_re": _A_in["B_re"],
        "A_B_im": _A_in["B_im"],
        "A_C_re": _A_in["C_re"],
        "A_C_im": _A_in["C_im"],
        "A_log_dt": _A_in["log_dt"],
        "A_Dskip": _A_in["Dskip"],
        "B_x": _B_in["x"],
        "B_w1": _B_in["w1"],
        "B_w3": _B_in["w3"],
        "B_w2": _B_in["w2"],
    }

def reference(A_x, A_Lambda_re, A_Lambda_im, A_B_re, A_B_im, A_C_re, A_C_im, A_log_dt, A_Dskip, B_x, B_w1, B_w3, B_w2):
    def _A_ref(x, Lambda_re, Lambda_im, B_re, B_im, C_re, C_im, log_dt, Dskip):
        Bsz, L, H = x.shape
        Lam = Lambda_re + 1j * Lambda_im
        Bmat = B_re + 1j * B_im
        Cmat = C_re + 1j * C_im
        dt = torch.exp(log_dt)
        Lam_bar = torch.exp(dt * Lam)
        B_bar = ((Lam_bar - 1.0) / Lam)[:, None] * Bmat
        Bu = torch.einsum("bld,pd->blp", x + 0j, B_bar)
        h = torch.zeros_like(Bu[:, 0, :])
        hs = []
        for t in range(L):
            h = Lam_bar[None, :] * h + Bu[:, t, :]
            hs.append(h)
        hseq = torch.stack(hs, 1)
        y = 2.0 * torch.einsum("blp,dp->bld", hseq, Cmat).real + x * Dskip[None, None, :]
        return y

    def _B_ref(x, w1, w3, w2):
        gate = torch.einsum("bsd,df->bsf", x, w1)
        up = torch.einsum("bsd,df->bsf", x, w3)
        h = _silu(gate) * up
        out = torch.einsum("bsf,fd->bsd", h, w2)
        return out

    x = A_x
    xn = _layernorm(x, axis=-1)
    return x + _A_ref(xn, A_Lambda_re, A_Lambda_im, A_B_re, A_B_im, A_C_re, A_C_im, A_log_dt, A_Dskip) + _B_ref(xn, B_w1, B_w3, B_w2)
```

```asm
; @launch grid=(256,1,1) block=(512,1,1) lds=163840
.amdgcn_target "amdgcn-amd-amdhsa--gfx950"
.text
.globl parallel_sum__ssm_conv_s5__glu_gated_swiglu__prompt_kernel
.p2align 8
.type parallel_sum__ssm_conv_s5__glu_gated_swiglu__prompt_kernel,@function
parallel_sum__ssm_conv_s5__glu_gated_swiglu__prompt_kernel:
L_code_start:
    s_cmp_ge_u32 s2, 256
    s_cbranch_scc1 L_end
    s_load_dwordx16 s[4:19], s[0:1], 0
    s_load_dwordx16 s[20:35], s[0:1], 64
    v_lshrrev_b32 v1, 6, v0
    v_and_b32 v254, 63, v0
    s_and_b32 s60, s2, 7
    v_readfirstlane_b32 s65, v1
    s_lshr_b32 s61, s2, 3
    s_and_b32 s70, s60, 1
    s_lshl_b32 s70, s70, 3
    s_and_b32 s71, s61, 7
    s_add_u32 s62, s70, s71
    s_lshr_b32 s63, s61, 3
    s_lshr_b32 s72, s60, 1
    s_mul_i32 s64, s72, 3
    s_add_u32 s64, s64, s63
    s_sub_u32 s64, s64, 1
    s_cmp_eq_u32 s63, 0
    s_cselect_b32 s64, s72, s64
    s_lshl_b32 s95, s72, 2
    s_add_u32 s95, s95, s63
    s_add_u32 s95, s95, s70
    s_add_u32 s95, s71, s95
    s_and_b32 s95, s95, 15
    s_mul_i32 s95, s95, 10
    s_lshr_b32 s95, s95, 4
    s_cmp_lt_u32 s65, 4
    s_cbranch_scc1 L_compute
    s_sub_u32 s85, s65, 4
    s_setprio 0
    s_cmp_eq_u32 s63, 0
    s_cbranch_scc1 L_ssm_head
    v_lshrrev_b32 v10, 4, v254
    v_xor_b32 v11, v10, v254
    v_and_b32 v11, 7, v11
    v_lshrrev_b32 v10, 3, v254
    v_mul_u32_u24 v2, 1280, v10
    v_lshl_add_u32 v2, v11, 4, v2
    v_xor_b32 v3, 64, v2
    v_add_u32 v3, 9216, v3
    s_mul_i32 s70, s62, 163840
    s_mul_i32 s71, s85, 40960
    s_add_u32 s70, s70, s71
    v_add_u32 v2, s70, v2
    v_add_u32 v3, s70, v3
    v_add_u32 v4, 18432, v2
    v_add_u32 v5, 18432, v3
    v_lshrrev_b32 v10, 4, v254
    s_and_b32 s70, s85, 1
    s_lshl_b32 s70, s70, 2
    v_or_b32 v11, s70, v10
    v_lshlrev_b32 v11, 1, v11
    v_and_b32 v6, 15, v254
    v_xor_b32 v11, v11, v6
    v_mul_u32_u24 v10, 3072, v10
    v_lshl_add_u32 v10, v11, 4, v10
    s_mul_i32 s70, s85, 24576
    s_lshl_b32 s71, s64, 8
    s_add_u32 s70, s70, s71
    v_add_u32 v6, s70, v10
    v_add_u32 v7, 11264, v6
    s_mul_i32 s81, s95, 128
    s_mul_i32 s82, s95, 196608
    s_lshl_b32 s79, s85, 12
    s_lshl_b32 s78, s85, 11
    s_add_u32 s78, s78, 49152
    s_mov_b32 m0, s79
    s_waitcnt lgkmcnt(0)
    s_load_dword s3, s[4:5], 0
    s_mov_b32 s36, s4
    s_mov_b32 s37, s5
    s_mov_b32 s38, 2621440
    s_mov_b32 s39, 0x20000
    buffer_load_dwordx4 v2, s[36:39], s81 offen offset:0 lds
    buffer_load_dwordx4 v3, s[36:39], s81 offen offset:1024 lds
    buffer_load_dwordx4 v4, s[36:39], s81 offen offset:2048 lds
    buffer_load_dwordx4 v5, s[36:39], s81 offen offset:3072 lds
    s_mov_b32 s40, s24
    s_mov_b32 s41, s25
    s_mov_b32 s42, 1966080
    s_mov_b32 s43, 0x20000
    s_mov_b32 s44, s26
    s_mov_b32 s45, s27
    s_mov_b32 s46, 1966080
    s_mov_b32 s47, 0x20000
    s_add_u32 m0, s78, 0
    s_nop 0
    buffer_load_dwordx4 v6, s[40:43], s82 offen offset:0 lds
    buffer_load_dwordx4 v7, s[40:43], s82 offen offset:1024 lds
    s_add_u32 m0, s78, 8192
    s_nop 0
    buffer_load_dwordx4 v6, s[44:47], s82 offen offset:0 lds
    buffer_load_dwordx4 v7, s[44:47], s82 offen offset:1024 lds
    s_lshl_b32 s70, s85, 9
    s_add_u32 s70, s70, 157696
    v_lshlrev_b32 v253, 2, v254
    v_add_u32 v253, s70, v253
    v_mov_b32 v252, 0
    s_waitcnt lgkmcnt(0)
    v_not_b32 v240, s3
    ds_write2st64_b32 v253, v240, v240 offset0:0 offset1:1
    s_lshl_b32 s71, s85, 8
    v_lshlrev_b32 v245, 2, v254
    v_add_u32 v245, s71, v245
    v_add_u32 v245, 161792, v245
    ds_write_b32 v245, v252
    v_and_b32 v240, 3, v254
    v_lshlrev_b32 v240, 9, v240
    v_add_u32 v240, 159996, v240
    s_waitcnt lgkmcnt(0)
    s_barrier
    s_add_u32 s22, s70, 4
    v_subrev_u32 v246, 8, v240
    s_getpc_b64 s[30:31]
L_gp_mlp:
    s_add_u32 s32, s30, L_subn_mlp-L_gp_mlp
    s_addc_u32 s33, s31, 0
    s_add_u32 s30, s30, L_sub_mlp-L_gp_mlp
    s_addc_u32 s31, s31, 0
    s_mov_b32 s83, 2
    s_mov_b32 s80, 32768
    s_mov_b32 s84, 16384
    s_mov_b32 m0, s22
    s_add_u32 s22, s22, 4
    buffer_load_dword v252, s[36:39], 0 offen lds
    s_add_u32 s82, s82, 98304
    s_add_u32 m0, s78, 16384
    s_nop 0
    buffer_load_dwordx4 v6, s[40:43], s82 offen offset:0 lds
    buffer_load_dwordx4 v7, s[40:43], s82 offen offset:1024 lds
    s_add_u32 m0, s78, 24576
    s_nop 0
    buffer_load_dwordx4 v6, s[44:47], s82 offen offset:0 lds
    buffer_load_dwordx4 v7, s[44:47], s82 offen offset:1024 lds
    s_add_u32 s82, s82, 98304
    s_cmp_eq_u32 s82, 1966080
    s_cselect_b32 s82, 0, s82
    s_add_u32 s81, s81, 128
    s_cmp_eq_u32 s81, 1280
    s_cselect_b32 s81, 0, s81
    s_sub_u32 s70, s61, 8
    s_mul_i32 s71, s70, 13
    s_lshr_b32 s71, s71, 6
    s_mul_i32 s72, s71, 5
    s_sub_u32 s72, s70, s72
    s_mul_i32 s23, s72, 6
    s_lshl_b32 s73, s61, 1
    s_add_u32 s73, s73, 16
    s_cmp_lt_u32 s61, 4
    s_cselect_b32 s73, 30, s73
    s_min_u32 s70, s61, 4
    s_cmp_eq_u32 s63, 0
    s_cselect_b32 s23, s73, s23
    s_cselect_b32 s71, s70, s71
    s_cselect_b32 s72, 5, s72
    s_lshr_b32 s70, s60, 1
    s_lshl_b32 s70, s70, 5
    s_add_u32 s23, s23, s70
    s_lshr_b32 s67, s23, 2
    s_lshl_b32 s68, s71, 6
    s_and_b32 s70, s60, 1
    s_mul_i32 s70, s70, 320
    s_add_u32 s68, s68, s70
    s_mov_b32 s69, 0x3f803f80
    s_mov_b32 s94, 1048576
    s_mov_b32 s98, 0
    s_mov_b32 s99, 0
    s_mov_b32 m0, s22
    s_waitcnt vmcnt(9)
    buffer_load_dword v252, s[36:39], 0 offen lds
    s_swappc_b64 s[90:91], s[32:33]
    s_swappc_b64 s[90:91], s[32:33]
    s_swappc_b64 s[90:91], s[32:33]
    s_load_dword s66, s[34:35], 0
    s_branch L_mlp_loader
L_sub_mlp:
    s_waitcnt lgkmcnt(0)
    v_cmp_ne_u32 vcc, s3, v242
    s_cbranch_vccnz L_sw_206
L_bk_207:
L_subn_mlp:
    s_bitcmp1_b32 s83, 0
    s_cbranch_scc1 L_is_209
    s_add_u32 m0, s84, s79
    s_waitcnt vmcnt(12)
    buffer_load_dwordx4 v2, s[36:39], s81 offen offset:0 lds
    s_waitcnt vmcnt(12)
    buffer_load_dwordx4 v3, s[36:39], s81 offen offset:1024 lds
    s_waitcnt vmcnt(12)
    buffer_load_dwordx4 v4, s[36:39], s81 offen offset:2048 lds
    s_waitcnt vmcnt(12)
    buffer_load_dwordx4 v5, s[36:39], s81 offen offset:3072 lds
    s_add_u32 s84, s84, 16384
    s_cmp_eq_u32 s84, 49152
    s_cselect_b32 s84, 0, s84
L_is_209:
    s_add_u32 m0, s80, s78
    s_waitcnt vmcnt(12)
    buffer_load_dwordx4 v6, s[40:43], s82 offen offset:0 lds
    s_waitcnt vmcnt(12)
    buffer_load_dwordx4 v7, s[40:43], s82 offen offset:1024 lds
    s_add_u32 m0, m0, 8192
    s_waitcnt vmcnt(12)
    buffer_load_dwordx4 v6, s[44:47], s82 offen offset:0 lds
    s_waitcnt vmcnt(12)
    buffer_load_dwordx4 v7, s[44:47], s82 offen offset:1024 lds
    s_add_u32 s82, s82, 98304
    s_cmp_eq_u32 s82, 1966080
    s_cselect_b32 s82, 0, s82
    s_bitcmp1_b32 s83, 0
    s_cbranch_scc0 L_is_209b
    s_add_u32 s81, s81, 128
    s_cmp_eq_u32 s81, 1280
    s_cselect_b32 s81, 0, s81
L_is_209b:
    s_add_u32 s83, s83, 1
    s_add_u32 s22, s22, 4
    v_add_u32 v246, 4, v246
    s_mov_b32 m0, s22
    ds_read_b32 v242, v246
    s_add_u32 s80, s80, 16384
    s_cmp_eq_u32 s80, 81920
    s_cselect_b32 s80, 0, s80
    s_waitcnt vmcnt(12)
    buffer_load_dword v252, s[36:39], 0 offen lds
    s_setpc_b64 s[90:91]
L_sw_206:
L_sr_208:
    ds_read_b32 v242, v246 offset:0
    s_waitcnt lgkmcnt(0)
    v_cmp_ne_u32 vcc, s3, v242
    s_cbranch_vccz L_bk_207
    s_sub_u32 s94, s94, 1
    s_cmp_lg_u32 s94, 0
    s_cbranch_scc1 L_sr_208
    s_mov_b32 s94, 1
    s_branch L_bk_207
L_ssm_head:
    v_lshrrev_b32 v14, 4, v254
    v_xor_b32 v15, v14, v254
    v_and_b32 v15, 7, v15
    v_lshrrev_b32 v14, 5, v254
    v_lshlrev_b32 v14, 4, v14
    v_bfe_u32 v2, v254, 3, 1
    v_lshl_add_u32 v14, v2, 3, v14
    v_bfe_u32 v2, v254, 4, 1
    v_add_u32 v14, v14, v2
    v_mul_u32_u24 v2, 1280, v14
    v_lshl_add_u32 v2, v15, 4, v2
    v_xor_b32 v3, 64, v2
    v_add_u32 v3, 39936, v3
    v_lshrrev_b32 v14, 4, v254
    v_xor_b32 v15, v14, v254
    v_and_b32 v15, 7, v15
    v_lshrrev_b32 v14, 3, v254
    v_mul_u32_u24 v6, 1280, v14
    v_lshl_add_u32 v6, v15, 4, v6
    v_xor_b32 v7, 64, v6
    v_add_u32 v7, 9216, v7
    s_mul_i32 s70, s62, 163840
    s_lshr_b32 s71, s85, 1
    s_mul_i32 s71, s71, 81920
    s_add_u32 s70, s70, s71
    s_and_b32 s71, s85, 1
    s_mul_i32 s71, s71, 5120
    s_add_u32 s70, s70, s71
    v_add_u32 v2, s70, v2
    v_add_u32 v3, s70, v3
    v_add_u32 v4, 512, v2
    v_add_u32 v5, 512, v3
    v_add_u32 v7, 4294958080, v7
    s_mul_i32 s70, s64, 204800
    s_mul_i32 s71, s85, 51200
    s_add_u32 s70, s70, s71
    s_bitcmp1_b32 s85, 0
    s_cselect_b64 vcc, -1, 0
    v_add_u32 v6, s70, v6
    v_add_u32 v7, s70, v7
    v_cndmask_b32 v12, v6, v7, vcc
    v_cndmask_b32 v13, v7, v6, vcc
    v_mov_b32 v6, v12
    v_add_u32 v7, 9216, v13
    v_add_u32 v8, 18432, v12
    v_add_u32 v9, 27648, v13
    v_add_u32 v10, 40960, v12
    s_mul_i32 s81, s95, 128
    s_lshl_b32 s79, s85, 12
    s_mul_i32 s78, s85, 5120
    s_add_u32 s78, s78, 49152
    s_mov_b32 m0, s79
    s_waitcnt lgkmcnt(0)
    s_load_dword s3, s[4:5], 0
    s_mov_b32 s36, s4
    s_mov_b32 s37, s5
    s_mov_b32 s38, 2621440
    s_mov_b32 s39, 0x20000
    buffer_load_dwordx4 v2, s[36:39], s81 offen offset:0 lds
    buffer_load_dwordx4 v3, s[36:39], s81 offen offset:1024 lds
    buffer_load_dwordx4 v4, s[36:39], s81 offen offset:2048 lds
    buffer_load_dwordx4 v5, s[36:39], s81 offen offset:3072 lds
    s_mov_b32 s40, s10
    s_mov_b32 s41, s11
    s_mov_b32 s42, 819200
    s_mov_b32 s43, 0x20000
    s_mov_b32 s44, s12
    s_mov_b32 s45, s13
    s_mov_b32 s46, 819200
    s_mov_b32 s47, 0x20000
    s_mov_b32 m0, s78
    s_nop 0
    buffer_load_dwordx4 v6, s[40:43], s81 offen offset:0 lds
    buffer_load_dwordx4 v7, s[40:43], s81 offen offset:1024 lds
    buffer_load_dwordx4 v8, s[40:43], s81 offen offset:2048 lds
    buffer_load_dwordx4 v9, s[40:43], s81 offen offset:3072 lds
    s_add_u32 m0, m0, 4096
    s_nop 0
    buffer_load_dwordx4 v10, s[40:43], s81 offen lds
    s_lshl_b32 s70, s85, 9
    s_add_u32 s70, s70, 157696
    v_lshlrev_b32 v253, 2, v254
    v_add_u32 v253, s70, v253
    v_mov_b32 v252, 0
    s_waitcnt lgkmcnt(0)
    v_not_b32 v240, s3
    ds_write2st64_b32 v253, v240, v240 offset0:0 offset1:1
    s_lshl_b32 s71, s85, 8
    v_lshlrev_b32 v245, 2, v254
    v_add_u32 v245, s71, v245
    v_add_u32 v245, 161792, v245
    ds_write_b32 v245, v252
    v_and_b32 v240, 3, v254
    v_lshlrev_b32 v240, 9, v240
    v_add_u32 v240, 159996, v240
    s_waitcnt lgkmcnt(0)
    s_barrier
    s_add_u32 s22, s70, 4
    v_subrev_u32 v246, 8, v240
    s_getpc_b64 s[30:31]
L_gp_ssm:
    s_add_u32 s32, s30, L_subn_ssm-L_gp_ssm
    s_addc_u32 s33, s31, 0
    s_add_u32 s30, s30, L_sub_ssm-L_gp_ssm
    s_addc_u32 s31, s31, 0
    s_mov_b32 s83, 2
    s_mov_b32 s80, 40960
    s_mov_b32 s84, 16384
    s_mov_b32 m0, s22
    s_add_u32 s22, s22, 4
    buffer_load_dword v252, s[36:39], 0 offen lds
    s_add_u32 m0, s78, 20480
    s_nop 0
    buffer_load_dwordx4 v6, s[44:47], s81 offen offset:0 lds
    buffer_load_dwordx4 v7, s[44:47], s81 offen offset:1024 lds
    buffer_load_dwordx4 v8, s[44:47], s81 offen offset:2048 lds
    buffer_load_dwordx4 v9, s[44:47], s81 offen offset:3072 lds
    s_add_u32 m0, m0, 4096
    s_nop 0
    buffer_load_dwordx4 v10, s[44:47], s81 offen lds
    s_add_u32 s81, s81, 128
    s_cmp_eq_u32 s81, 1280
    s_cselect_b32 s81, 0, s81
    s_sub_u32 s70, s61, 8
    s_mul_i32 s71, s70, 13
    s_lshr_b32 s71, s71, 6
    s_mul_i32 s72, s71, 5
    s_sub_u32 s72, s70, s72
    s_mul_i32 s23, s72, 6
    s_lshl_b32 s73, s61, 1
    s_add_u32 s73, s73, 16
    s_cmp_lt_u32 s61, 4
    s_cselect_b32 s73, 30, s73
    s_min_u32 s70, s61, 4
    s_cmp_eq_u32 s63, 0
    s_cselect_b32 s23, s73, s23
    s_cselect_b32 s71, s70, s71
    s_cselect_b32 s72, 5, s72
    s_lshr_b32 s70, s60, 1
    s_lshl_b32 s70, s70, 5
    s_add_u32 s23, s23, s70
    s_lshr_b32 s67, s23, 2
    s_lshl_b32 s68, s71, 6
    s_and_b32 s70, s60, 1
    s_mul_i32 s70, s70, 320
    s_add_u32 s68, s68, s70
    s_mov_b32 s69, 0x3f803f80
    s_mov_b32 s94, 1048576
    s_mov_b32 s98, 0
    s_mov_b32 s99, 0
    s_mov_b32 m0, s22
    s_waitcnt vmcnt(9)
    buffer_load_dword v252, s[36:39], 0 offen lds
    s_swappc_b64 s[90:91], s[32:33]
    s_swappc_b64 s[90:91], s[32:33]
    s_swappc_b64 s[90:91], s[32:33]
    s_load_dword s66, s[34:35], 0
    s_branch L_ssm_loader
L_sub_ssm:
    s_waitcnt lgkmcnt(0)
    v_cmp_ne_u32 vcc, s3, v242
    s_cbranch_vccnz L_sw_245
L_bk_246:
L_subn_ssm:
    s_bitcmp1_b32 s83, 0
    s_cbranch_scc1 L_is_248
    s_add_u32 m0, s84, s79
    s_waitcnt vmcnt(12)
    buffer_load_dwordx4 v2, s[36:39], s81 offen offset:0 lds
    s_waitcnt vmcnt(12)
    buffer_load_dwordx4 v3, s[36:39], s81 offen offset:1024 lds
    s_waitcnt vmcnt(12)
    buffer_load_dwordx4 v4, s[36:39], s81 offen offset:2048 lds
    s_waitcnt vmcnt(12)
    buffer_load_dwordx4 v5, s[36:39], s81 offen offset:3072 lds
    s_add_u32 s84, s84, 16384
    s_cmp_eq_u32 s84, 49152
    s_cselect_b32 s84, 0, s84
    s_add_u32 m0, s80, s78
    s_waitcnt vmcnt(12)
    buffer_load_dwordx4 v6, s[40:43], s81 offen offset:0 lds
    s_waitcnt vmcnt(12)
    buffer_load_dwordx4 v7, s[40:43], s81 offen offset:1024 lds
    s_waitcnt vmcnt(12)
    buffer_load_dwordx4 v8, s[40:43], s81 offen offset:2048 lds
    s_waitcnt vmcnt(12)
    buffer_load_dwordx4 v9, s[40:43], s81 offen offset:3072 lds
    s_add_u32 m0, m0, 4096
    s_waitcnt vmcnt(12)
    buffer_load_dwordx4 v10, s[40:43], s81 offen lds
    s_branch L_is_248b
L_is_248:
    s_add_u32 m0, s80, s78
    s_waitcnt vmcnt(12)
    buffer_load_dwordx4 v6, s[44:47], s81 offen offset:0 lds
    s_waitcnt vmcnt(12)
    buffer_load_dwordx4 v7, s[44:47], s81 offen offset:1024 lds
    s_waitcnt vmcnt(12)
    buffer_load_dwordx4 v8, s[44:47], s81 offen offset:2048 lds
    s_waitcnt vmcnt(12)
    buffer_load_dwordx4 v9, s[44:47], s81 offen offset:3072 lds
    s_add_u32 m0, m0, 4096
    s_waitcnt vmcnt(12)
    buffer_load_dwordx4 v10, s[44:47], s81 offen lds
    s_add_u32 s81, s81, 128
    s_cmp_eq_u32 s81, 1280
    s_cselect_b32 s81, 0, s81
L_is_248b:
    s_add_u32 s83, s83, 1
    s_add_u32 s22, s22, 4
    v_add_u32 v246, 4, v246
    s_mov_b32 m0, s22
    ds_read_b32 v242, v246
    s_add_u32 s80, s80, 20480
    s_cmp_eq_u32 s80, 102400
    s_cselect_b32 s80, 0, s80
    s_waitcnt vmcnt(12)
    buffer_load_dword v252, s[36:39], 0 offen lds
    s_setpc_b64 s[90:91]
L_sw_245:
L_sr_247:
    ds_read_b32 v242, v246 offset:0
    s_waitcnt lgkmcnt(0)
    v_cmp_ne_u32 vcc, s3, v242
    s_cbranch_vccz L_bk_246
    s_sub_u32 s94, s94, 1
    s_cmp_lg_u32 s94, 0
    s_cbranch_scc1 L_sr_247
    s_mov_b32 s94, 1
    s_branch L_bk_246
L_compute:
    s_setprio 2
    s_cmp_lg_u32 s65, 3
    s_cbranch_scc1 L_pcd
    s_getpc_b64 s[88:89]
L_pcc:
    s_sub_u32 s88, s88, L_pcc-L_code_start
    s_subb_u32 s89, s89, 0
    s_lshl_b32 s70, s61, 11
    v_and_b32 v2, 15, v254
    v_lshlrev_b32 v2, 7, v2
    v_add_u32 v2, s70, v2
    v_min_u32 v2, L_code_end-L_code_start-8, v2
    global_load_dword v247, v2, s[88:89]
L_pcd:
    s_waitcnt lgkmcnt(0)
    s_load_dword s3, s[4:5], 0
    s_mov_b32 s52, s4
    s_mov_b32 s53, s5
    s_mov_b32 s54, 4
    s_mov_b32 s55, 0x20000
    v_mov_b32 v2, 162816
    v_mov_b32 v3, 0
    ds_write_b32 v2, v3
    s_lshl_b32 s70, s65, 9
    s_add_u32 s70, s70, 159744
    v_lshlrev_b32 v253, 2, v254
    v_add_u32 v253, s70, v253
    v_mov_b32 v252, 0
    s_waitcnt lgkmcnt(0)
    v_not_b32 v248, s3
    ds_write2st64_b32 v253, v248, v248 offset0:0 offset1:1
    v_and_b32 v248, 3, v254
    v_lshlrev_b32 v248, 9, v248
    v_add_u32 v248, 157948, v248
    s_waitcnt lgkmcnt(0)
    s_barrier
    s_mov_b32 s86, s70
    s_sub_u32 s70, s61, 8
    s_mul_i32 s71, s70, 13
    s_lshr_b32 s71, s71, 6
    s_mul_i32 s72, s71, 5
    s_sub_u32 s72, s70, s72
    s_mul_i32 s23, s72, 6
    s_lshl_b32 s73, s61, 1
    s_add_u32 s73, s73, 16
    s_cmp_lt_u32 s61, 4
    s_cselect_b32 s73, 30, s73
    s_min_u32 s70, s61, 4
    s_cmp_eq_u32 s63, 0
    s_cselect_b32 s23, s73, s23
    s_cselect_b32 s71, s70, s71
    s_cselect_b32 s72, 5, s72
    s_lshr_b32 s70, s60, 1
    s_lshl_b32 s70, s70, 5
    s_add_u32 s23, s23, s70
    s_lshr_b32 s67, s23, 2
    s_lshl_b32 s68, s71, 6
    s_and_b32 s70, s60, 1
    s_mul_i32 s70, s70, 320
    s_add_u32 s68, s68, s70
    s_mov_b32 s69, 0x3f803f80
    s_mov_b32 s94, 1048576
    s_mov_b32 s98, 0
    s_mov_b32 s99, 0
    s_cmp_eq_u32 s63, 0
    s_cbranch_scc1 L_ssm_compute
    v_mov_b32 v249, 0
    v_mov_b32 v0, 0
    v_mov_b32 v1, 0
    v_mov_b32 v2, 0
    v_mov_b32 v3, 0
    v_mov_b32 v4, 0
    v_mov_b32 v5, 0
    v_mov_b32 v6, 0
    v_mov_b32 v7, 0
    v_mov_b32 v8, 0
    v_mov_b32 v9, 0
    v_mov_b32 v10, 0
    v_mov_b32 v11, 0
    v_mov_b32 v12, 0
    v_mov_b32 v13, 0
    v_mov_b32 v14, 0
    v_mov_b32 v15, 0
    v_mov_b32 v16, 0
    v_mov_b32 v17, 0
    v_mov_b32 v18, 0
    v_mov_b32 v19, 0
    v_mov_b32 v20, 0
    v_mov_b32 v21, 0
    v_mov_b32 v22, 0
    v_mov_b32 v23, 0
    v_mov_b32 v24, 0
    v_mov_b32 v25, 0
    v_mov_b32 v26, 0
    v_mov_b32 v27, 0
    v_mov_b32 v28, 0
    v_mov_b32 v29, 0
    v_mov_b32 v30, 0
    v_mov_b32 v31, 0
    v_mov_b32 v32, 0
    v_mov_b32 v33, 0
    v_mov_b32 v34, 0
    v_mov_b32 v35, 0
    v_mov_b32 v36, 0
    v_mov_b32 v37, 0
    v_mov_b32 v38, 0
    v_mov_b32 v39, 0
    v_mov_b32 v40, 0
    v_mov_b32 v41, 0
    v_mov_b32 v42, 0
    v_mov_b32 v43, 0
    v_mov_b32 v44, 0
    v_mov_b32 v45, 0
    v_mov_b32 v46, 0
    v_mov_b32 v47, 0
    v_mov_b32 v48, 0
    v_mov_b32 v49, 0
    v_mov_b32 v50, 0
    v_mov_b32 v51, 0
    v_mov_b32 v52, 0
    v_mov_b32 v53, 0
    v_mov_b32 v54, 0
    v_mov_b32 v55, 0
    v_mov_b32 v56, 0
    v_mov_b32 v57, 0
    v_mov_b32 v58, 0
    v_mov_b32 v59, 0
    v_mov_b32 v60, 0
    v_mov_b32 v61, 0
    v_mov_b32 v62, 0
    v_mov_b32 v63, 0
    v_mov_b32 v64, 0
    v_mov_b32 v65, 0
    v_mov_b32 v66, 0
    v_mov_b32 v67, 0
    v_mov_b32 v68, 0
    v_mov_b32 v69, 0
    v_mov_b32 v70, 0
    v_mov_b32 v71, 0
    v_mov_b32 v72, 0
    v_mov_b32 v73, 0
    v_mov_b32 v74, 0
    v_mov_b32 v75, 0
    v_mov_b32 v76, 0
    v_mov_b32 v77, 0
    v_mov_b32 v78, 0
    v_mov_b32 v79, 0
    v_mov_b32 v80, 0
    v_mov_b32 v81, 0
    v_mov_b32 v82, 0
    v_mov_b32 v83, 0
    v_mov_b32 v84, 0
    v_mov_b32 v85, 0
    v_mov_b32 v86, 0
    v_mov_b32 v87, 0
    v_mov_b32 v88, 0
    v_mov_b32 v89, 0
    v_mov_b32 v90, 0
    v_mov_b32 v91, 0
    v_mov_b32 v92, 0
    v_mov_b32 v93, 0
    v_mov_b32 v94, 0
    v_mov_b32 v95, 0
    v_mov_b32 v96, 0
    v_mov_b32 v97, 0
    v_mov_b32 v98, 0
    v_mov_b32 v99, 0
    v_mov_b32 v100, 0
    v_mov_b32 v101, 0
    v_mov_b32 v102, 0
    v_mov_b32 v103, 0
    v_mov_b32 v104, 0
    v_mov_b32 v105, 0
    v_mov_b32 v106, 0
    v_mov_b32 v107, 0
    v_mov_b32 v108, 0
    v_mov_b32 v109, 0
    v_mov_b32 v110, 0
    v_mov_b32 v111, 0
    v_mov_b32 v112, 0
    v_mov_b32 v113, 0
    v_mov_b32 v114, 0
    v_mov_b32 v115, 0
    v_mov_b32 v116, 0
    v_mov_b32 v117, 0
    v_mov_b32 v118, 0
    v_mov_b32 v119, 0
    v_mov_b32 v120, 0
    v_mov_b32 v121, 0
    v_mov_b32 v122, 0
    v_mov_b32 v123, 0
    v_mov_b32 v124, 0
    v_mov_b32 v125, 0
    v_mov_b32 v126, 0
    v_mov_b32 v127, 0
    v_bfe_u32 v198, v254, 1, 3
    v_lshrrev_b32 v192, 4, v254
    v_xor_b32 v198, v198, v192
    v_and_b32 v192, 15, v254
    v_lshlrev_b32 v192, 7, v192
    v_lshl_add_u32 v192, v198, 4, v192
    s_and_b32 s70, s65, 1
    s_lshl_b32 s70, s70, 13
    v_add_u32 v192, s70, v192
    v_xor_b32 v193, 64, v192
    v_lshrrev_b32 v198, 4, v254
    v_bfe_u32 v199, v254, 2, 2
    v_and_b32 v160, 1, v198
    v_lshl_add_u32 v160, v160, 2, v199
    v_lshl_add_u32 v198, v198, 3, v199
    v_lshlrev_b32 v198, 8, v198
    v_and_b32 v199, 3, v254
    v_lshl_add_u32 v198, v199, 3, v198
    v_add_u32 v198, 49152, v198
    s_lshr_b32 s70, s65, 1
    s_lshl_b32 s70, s70, 2
    s_add_u32 s71, s70, 0
    v_xor_b32 v199, s71, v160
    v_lshl_add_u32 v194, v199, 5, v198
    s_add_u32 s71, s70, 1
    v_xor_b32 v199, s71, v160
    v_lshl_add_u32 v195, v199, 5, v198
    s_add_u32 s71, s70, 2
    v_xor_b32 v199, s71, v160
    v_lshl_add_u32 v196, v199, 5, v198
    s_add_u32 s71, s70, 3
    v_xor_b32 v199, s71, v160
    v_lshl_add_u32 v197, v199, 5, v198
    s_mov_b32 s80, 0
    s_mov_b32 s83, 0
    s_mov_b32 s81, 0
    s_mov_b32 m0, s86
    s_mov_b32 s85, 2
    ds_read_b32 v250, v248 offset:4
    s_waitcnt lgkmcnt(0)
    v_cmp_ne_u32 vcc, s3, v250
    s_cbranch_vccnz L_sw_1
L_bk_2:
    v_add_u32 v248, 4, v248
    ds_read_b64_tr_b16 v[160:161], v194 offset:0
    ds_read_b64_tr_b16 v[162:163], v194 offset:1024
    ds_read_b128 v[128:131], v192 offset:0
    ds_read_b128 v[132:135], v192 offset:2048
    ds_read_b64_tr_b16 v[164:165], v194 offset:8192
    ds_read_b64_tr_b16 v[166:167], v194 offset:9216
    ds_read_b128 v[136:139], v192 offset:4096
    ds_read_b128 v[140:143], v192 offset:6144
    ds_read_b64_tr_b16 v[168:169], v195 offset:0
    ds_read_b64_tr_b16 v[170:171], v195 offset:1024
    ds_read_b64_tr_b16 v[172:173], v195 offset:8192
    ds_read_b64_tr_b16 v[174:175], v195 offset:9216
    s_mov_b32 s70, 16384
    s_mov_b32 s71, 4294901760
    s_mov_b32 s72, 16384
    s_mov_b32 s73, 4294934528
L_g1_mlp:
    s_waitcnt lgkmcnt(4)
    v_mfma_f32_16x16x32_bf16 v[0:3], v[160:163], v[128:131], v[0:3]
    ds_read_b64_tr_b16 v[176:177], v196 offset:0
    v_mfma_f32_16x16x32_bf16 v[4:7], v[160:163], v[132:135], v[4:7]
    ds_read_b64_tr_b16 v[178:179], v196 offset:1024
    v_mfma_f32_16x16x32_bf16 v[8:11], v[160:163], v[136:139], v[8:11]
    s_add_u32 s80, s80, 1
    s_cmp_eq_u32 s80, 5
    v_mfma_f32_16x16x32_bf16 v[12:15], v[160:163], v[140:143], v[12:15]
    v_add_u32 v248, 4, v248
    v_mfma_f32_16x16x32_bf16 v[16:19], v[164:167], v[128:131], v[16:19]
    ds_read_b64_tr_b16 v[180:181], v196 offset:8192
    v_mfma_f32_16x16x32_bf16 v[20:23], v[164:167], v[132:135], v[20:23]
    ds_read_b64_tr_b16 v[182:183], v196 offset:9216
    v_mfma_f32_16x16x32_bf16 v[24:27], v[164:167], v[136:139], v[24:27]
    s_cselect_b32 s84, s71, s70
    s_cselect_b32 s80, 0, s80
    v_mfma_f32_16x16x32_bf16 v[28:31], v[164:167], v[140:143], v[28:31]
    ds_read_b32 v250, v248
    s_waitcnt lgkmcnt(7)
    v_mfma_f32_16x16x32_bf16 v[32:35], v[168:171], v[128:131], v[32:35]
    ds_read_b64_tr_b16 v[184:185], v197 offset:0
    v_mfma_f32_16x16x32_bf16 v[36:39], v[168:171], v[132:135], v[36:39]
    ds_read_b64_tr_b16 v[186:187], v197 offset:1024
    v_mfma_f32_16x16x32_bf16 v[40:43], v[168:171], v[136:139], v[40:43]
    v_add_u32 v194, s84, v194
    v_add_u32 v195, s84, v195
    v_mfma_f32_16x16x32_bf16 v[44:47], v[168:171], v[140:143], v[44:47]
    s_waitcnt lgkmcnt(2)
    v_mfma_f32_16x16x32_bf16 v[48:51], v[172:175], v[128:131], v[48:51]
    ds_read_b64_tr_b16 v[188:189], v197 offset:8192
    v_cmp_ne_u32 vcc, s3, v250
    v_mfma_f32_16x16x32_bf16 v[52:55], v[172:175], v[132:135], v[52:55]
    ds_read_b64_tr_b16 v[190:191], v197 offset:9216
    v_mfma_f32_16x16x32_bf16 v[56:59], v[172:175], v[136:139], v[56:59]
    s_add_u32 s81, s81, 1
    s_cmp_eq_u32 s81, 3
    v_mfma_f32_16x16x32_bf16 v[60:63], v[172:175], v[140:143], v[60:63]
    s_cselect_b32 s82, s73, s72
    s_cselect_b32 s81, 0, s81
    v_mfma_f32_16x16x32_bf16 v[64:67], v[176:179], v[128:131], v[64:67]
    s_cbranch_vccnz L_sw_4
L_bk_5:
    v_mfma_f32_16x16x32_bf16 v[68:71], v[176:179], v[132:135], v[68:71]
    ds_read_b64_tr_b16 v[160:161], v194 offset:0
    v_mfma_f32_16x16x32_bf16 v[72:75], v[176:179], v[136:139], v[72:75]
    ds_read_b64_tr_b16 v[162:163], v194 offset:1024
    v_mfma_f32_16x16x32_bf16 v[76:79], v[176:179], v[140:143], v[76:79]
    ds_read_b128 v[144:147], v193 offset:0
    ds_read_b128 v[148:151], v193 offset:2048
    v_mfma_f32_16x16x32_bf16 v[80:83], v[180:183], v[128:131], v[80:83]
    ds_read_b64_tr_b16 v[164:165], v194 offset:8192
    v_mfma_f32_16x16x32_bf16 v[84:87], v[180:183], v[132:135], v[84:87]
    ds_read_b64_tr_b16 v[166:167], v194 offset:9216
    v_mfma_f32_16x16x32_bf16 v[88:91], v[180:183], v[136:139], v[88:91]
    ds_read_b128 v[152:155], v193 offset:4096
    v_mfma_f32_16x16x32_bf16 v[92:95], v[180:183], v[140:143], v[92:95]
    ds_read_b128 v[156:159], v193 offset:6144
    s_waitcnt lgkmcnt(10)
    v_mfma_f32_16x16x32_bf16 v[96:99], v[184:187], v[128:131], v[96:99]
    ds_read_b64_tr_b16 v[168:169], v195 offset:0
    v_mfma_f32_16x16x32_bf16 v[100:103], v[184:187], v[132:135], v[100:103]
    ds_read_b64_tr_b16 v[170:171], v195 offset:1024
    v_mfma_f32_16x16x32_bf16 v[104:107], v[184:187], v[136:139], v[104:107]
    v_add_u32 v196, s84, v196
    s_add_u32 m0, m0, 4
    v_mfma_f32_16x16x32_bf16 v[108:111], v[184:187], v[140:143], v[108:111]
    s_waitcnt lgkmcnt(10)
    v_mfma_f32_16x16x32_bf16 v[112:115], v[188:191], v[128:131], v[112:115]
    ds_read_b64_tr_b16 v[172:173], v195 offset:8192
    v_mfma_f32_16x16x32_bf16 v[116:119], v[188:191], v[132:135], v[116:119]
    ds_read_b64_tr_b16 v[174:175], v195 offset:9216
    v_mfma_f32_16x16x32_bf16 v[120:123], v[188:191], v[136:139], v[120:123]
    v_add_u32 v197, s84, v197
    buffer_load_dword v252, s[52:55], 0 offen lds
    v_mfma_f32_16x16x32_bf16 v[124:127], v[188:191], v[140:143], v[124:127]
    s_waitcnt lgkmcnt(4)
    v_mfma_f32_16x16x32_bf16 v[0:3], v[160:163], v[144:147], v[0:3]
    ds_read_b64_tr_b16 v[176:177], v196 offset:0
    v_mfma_f32_16x16x32_bf16 v[4:7], v[160:163], v[148:151], v[4:7]
    ds_read_b64_tr_b16 v[178:179], v196 offset:1024
    v_mfma_f32_16x16x32_bf16 v[8:11], v[160:163], v[152:155], v[8:11]
    s_add_u32 s80, s80, 1
    s_cmp_eq_u32 s80, 5
    v_mfma_f32_16x16x32_bf16 v[12:15], v[160:163], v[156:159], v[12:15]
    v_add_u32 v248, 4, v248
    v_mfma_f32_16x16x32_bf16 v[16:19], v[164:167], v[144:147], v[16:19]
    ds_read_b64_tr_b16 v[180:181], v196 offset:8192
    v_mfma_f32_16x16x32_bf16 v[20:23], v[164:167], v[148:151], v[20:23]
    ds_read_b64_tr_b16 v[182:183], v196 offset:9216
    v_mfma_f32_16x16x32_bf16 v[24:27], v[164:167], v[152:155], v[24:27]
    s_cselect_b32 s84, s71, s70
    s_cselect_b32 s80, 0, s80
    v_mfma_f32_16x16x32_bf16 v[28:31], v[164:167], v[156:159], v[28:31]
    ds_read_b32 v250, v248
    s_waitcnt lgkmcnt(7)
    v_mfma_f32_16x16x32_bf16 v[32:35], v[168:171], v[144:147], v[32:35]
    ds_read_b64_tr_b16 v[184:185], v197 offset:0
    v_mfma_f32_16x16x32_bf16 v[36:39], v[168:171], v[148:151], v[36:39]
    ds_read_b64_tr_b16 v[186:187], v197 offset:1024
    v_mfma_f32_16x16x32_bf16 v[40:43], v[168:171], v[152:155], v[40:43]
    v_add_u32 v194, s84, v194
    v_add_u32 v195, s84, v195
    v_mfma_f32_16x16x32_bf16 v[44:47], v[168:171], v[156:159], v[44:47]
    s_waitcnt lgkmcnt(2)
    v_mfma_f32_16x16x32_bf16 v[48:51], v[172:175], v[144:147], v[48:51]
    ds_read_b64_tr_b16 v[188:189], v197 offset:8192
    v_cmp_ne_u32 vcc, s3, v250
    v_mfma_f32_16x16x32_bf16 v[52:55], v[172:175], v[148:151], v[52:55]
    ds_read_b64_tr_b16 v[190:191], v197 offset:9216
    v_mfma_f32_16x16x32_bf16 v[56:59], v[172:175], v[152:155], v[56:59]
    v_add_u32 v192, s82, v192
    v_add_u32 v193, s82, v193
    v_mfma_f32_16x16x32_bf16 v[60:63], v[172:175], v[156:159], v[60:63]
    v_mfma_f32_16x16x32_bf16 v[64:67], v[176:179], v[144:147], v[64:67]
    s_cbranch_vccnz L_sw_7
L_bk_8:
    v_mfma_f32_16x16x32_bf16 v[68:71], v[176:179], v[148:151], v[68:71]
    ds_read_b64_tr_b16 v[160:161], v194 offset:0
    v_mfma_f32_16x16x32_bf16 v[72:75], v[176:179], v[152:155], v[72:75]
    ds_read_b64_tr_b16 v[162:163], v194 offset:1024
    v_mfma_f32_16x16x32_bf16 v[76:79], v[176:179], v[156:159], v[76:79]
    ds_read_b128 v[128:131], v192 offset:0
    ds_read_b128 v[132:135], v192 offset:2048
    v_mfma_f32_16x16x32_bf16 v[80:83], v[180:183], v[144:147], v[80:83]
    ds_read_b64_tr_b16 v[164:165], v194 offset:8192
    v_mfma_f32_16x16x32_bf16 v[84:87], v[180:183], v[148:151], v[84:87]
    ds_read_b64_tr_b16 v[166:167], v194 offset:9216
    v_mfma_f32_16x16x32_bf16 v[88:91], v[180:183], v[152:155], v[88:91]
    ds_read_b128 v[136:139], v192 offset:4096
    v_mfma_f32_16x16x32_bf16 v[92:95], v[180:183], v[156:159], v[92:95]
    ds_read_b128 v[140:143], v192 offset:6144
    s_waitcnt lgkmcnt(10)
    v_mfma_f32_16x16x32_bf16 v[96:99], v[184:187], v[144:147], v[96:99]
    ds_read_b64_tr_b16 v[168:169], v195 offset:0
    v_mfma_f32_16x16x32_bf16 v[100:103], v[184:187], v[148:151], v[100:103]
    ds_read_b64_tr_b16 v[170:171], v195 offset:1024
    v_mfma_f32_16x16x32_bf16 v[104:107], v[184:187], v[152:155], v[104:107]
    v_add_u32 v196, s84, v196
    s_add_u32 m0, m0, 4
    v_mfma_f32_16x16x32_bf16 v[108:111], v[184:187], v[156:159], v[108:111]
    s_waitcnt lgkmcnt(10)
    v_mfma_f32_16x16x32_bf16 v[112:115], v[188:191], v[144:147], v[112:115]
    ds_read_b64_tr_b16 v[172:173], v195 offset:8192
    v_mfma_f32_16x16x32_bf16 v[116:119], v[188:191], v[148:151], v[116:119]
    ds_read_b64_tr_b16 v[174:175], v195 offset:9216
    v_mfma_f32_16x16x32_bf16 v[120:123], v[188:191], v[152:155], v[120:123]
    v_add_u32 v197, s84, v197
    buffer_load_dword v252, s[52:55], 0 offen lds
    v_mfma_f32_16x16x32_bf16 v[124:127], v[188:191], v[156:159], v[124:127]
    s_add_u32 s83, s83, 1
    s_cmp_lt_u32 s83, s85
    s_cbranch_scc1 L_g1_mlp
    s_cmp_eq_u32 s83, 10
    s_cbranch_scc1 L_g1e_10
    s_cmp_lg_u32 s83, 2
    s_cbranch_scc1 L_g1w_11
    s_mov_b32 s86, m0
    s_load_dword s66, s[34:35], 0
    s_mov_b64 s[88:89], s[70:71]
    s_mov_b64 s[90:91], s[72:73]
    s_cmp_ge_u32 s65, 2
    s_cbranch_scc1 L_bw_12
    v_lshrrev_b32 v242, 4, v254
    s_lshl_b32 s71, s65, 2
    v_add_u32 v242, s71, v242
    s_sub_u32 s70, s61, 8
    s_min_u32 s70, s70, 19
    s_lshl_b32 s70, s70, 3
    s_lshr_b32 s71, s60, 1
    s_mul_i32 s71, s71, 160
    s_add_u32 s72, s70, s71
    s_bitcmp1_b32 s60, 0
    s_cselect_b32 s74, s12, s10
    s_cselect_b32 s75, s13, s11
    s_cselect_b32 s73, 640, 0
    v_add_u32 v244, s72, v242
    v_add_u32 v243, s73, v244
    s_lshr_b32 s70, s60, 1
    s_lshl_b32 s70, s70, 2
    s_add_u32 s70, s70, s63
    s_lshl_b32 s70, s70, 3
    s_lshl_b32 s71, s62, 7
    s_add_u32 s70, s70, s71
    v_add_u32 v242, s70, v242
    v_and_b32 v220, 15, v254
    v_mul_u32_u24 v221, 1280, v242
    v_lshl_add_u32 v221, v220, 4, v221
    global_load_dwordx4 v[200:203], v221, s[4:5] offset:0
    global_load_dwordx4 v[204:207], v221, s[4:5] offset:256
    global_load_dwordx4 v[208:211], v221, s[4:5] offset:512
    global_load_dwordx4 v[212:215], v221, s[4:5] offset:768
    global_load_dwordx4 v[216:219], v221, s[4:5] offset:1024
    v_and_b32 v240, 15, v254
    v_mul_u32_u24 v241, 1280, v244
    v_lshl_add_u32 v241, v240, 4, v241
    global_load_dwordx4 v[220:223], v241, s[74:75] offset:0
    global_load_dwordx4 v[224:227], v241, s[74:75] offset:256
    global_load_dwordx4 v[228:231], v241, s[74:75] offset:512
    global_load_dwordx4 v[232:235], v241, s[74:75] offset:768
    global_load_dwordx4 v[236:239], v241, s[74:75] offset:1024
    s_branch L_bw_13
L_bw_12:
    s_and_b32 s70, s61, 3
    s_lshl_b32 s71, s64, 2
    s_add_u32 s71, s71, s70
    s_bitcmp1_b32 s61, 2
    s_cselect_b32 s70, 48, 0
    s_add_u32 s71, s71, s70
    s_and_b32 s72, s60, 1
    s_lshl_b32 s72, s72, 1
    s_sub_u32 s75, s65, 2
    s_add_u32 s72, s72, s75
    s_mul_i32 s75, s75, 10240
    s_add_u32 s75, s75, 131072
    v_and_b32 v201, 3, v254
    v_lshrrev_b32 v202, 4, v254
    v_lshlrev_b32 v203, 5, v202
    v_lshlrev_b32 v202, 9, v202
    v_bfe_u32 v200, v254, 2, 2
    v_lshl_add_u32 v202, v200, 6, v202
    v_lshl_add_u32 v202, v201, 3, v202
    v_add_u32 v202, s75, v202
    s_mul_i32 s72, s72, 24576
    s_lshl_b32 s71, s71, 8
    s_add_u32 s72, s72, s71
    s_add_u32 s72, s72, 65536
    v_add_u32 v249, s72, v203
    v_and_b32 v201, 15, v254
    v_mov_b32 v204, s69
    v_mov_b32 v205, s69
    v_mov_b32 v206, s69
    v_mov_b32 v207, s69
L_bw_13:
    s_mov_b64 s[70:71], s[88:89]
    s_mov_b64 s[72:73], s[90:91]
    s_mov_b32 m0, s86
    s_mov_b32 s85, 5
    s_branch L_g1_mlp
L_g1w_11:
    s_waitcnt lgkmcnt(0)
    s_add_u32 s66, s66, 1
    s_cmp_ge_u32 s65, 2
    s_cbranch_scc1 L_bw_14
    v_mov_b32 v244, 0
    v_mov_b32 v246, 0
    v_mov_b32 v245, 0
    v_mov_b32 v247, 0
    s_waitcnt vmcnt(6)
    v_dot2c_f32_bf16 v244, s69, v200
    v_dot2c_f32_bf16 v246, v200, v200
    v_dot2c_f32_bf16 v245, s69, v220
    v_dot2c_f32_bf16 v244, s69, v201
    v_dot2c_f32_bf16 v246, v201, v201
    v_dot2c_f32_bf16 v247, s69, v221
    v_dot2c_f32_bf16 v244, s69, v202
    v_dot2c_f32_bf16 v246, v202, v202
    v_dot2c_f32_bf16 v245, s69, v222
    v_dot2c_f32_bf16 v244, s69, v203
    v_dot2c_f32_bf16 v246, v203, v203
    v_dot2c_f32_bf16 v247, s69, v223
    v_dot2c_f32_bf16 v244, s69, v204
    v_dot2c_f32_bf16 v246, v204, v204
    v_dot2c_f32_bf16 v245, s69, v224
    v_dot2c_f32_bf16 v244, s69, v205
    v_dot2c_f32_bf16 v246, v205, v205
    v_dot2c_f32_bf16 v247, s69, v225
    v_dot2c_f32_bf16 v244, s69, v206
    v_dot2c_f32_bf16 v246, v206, v206
    v_dot2c_f32_bf16 v245, s69, v226
    v_dot2c_f32_bf16 v244, s69, v207
    v_dot2c_f32_bf16 v246, v207, v207
    v_dot2c_f32_bf16 v247, s69, v227
    v_dot2c_f32_bf16 v244, s69, v208
    v_dot2c_f32_bf16 v246, v208, v208
    v_dot2c_f32_bf16 v245, s69, v228
    v_dot2c_f32_bf16 v244, s69, v209
    v_dot2c_f32_bf16 v246, v209, v209
    v_dot2c_f32_bf16 v247, s69, v229
    v_dot2c_f32_bf16 v244, s69, v210
    v_dot2c_f32_bf16 v246, v210, v210
    v_dot2c_f32_bf16 v245, s69, v230
    v_dot2c_f32_bf16 v244, s69, v211
    v_dot2c_f32_bf16 v246, v211, v211
    v_dot2c_f32_bf16 v247, s69, v231
    v_dot2c_f32_bf16 v244, s69, v212
    v_dot2c_f32_bf16 v246, v212, v212
    v_dot2c_f32_bf16 v245, s69, v232
    v_dot2c_f32_bf16 v244, s69, v213
    v_dot2c_f32_bf16 v246, v213, v213
    v_dot2c_f32_bf16 v247, s69, v233
    v_dot2c_f32_bf16 v244, s69, v214
    v_dot2c_f32_bf16 v246, v214, v214
    v_dot2c_f32_bf16 v245, s69, v234
    v_dot2c_f32_bf16 v244, s69, v215
    v_dot2c_f32_bf16 v246, v215, v215
    v_dot2c_f32_bf16 v247, s69, v235
    v_dot2c_f32_bf16 v244, s69, v216
    v_dot2c_f32_bf16 v246, v216, v216
    v_dot2c_f32_bf16 v245, s69, v236
    v_dot2c_f32_bf16 v244, s69, v217
    v_dot2c_f32_bf16 v246, v217, v217
    v_dot2c_f32_bf16 v247, s69, v237
    v_dot2c_f32_bf16 v244, s69, v218
    v_dot2c_f32_bf16 v246, v218, v218
    v_dot2c_f32_bf16 v245, s69, v238
    v_dot2c_f32_bf16 v244, s69, v219
    v_dot2c_f32_bf16 v246, v219, v219
    v_dot2c_f32_bf16 v247, s69, v239
    s_nop 2
    v_add_f32 v200, v245, v247
    s_nop 1
    v_add_f32_dpp v244, v244, v244 row_ror:8 row_mask:0xf bank_mask:0xf
    v_add_f32_dpp v246, v246, v246 row_ror:8 row_mask:0xf bank_mask:0xf
    v_add_f32_dpp v200, v200, v200 row_ror:8 row_mask:0xf bank_mask:0xf
    s_nop 1
    v_add_f32_dpp v244, v244, v244 row_ror:4 row_mask:0xf bank_mask:0xf
    v_add_f32_dpp v246, v246, v246 row_ror:4 row_mask:0xf bank_mask:0xf
    v_add_f32_dpp v200, v200, v200 row_ror:4 row_mask:0xf bank_mask:0xf
    s_nop 1
    v_add_f32_dpp v244, v244, v244 row_ror:2 row_mask:0xf bank_mask:0xf
    v_add_f32_dpp v246, v246, v246 row_ror:2 row_mask:0xf bank_mask:0xf
    v_add_f32_dpp v200, v200, v200 row_ror:2 row_mask:0xf bank_mask:0xf
    s_nop 1
    v_add_f32_dpp v244, v244, v244 row_ror:1 row_mask:0xf bank_mask:0xf
    v_add_f32_dpp v246, v246, v246 row_ror:1 row_mask:0xf bank_mask:0xf
    v_add_f32_dpp v200, v200, v200 row_ror:1 row_mask:0xf bank_mask:0xf
    v_mul_f32 v244, 0x3acccccd, v244
    v_mul_f32 v246, 0x3acccccd, v246
    v_fma_f32 v246, -v244, v244, v246
    v_max_f32 v246, 0, v246
    v_cvt_pk_bf16_f32 v246, v246, v246
    v_lshlrev_b32 v246, 16, v246
    v_add_f32 v246, 0x3727c5ac, v246
    v_cvt_pk_bf16_f32 v246, v246, v246
    v_lshlrev_b32 v246, 16, v246
    v_sqrt_f32 v246, v246
    v_lshlrev_b32 v242, 3, v242
    v_add_u32 v242, 16384, v242
    v_cvt_pk_bf16_f32 v244, v244, v246
    v_mov_b32 v245, s66
    v_cmp_eq_u32 vcc, 0, v240
    v_mov_b32 v201, s66
    v_lshlrev_b32 v243, 3, v243
    v_add_u32 v243, 32768, v243
    s_and_saveexec_b64 s[92:93], vcc
    global_store_dwordx2 v242, v[244:245], s[34:35] sc1
    global_store_dwordx2 v243, v[200:201], s[34:35] sc1
    s_mov_b64 exec, s[92:93]
    s_branch L_bw_15
L_bw_14:
    s_waitcnt vmcnt(6)
    ds_read_b64_tr_b16 v[208:209], v202 offset:0
    ds_read_b64_tr_b16 v[210:211], v202 offset:256
    ds_read_b64_tr_b16 v[212:213], v202 offset:2048
    ds_read_b64_tr_b16 v[214:215], v202 offset:2304
    ds_read_b64_tr_b16 v[216:217], v202 offset:4096
    ds_read_b64_tr_b16 v[218:219], v202 offset:4352
    ds_read_b64_tr_b16 v[220:221], v202 offset:6144
    ds_read_b64_tr_b16 v[222:223], v202 offset:6400
    ds_read_b64_tr_b16 v[224:225], v202 offset:8192
    ds_read_b64_tr_b16 v[226:227], v202 offset:8448
    ds_read_b64_tr_b16 v[228:229], v202 offset:32
    ds_read_b64_tr_b16 v[230:231], v202 offset:288
    ds_read_b64_tr_b16 v[232:233], v202 offset:2080
    ds_read_b64_tr_b16 v[234:235], v202 offset:2336
    ds_read_b64_tr_b16 v[236:237], v202 offset:4128
    ds_read_b64_tr_b16 v[238:239], v202 offset:4384
    ds_read_b64_tr_b16 v[240:241], v202 offset:6176
    ds_read_b64_tr_b16 v[242:243], v202 offset:6432
    ds_read_b64_tr_b16 v[244:245], v202 offset:8224
    ds_read_b64_tr_b16 v[246:247], v202 offset:8480
    v_cmp_eq_u32 vcc, 0, v201
    s_waitcnt lgkmcnt(0)
    v_mfma_f32_16x16x32_bf16 v[200:203], v[208:211], v[204:207], 0
    v_mfma_f32_16x16x32_bf16 v[200:203], v[212:215], v[204:207], v[200:203]
    v_mfma_f32_16x16x32_bf16 v[200:203], v[216:219], v[204:207], v[200:203]
    v_mfma_f32_16x16x32_bf16 v[200:203], v[220:223], v[204:207], v[200:203]
    v_mfma_f32_16x16x32_bf16 v[200:203], v[224:227], v[204:207], v[200:203]
    v_mfma_f32_16x16x32_bf16 v[208:211], v[228:231], v[204:207], 0
    v_mfma_f32_16x16x32_bf16 v[208:211], v[232:235], v[204:207], v[208:211]
    v_mfma_f32_16x16x32_bf16 v[208:211], v[236:239], v[204:207], v[208:211]
    v_mfma_f32_16x16x32_bf16 v[208:211], v[240:243], v[204:207], v[208:211]
    v_mfma_f32_16x16x32_bf16 v[208:211], v[244:247], v[204:207], v[208:211]
    s_nop 7
    v_mov_b32 v212, v200
    v_mov_b32 v213, s66
    v_mov_b32 v214, v201
    v_mov_b32 v215, s66
    v_mov_b32 v216, v202
    v_mov_b32 v217, s66
    v_mov_b32 v218, v203
    v_mov_b32 v219, s66
    v_mov_b32 v220, v208
    v_mov_b32 v221, s66
    v_mov_b32 v222, v209
    v_mov_b32 v223, s66
    v_mov_b32 v224, v210
    v_mov_b32 v225, s66
    v_mov_b32 v226, v211
    v_mov_b32 v227, s66
    s_and_saveexec_b64 s[92:93], vcc
    global_store_dwordx4 v249, v[212:215], s[34:35] offset:0 sc1
    global_store_dwordx4 v249, v[216:219], s[34:35] offset:16 sc1
    global_store_dwordx4 v249, v[220:223], s[34:35] offset:128 sc1
    global_store_dwordx4 v249, v[224:227], s[34:35] offset:144 sc1
    s_mov_b64 exec, s[92:93]
L_bw_15:
    s_mov_b64 s[88:89], s[70:71]
    s_mov_b64 s[90:91], s[72:73]
    s_sub_u32 s73, s2, 64
    s_cmp_lt_u32 s65, 2
    s_cselect_b32 s70, 39, 33
    s_mov_b32 s71, 4352
    s_cmov_b32 s71, 10240
    s_cselect_b32 s74, s28, s14
    s_cselect_b32 s75, s29, s15
    s_mov_b32 s76, 819196
    s_cmov_b32 s76, 1966076
    s_cmp_eq_u32 s65, 3
    s_cselect_b32 s74, s16, s74
    s_cselect_b32 s75, s17, s75
    s_mul_i32 s71, s71, s73
    s_cmp_eq_u32 s65, 1
    s_cselect_b32 s72, 5120, 0
    s_add_u32 s71, s71, s72
    v_min_u32 v251, s70, v254
    v_lshlrev_b32 v251, 7, v251
    v_add_u32 v251, s71, v251
    v_min_u32 v251, s76, v251
    global_load_dword v251, v251, s[74:75]
    s_mov_b64 s[70:71], s[88:89]
    s_mov_b64 s[72:73], s[90:91]
    s_mov_b32 s85, 10
    s_branch L_g1_mlp
L_g1e_10:
    s_waitcnt lgkmcnt(0)
    s_setprio 3
    s_and_b32 s70, s65, 1
    s_lshl_b32 s70, s70, 10
    s_add_u32 s70, s70, 151552
    v_and_b32 v192, 15, v254
    v_lshlrev_b32 v192, 4, v192
    v_add_u32 v192, s70, v192
    s_lshr_b32 s70, s65, 1
    s_lshl_b32 s70, s70, 8
    s_add_u32 s70, s70, 153600
    v_lshrrev_b32 v193, 4, v254
    v_lshlrev_b32 v193, 4, v193
    v_add_u32 v193, s70, v193
    ds_read_b128 v[128:131], v192 offset:0
    ds_read_b128 v[132:135], v192 offset:256
    ds_read_b128 v[136:139], v192 offset:512
    ds_read_b128 v[140:143], v192 offset:768
    ds_read_b128 v[144:147], v193 offset:0
    ds_read_b128 v[148:151], v193 offset:512
    ds_read_b128 v[152:155], v193 offset:64
    ds_read_b128 v[156:159], v193 offset:576
    ds_read_b128 v[160:163], v193 offset:128
    ds_read_b128 v[164:167], v193 offset:640
    ds_read_b128 v[168:171], v193 offset:192
    ds_read_b128 v[172:175], v193 offset:704
    s_lshl_b32 s70, s62, 1
    s_and_b32 s71, s65, 1
    s_add_u32 s70, s70, s71
    s_mul_i32 s70, s70, 88
    s_lshl_b32 s71, s64, 2
    s_add_u32 s70, s70, s71
    s_and_b32 s71, s65, 2
    s_add_u32 s70, s70, s71
    s_lshl_b32 s70, s70, 12
    s_add_u32 s70, s70, 1048576
    v_lshlrev_b32 v194, 4, v254
    v_add_u32 v194, s70, v194
    v_add_u32 v195, 4096, v194
    s_waitcnt lgkmcnt(0)
    v_pk_fma_f32 v[0:1], v[144:145], v[128:129], v[0:1] op_sel_hi:[1,0,1] neg_lo:[0,1,0] neg_hi:[0,1,0]
    v_pk_fma_f32 v[2:3], v[146:147], v[128:129], v[2:3] op_sel_hi:[1,0,1] neg_lo:[0,1,0] neg_hi:[0,1,0]
    v_pk_fma_f32 v[32:33], v[152:153], v[128:129], v[32:33] op_sel_hi:[1,0,1] neg_lo:[0,1,0] neg_hi:[0,1,0]
    v_pk_fma_f32 v[34:35], v[154:155], v[128:129], v[34:35] op_sel_hi:[1,0,1] neg_lo:[0,1,0] neg_hi:[0,1,0]
    v_pk_mul_f32 v[176:177], v[0:1], v[128:129] op_sel:[0,1] op_sel_hi:[1,1]
    v_pk_mul_f32 v[178:179], v[2:3], v[128:129] op_sel:[0,1] op_sel_hi:[1,1]
    v_pk_mul_f32 v[180:181], v[32:33], v[128:129] op_sel:[0,1] op_sel_hi:[1,1]
    v_pk_mul_f32 v[182:183], v[34:35], v[128:129] op_sel:[0,1] op_sel_hi:[1,1]
    v_exp_f32 v176, v176
    v_exp_f32 v177, v177
    v_pk_fma_f32 v[16:17], v[148:149], v[128:129], v[16:17] op_sel_hi:[1,0,1] neg_lo:[0,1,0] neg_hi:[0,1,0]
    v_exp_f32 v178, v178
    v_exp_f32 v179, v179
    v_pk_fma_f32 v[18:19], v[150:151], v[128:129], v[18:19] op_sel_hi:[1,0,1] neg_lo:[0,1,0] neg_hi:[0,1,0]
    v_exp_f32 v180, v180
    v_exp_f32 v181, v181
    v_pk_fma_f32 v[48:49], v[156:157], v[128:129], v[48:49] op_sel_hi:[1,0,1] neg_lo:[0,1,0] neg_hi:[0,1,0]
    v_exp_f32 v182, v182
    v_exp_f32 v183, v183
    v_pk_fma_f32 v[50:51], v[158:159], v[128:129], v[50:51] op_sel_hi:[1,0,1] neg_lo:[0,1,0] neg_hi:[0,1,0]
    v_pk_fma_f32 v[176:177], v[176:177], v[130:131], v[130:131] op_sel_hi:[1,0,0]
    v_pk_fma_f32 v[178:179], v[178:179], v[130:131], v[130:131] op_sel_hi:[1,0,0]
    v_pk_fma_f32 v[180:181], v[180:181], v[130:131], v[130:131] op_sel_hi:[1,0,0]
    v_pk_fma_f32 v[182:183], v[182:183], v[130:131], v[130:131] op_sel_hi:[1,0,0]
    v_rcp_f32 v176, v176
    v_rcp_f32 v177, v177
    v_pk_mul_f32 v[0:1], v[0:1], v[16:17]
    v_rcp_f32 v178, v178
    v_rcp_f32 v179, v179
    v_pk_mul_f32 v[2:3], v[2:3], v[18:19]
    v_rcp_f32 v180, v180
    v_rcp_f32 v181, v181
    v_pk_mul_f32 v[32:33], v[32:33], v[48:49]
    v_rcp_f32 v182, v182
    v_rcp_f32 v183, v183
    v_pk_mul_f32 v[34:35], v[34:35], v[50:51]
    v_pk_mul_f32 v[0:1], v[0:1], v[176:177]
    v_pk_mul_f32 v[2:3], v[2:3], v[178:179]
    v_pk_mul_f32 v[32:33], v[32:33], v[180:181]
    v_pk_mul_f32 v[34:35], v[34:35], v[182:183]
    v_cvt_pk_bf16_f32 v184, v0, v1
    v_cvt_pk_bf16_f32 v185, v2, v3
    v_cvt_pk_bf16_f32 v186, v32, v33
    v_cvt_pk_bf16_f32 v187, v34, v35
    global_store_dwordx4 v194, v[184:187], s[34:35] offset:0 sc1
    v_pk_fma_f32 v[4:5], v[144:145], v[132:133], v[4:5] op_sel_hi:[1,0,1] neg_lo:[0,1,0] neg_hi:[0,1,0]
    v_pk_fma_f32 v[6:7], v[146:147], v[132:133], v[6:7] op_sel_hi:[1,0,1] neg_lo:[0,1,0] neg_hi:[0,1,0]
    v_pk_fma_f32 v[36:37], v[152:153], v[132:133], v[36:37] op_sel_hi:[1,0,1] neg_lo:[0,1,0] neg_hi:[0,1,0]
    v_pk_fma_f32 v[38:39], v[154:155], v[132:133], v[38:39] op_sel_hi:[1,0,1] neg_lo:[0,1,0] neg_hi:[0,1,0]
    v_pk_mul_f32 v[176:177], v[4:5], v[132:133] op_sel:[0,1] op_sel_hi:[1,1]
    v_pk_mul_f32 v[178:179], v[6:7], v[132:133] op_sel:[0,1] op_sel_hi:[1,1]
    v_pk_mul_f32 v[180:181], v[36:37], v[132:133] op_sel:[0,1] op_sel_hi:[1,1]
    v_pk_mul_f32 v[182:183], v[38:39], v[132:133] op_sel:[0,1] op_sel_hi:[1,1]
    v_exp_f32 v176, v176
    v_exp_f32 v177, v177
    v_pk_fma_f32 v[20:21], v[148:149], v[132:133], v[20:21] op_sel_hi:[1,0,1] neg_lo:[0,1,0] neg_hi:[0,1,0]
    v_exp_f32 v178, v178
    v_exp_f32 v179, v179
    v_pk_fma_f32 v[22:23], v[150:151], v[132:133], v[22:23] op_sel_hi:[1,0,1] neg_lo:[0,1,0] neg_hi:[0,1,0]
    v_exp_f32 v180, v180
    v_exp_f32 v181, v181
    v_pk_fma_f32 v[52:53], v[156:157], v[132:133], v[52:53] op_sel_hi:[1,0,1] neg_lo:[0,1,0] neg_hi:[0,1,0]
    v_exp_f32 v182, v182
    v_exp_f32 v183, v183
    v_pk_fma_f32 v[54:55], v[158:159], v[132:133], v[54:55] op_sel_hi:[1,0,1] neg_lo:[0,1,0] neg_hi:[0,1,0]
    v_pk_fma_f32 v[176:177], v[176:177], v[134:135], v[134:135] op_sel_hi:[1,0,0]
    v_pk_fma_f32 v[178:179], v[178:179], v[134:135], v[134:135] op_sel_hi:[1,0,0]
    v_pk_fma_f32 v[180:181], v[180:181], v[134:135], v[134:135] op_sel_hi:[1,0,0]
    v_pk_fma_f32 v[182:183], v[182:183], v[134:135], v[134:135] op_sel_hi:[1,0,0]
    v_rcp_f32 v176, v176
    v_rcp_f32 v177, v177
    v_pk_mul_f32 v[4:5], v[4:5], v[20:21]
    v_rcp_f32 v178, v178
    v_rcp_f32 v179, v179
    v_pk_mul_f32 v[6:7], v[6:7], v[22:23]
    v_rcp_f32 v180, v180
    v_rcp_f32 v181, v181
    v_pk_mul_f32 v[36:37], v[36:37], v[52:53]
    v_rcp_f32 v182, v182
    v_rcp_f32 v183, v183
    v_pk_mul_f32 v[38:39], v[38:39], v[54:55]
    v_pk_mul_f32 v[4:5], v[4:5], v[176:177]
    v_pk_mul_f32 v[6:7], v[6:7], v[178:179]
    v_pk_mul_f32 v[36:37], v[36:37], v[180:181]
    v_pk_mul_f32 v[38:39], v[38:39], v[182:183]
    v_cvt_pk_bf16_f32 v188, v4, v5
    v_cvt_pk_bf16_f32 v189, v6, v7
    v_cvt_pk_bf16_f32 v190, v36, v37
    v_cvt_pk_bf16_f32 v191, v38, v39
    global_store_dwordx4 v194, v[188:191], s[34:35] offset:1024 sc1
    v_pk_fma_f32 v[8:9], v[144:145], v[136:137], v[8:9] op_sel_hi:[1,0,1] neg_lo:[0,1,0] neg_hi:[0,1,0]
    v_pk_fma_f32 v[10:11], v[146:147], v[136:137], v[10:11] op_sel_hi:[1,0,1] neg_lo:[0,1,0] neg_hi:[0,1,0]
    v_pk_fma_f32 v[40:41], v[152:153], v[136:137], v[40:41] op_sel_hi:[1,0,1] neg_lo:[0,1,0] neg_hi:[0,1,0]
    v_pk_fma_f32 v[42:43], v[154:155], v[136:137], v[42:43] op_sel_hi:[1,0,1] neg_lo:[0,1,0] neg_hi:[0,1,0]
    v_pk_mul_f32 v[176:177], v[8:9], v[136:137] op_sel:[0,1] op_sel_hi:[1,1]
    v_pk_mul_f32 v[178:179], v[10:11], v[136:137] op_sel:[0,1] op_sel_hi:[1,1]
    v_pk_mul_f32 v[180:181], v[40:41], v[136:137] op_sel:[0,1] op_sel_hi:[1,1]
    v_pk_mul_f32 v[182:183], v[42:43], v[136:137] op_sel:[0,1] op_sel_hi:[1,1]
    v_exp_f32 v176, v176
    v_exp_f32 v177, v177
    v_pk_fma_f32 v[24:25], v[148:149], v[136:137], v[24:25] op_sel_hi:[1,0,1] neg_lo:[0,1,0] neg_hi:[0,1,0]
    v_exp_f32 v178, v178
    v_exp_f32 v179, v179
    v_pk_fma_f32 v[26:27], v[150:151], v[136:137], v[26:27] op_sel_hi:[1,0,1] neg_lo:[0,1,0] neg_hi:[0,1,0]
    v_exp_f32 v180, v180
    v_exp_f32 v181, v181
    v_pk_fma_f32 v[56:57], v[156:157], v[136:137], v[56:57] op_sel_hi:[1,0,1] neg_lo:[0,1,0] neg_hi:[0,1,0]
    v_exp_f32 v182, v182
    v_exp_f32 v183, v183
    v_pk_fma_f32 v[58:59], v[158:159], v[136:137], v[58:59] op_sel_hi:[1,0,1] neg_lo:[0,1,0] neg_hi:[0,1,0]
    v_pk_fma_f32 v[176:177], v[176:177], v[138:139], v[138:139] op_sel_hi:[1,0,0]
    v_pk_fma_f32 v[178:179], v[178:179], v[138:139], v[138:139] op_sel_hi:[1,0,0]
    v_pk_fma_f32 v[180:181], v[180:181], v[138:139], v[138:139] op_sel_hi:[1,0,0]
    v_pk_fma_f32 v[182:183], v[182:183], v[138:139], v[138:139] op_sel_hi:[1,0,0]
    v_rcp_f32 v176, v176
    v_rcp_f32 v177, v177
    v_pk_mul_f32 v[8:9], v[8:9], v[24:25]
    v_rcp_f32 v178, v178
    v_rcp_f32 v179, v179
    v_pk_mul_f32 v[10:11], v[10:11], v[26:27]
    v_rcp_f32 v180, v180
    v_rcp_f32 v181, v181
    v_pk_mul_f32 v[40:41], v[40:41], v[56:57]
    v_rcp_f32 v182, v182
    v_rcp_f32 v183, v183
    v_pk_mul_f32 v[42:43], v[42:43], v[58:59]
    v_pk_mul_f32 v[8:9], v[8:9], v[176:177]
    v_pk_mul_f32 v[10:11], v[10:11], v[178:179]
    v_pk_mul_f32 v[40:41], v[40:41], v[180:181]
    v_pk_mul_f32 v[42:43], v[42:43], v[182:183]
    v_cvt_pk_bf16_f32 v184, v8, v9
    v_cvt_pk_bf16_f32 v185, v10, v11
    v_cvt_pk_bf16_f32 v186, v40, v41
    v_cvt_pk_bf16_f32 v187, v42, v43
    global_store_dwordx4 v194, v[184:187], s[34:35] offset:2048 sc1
    v_pk_fma_f32 v[12:13], v[144:145], v[140:141], v[12:13] op_sel_hi:[1,0,1] neg_lo:[0,1,0] neg_hi:[0,1,0]
    v_pk_fma_f32 v[14:15], v[146:147], v[140:141], v[14:15] op_sel_hi:[1,0,1] neg_lo:[0,1,0] neg_hi:[0,1,0]
    v_pk_fma_f32 v[44:45], v[152:153], v[140:141], v[44:45] op_sel_hi:[1,0,1] neg_lo:[0,1,0] neg_hi:[0,1,0]
    v_pk_fma_f32 v[46:47], v[154:155], v[140:141], v[46:47] op_sel_hi:[1,0,1] neg_lo:[0,1,0] neg_hi:[0,1,0]
    v_pk_mul_f32 v[176:177], v[12:13], v[140:141] op_sel:[0,1] op_sel_hi:[1,1]
    v_pk_mul_f32 v[178:179], v[14:15], v[140:141] op_sel:[0,1] op_sel_hi:[1,1]
    v_pk_mul_f32 v[180:181], v[44:45], v[140:141] op_sel:[0,1] op_sel_hi:[1,1]
    v_pk_mul_f32 v[182:183], v[46:47], v[140:141] op_sel:[0,1] op_sel_hi:[1,1]
    v_exp_f32 v176, v176
    v_exp_f32 v177, v177
    v_pk_fma_f32 v[28:29], v[148:149], v[140:141], v[28:29] op_sel_hi:[1,0,1] neg_lo:[0,1,0] neg_hi:[0,1,0]
    v_exp_f32 v178, v178
    v_exp_f32 v179, v179
    v_pk_fma_f32 v[30:31], v[150:151], v[140:141], v[30:31] op_sel_hi:[1,0,1] neg_lo:[0,1,0] neg_hi:[0,1,0]
    v_exp_f32 v180, v180
    v_exp_f32 v181, v181
    v_pk_fma_f32 v[60:61], v[156:157], v[140:141], v[60:61] op_sel_hi:[1,0,1] neg_lo:[0,1,0] neg_hi:[0,1,0]
    v_exp_f32 v182, v182
    v_exp_f32 v183, v183
    v_pk_fma_f32 v[62:63], v[158:159], v[140:141], v[62:63] op_sel_hi:[1,0,1] neg_lo:[0,1,0] neg_hi:[0,1,0]
    v_pk_fma_f32 v[176:177], v[176:177], v[142:143], v[142:143] op_sel_hi:[1,0,0]
    v_pk_fma_f32 v[178:179], v[178:179], v[142:143], v[142:143] op_sel_hi:[1,0,0]
    v_pk_fma_f32 v[180:181], v[180:181], v[142:143], v[142:143] op_sel_hi:[1,0,0]
    v_pk_fma_f32 v[182:183], v[182:183], v[142:143], v[142:143] op_sel_hi:[1,0,0]
    v_rcp_f32 v176, v176
    v_rcp_f32 v177, v177
    v_pk_mul_f32 v[12:13], v[12:13], v[28:29]
    v_rcp_f32 v178, v178
    v_rcp_f32 v179, v179
    v_pk_mul_f32 v[14:15], v[14:15], v[30:31]
    v_rcp_f32 v180, v180
    v_rcp_f32 v181, v181
    v_pk_mul_f32 v[44:45], v[44:45], v[60:61]
    v_rcp_f32 v182, v182
    v_rcp_f32 v183, v183
    v_pk_mul_f32 v[46:47], v[46:47], v[62:63]
    v_pk_mul_f32 v[12:13], v[12:13], v[176:177]
    v_pk_mul_f32 v[14:15], v[14:15], v[178:179]
    v_pk_mul_f32 v[44:45], v[44:45], v[180:181]
    v_pk_mul_f32 v[46:47], v[46:47], v[182:183]
    v_cvt_pk_bf16_f32 v188, v12, v13
    v_cvt_pk_bf16_f32 v189, v14, v15
    v_cvt_pk_bf16_f32 v190, v44, v45
    v_cvt_pk_bf16_f32 v191, v46, v47
    global_store_dwordx4 v194, v[188:191], s[34:35] offset:3072 sc1
    v_pk_fma_f32 v[64:65], v[160:161], v[128:129], v[64:65] op_sel_hi:[1,0,1] neg_lo:[0,1,0] neg_hi:[0,1,0]
    v_pk_fma_f32 v[66:67], v[162:163], v[128:129], v[66:67] op_sel_hi:[1,0,1] neg_lo:[0,1,0] neg_hi:[0,1,0]
    v_pk_fma_f32 v[96:97], v[168:169], v[128:129], v[96:97] op_sel_hi:[1,0,1] neg_lo:[0,1,0] neg_hi:[0,1,0]
    v_pk_fma_f32 v[98:99], v[170:171], v[128:129], v[98:99] op_sel_hi:[1,0,1] neg_lo:[0,1,0] neg_hi:[0,1,0]
    v_pk_mul_f32 v[176:177], v[64:65], v[128:129] op_sel:[0,1] op_sel_hi:[1,1]
    v_pk_mul_f32 v[178:179], v[66:67], v[128:129] op_sel:[0,1] op_sel_hi:[1,1]
    v_pk_mul_f32 v[180:181], v[96:97], v[128:129] op_sel:[0,1] op_sel_hi:[1,1]
    v_pk_mul_f32 v[182:183], v[98:99], v[128:129] op_sel:[0,1] op_sel_hi:[1,1]
    v_exp_f32 v176, v176
    v_exp_f32 v177, v177
    v_pk_fma_f32 v[80:81], v[164:165], v[128:129], v[80:81] op_sel_hi:[1,0,1] neg_lo:[0,1,0] neg_hi:[0,1,0]
    v_exp_f32 v178, v178
    v_exp_f32 v179, v179
    v_pk_fma_f32 v[82:83], v[166:167], v[128:129], v[82:83] op_sel_hi:[1,0,1] neg_lo:[0,1,0] neg_hi:[0,1,0]
    v_exp_f32 v180, v180
    v_exp_f32 v181, v181
    v_pk_fma_f32 v[112:113], v[172:173], v[128:129], v[112:113] op_sel_hi:[1,0,1] neg_lo:[0,1,0] neg_hi:[0,1,0]
    v_exp_f32 v182, v182
    v_exp_f32 v183, v183
    v_pk_fma_f32 v[114:115], v[174:175], v[128:129], v[114:115] op_sel_hi:[1,0,1] neg_lo:[0,1,0] neg_hi:[0,1,0]
    v_pk_fma_f32 v[176:177], v[176:177], v[130:131], v[130:131] op_sel_hi:[1,0,0]
    v_pk_fma_f32 v[178:179], v[178:179], v[130:131], v[130:131] op_sel_hi:[1,0,0]
    v_pk_fma_f32 v[180:181], v[180:181], v[130:131], v[130:131] op_sel_hi:[1,0,0]
    v_pk_fma_f32 v[182:183], v[182:183], v[130:131], v[130:131] op_sel_hi:[1,0,0]
    v_rcp_f32 v176, v176
    v_rcp_f32 v177, v177
    v_pk_mul_f32 v[64:65], v[64:65], v[80:81]
    v_rcp_f32 v178, v178
    v_rcp_f32 v179, v179
    v_pk_mul_f32 v[66:67], v[66:67], v[82:83]
    v_rcp_f32 v180, v180
    v_rcp_f32 v181, v181
    v_pk_mul_f32 v[96:97], v[96:97], v[112:113]
    v_rcp_f32 v182, v182
    v_rcp_f32 v183, v183
    v_pk_mul_f32 v[98:99], v[98:99], v[114:115]
    v_pk_mul_f32 v[64:65], v[64:65], v[176:177]
    v_pk_mul_f32 v[66:67], v[66:67], v[178:179]
    v_pk_mul_f32 v[96:97], v[96:97], v[180:181]
    v_pk_mul_f32 v[98:99], v[98:99], v[182:183]
    v_cvt_pk_bf16_f32 v184, v64, v65
    v_cvt_pk_bf16_f32 v185, v66, v67
    v_cvt_pk_bf16_f32 v186, v96, v97
    v_cvt_pk_bf16_f32 v187, v98, v99
    global_store_dwordx4 v195, v[184:187], s[34:35] offset:0 sc1
    v_pk_fma_f32 v[68:69], v[160:161], v[132:133], v[68:69] op_sel_hi:[1,0,1] neg_lo:[0,1,0] neg_hi:[0,1,0]
    v_pk_fma_f32 v[70:71], v[162:163], v[132:133], v[70:71] op_sel_hi:[1,0,1] neg_lo:[0,1,0] neg_hi:[0,1,0]
    v_pk_fma_f32 v[100:101], v[168:169], v[132:133], v[100:101] op_sel_hi:[1,0,1] neg_lo:[0,1,0] neg_hi:[0,1,0]
    v_pk_fma_f32 v[102:103], v[170:171], v[132:133], v[102:103] op_sel_hi:[1,0,1] neg_lo:[0,1,0] neg_hi:[0,1,0]
    v_pk_mul_f32 v[176:177], v[68:69], v[132:133] op_sel:[0,1] op_sel_hi:[1,1]
    v_pk_mul_f32 v[178:179], v[70:71], v[132:133] op_sel:[0,1] op_sel_hi:[1,1]
    v_pk_mul_f32 v[180:181], v[100:101], v[132:133] op_sel:[0,1] op_sel_hi:[1,1]
    v_pk_mul_f32 v[182:183], v[102:103], v[132:133] op_sel:[0,1] op_sel_hi:[1,1]
    v_exp_f32 v176, v176
    v_exp_f32 v177, v177
    v_pk_fma_f32 v[84:85], v[164:165], v[132:133], v[84:85] op_sel_hi:[1,0,1] neg_lo:[0,1,0] neg_hi:[0,1,0]
    v_exp_f32 v178, v178
    v_exp_f32 v179, v179
    v_pk_fma_f32 v[86:87], v[166:167], v[132:133], v[86:87] op_sel_hi:[1,0,1] neg_lo:[0,1,0] neg_hi:[0,1,0]
    v_exp_f32 v180, v180
    v_exp_f32 v181, v181
    v_pk_fma_f32 v[116:117], v[172:173], v[132:133], v[116:117] op_sel_hi:[1,0,1] neg_lo:[0,1,0] neg_hi:[0,1,0]
    v_exp_f32 v182, v182
    v_exp_f32 v183, v183
    v_pk_fma_f32 v[118:119], v[174:175], v[132:133], v[118:119] op_sel_hi:[1,0,1] neg_lo:[0,1,0] neg_hi:[0,1,0]
    v_pk_fma_f32 v[176:177], v[176:177], v[134:135], v[134:135] op_sel_hi:[1,0,0]
    v_pk_fma_f32 v[178:179], v[178:179], v[134:135], v[134:135] op_sel_hi:[1,0,0]
    v_pk_fma_f32 v[180:181], v[180:181], v[134:135], v[134:135] op_sel_hi:[1,0,0]
    v_pk_fma_f32 v[182:183], v[182:183], v[134:135], v[134:135] op_sel_hi:[1,0,0]
    v_rcp_f32 v176, v176
    v_rcp_f32 v177, v177
    v_pk_mul_f32 v[68:69], v[68:69], v[84:85]
    v_rcp_f32 v178, v178
    v_rcp_f32 v179, v179
    v_pk_mul_f32 v[70:71], v[70:71], v[86:87]
    v_rcp_f32 v180, v180
    v_rcp_f32 v181, v181
    v_pk_mul_f32 v[100:101], v[100:101], v[116:117]
    v_rcp_f32 v182, v182
    v_rcp_f32 v183, v183
    v_pk_mul_f32 v[102:103], v[102:103], v[118:119]
    v_pk_mul_f32 v[68:69], v[68:69], v[176:177]
    v_pk_mul_f32 v[70:71], v[70:71], v[178:179]
    v_pk_mul_f32 v[100:101], v[100:101], v[180:181]
    v_pk_mul_f32 v[102:103], v[102:103], v[182:183]
    v_cvt_pk_bf16_f32 v188, v68, v69
    v_cvt_pk_bf16_f32 v189, v70, v71
    v_cvt_pk_bf16_f32 v190, v100, v101
    v_cvt_pk_bf16_f32 v191, v102, v103
    global_store_dwordx4 v195, v[188:191], s[34:35] offset:1024 sc1
    v_pk_fma_f32 v[72:73], v[160:161], v[136:137], v[72:73] op_sel_hi:[1,0,1] neg_lo:[0,1,0] neg_hi:[0,1,0]
    v_pk_fma_f32 v[74:75], v[162:163], v[136:137], v[74:75] op_sel_hi:[1,0,1] neg_lo:[0,1,0] neg_hi:[0,1,0]
    v_pk_fma_f32 v[104:105], v[168:169], v[136:137], v[104:105] op_sel_hi:[1,0,1] neg_lo:[0,1,0] neg_hi:[0,1,0]
    v_pk_fma_f32 v[106:107], v[170:171], v[136:137], v[106:107] op_sel_hi:[1,0,1] neg_lo:[0,1,0] neg_hi:[0,1,0]
    v_pk_mul_f32 v[176:177], v[72:73], v[136:137] op_sel:[0,1] op_sel_hi:[1,1]
    v_pk_mul_f32 v[178:179], v[74:75], v[136:137] op_sel:[0,1] op_sel_hi:[1,1]
    v_pk_mul_f32 v[180:181], v[104:105], v[136:137] op_sel:[0,1] op_sel_hi:[1,1]
    v_pk_mul_f32 v[182:183], v[106:107], v[136:137] op_sel:[0,1] op_sel_hi:[1,1]
    v_exp_f32 v176, v176
    v_exp_f32 v177, v177
    v_pk_fma_f32 v[88:89], v[164:165], v[136:137], v[88:89] op_sel_hi:[1,0,1] neg_lo:[0,1,0] neg_hi:[0,1,0]
    v_exp_f32 v178, v178
    v_exp_f32 v179, v179
    v_pk_fma_f32 v[90:91], v[166:167], v[136:137], v[90:91] op_sel_hi:[1,0,1] neg_lo:[0,1,0] neg_hi:[0,1,0]
    v_exp_f32 v180, v180
    v_exp_f32 v181, v181
    v_pk_fma_f32 v[120:121], v[172:173], v[136:137], v[120:121] op_sel_hi:[1,0,1] neg_lo:[0,1,0] neg_hi:[0,1,0]
    v_exp_f32 v182, v182
    v_exp_f32 v183, v183
    v_pk_fma_f32 v[122:123], v[174:175], v[136:137], v[122:123] op_sel_hi:[1,0,1] neg_lo:[0,1,0] neg_hi:[0,1,0]
    v_pk_fma_f32 v[176:177], v[176:177], v[138:139], v[138:139] op_sel_hi:[1,0,0]
    v_pk_fma_f32 v[178:179], v[178:179], v[138:139], v[138:139] op_sel_hi:[1,0,0]
    v_pk_fma_f32 v[180:181], v[180:181], v[138:139], v[138:139] op_sel_hi:[1,0,0]
    v_pk_fma_f32 v[182:183], v[182:183], v[138:139], v[138:139] op_sel_hi:[1,0,0]
    v_rcp_f32 v176, v176
    v_rcp_f32 v177, v177
    v_pk_mul_f32 v[72:73], v[72:73], v[88:89]
    v_rcp_f32 v178, v178
    v_rcp_f32 v179, v179
    v_pk_mul_f32 v[74:75], v[74:75], v[90:91]
    v_rcp_f32 v180, v180
    v_rcp_f32 v181, v181
    v_pk_mul_f32 v[104:105], v[104:105], v[120:121]
    v_rcp_f32 v182, v182
    v_rcp_f32 v183, v183
    v_pk_mul_f32 v[106:107], v[106:107], v[122:123]
    v_pk_mul_f32 v[72:73], v[72:73], v[176:177]
    v_pk_mul_f32 v[74:75], v[74:75], v[178:179]
    v_pk_mul_f32 v[104:105], v[104:105], v[180:181]
    v_pk_mul_f32 v[106:107], v[106:107], v[182:183]
    v_cvt_pk_bf16_f32 v184, v72, v73
    v_cvt_pk_bf16_f32 v185, v74, v75
    v_cvt_pk_bf16_f32 v186, v104, v105
    v_cvt_pk_bf16_f32 v187, v106, v107
    global_store_dwordx4 v195, v[184:187], s[34:35] offset:2048 sc1
    v_pk_fma_f32 v[76:77], v[160:161], v[140:141], v[76:77] op_sel_hi:[1,0,1] neg_lo:[0,1,0] neg_hi:[0,1,0]
    v_pk_fma_f32 v[78:79], v[162:163], v[140:141], v[78:79] op_sel_hi:[1,0,1] neg_lo:[0,1,0] neg_hi:[0,1,0]
    v_pk_fma_f32 v[108:109], v[168:169], v[140:141], v[108:109] op_sel_hi:[1,0,1] neg_lo:[0,1,0] neg_hi:[0,1,0]
    v_pk_fma_f32 v[110:111], v[170:171], v[140:141], v[110:111] op_sel_hi:[1,0,1] neg_lo:[0,1,0] neg_hi:[0,1,0]
    v_pk_mul_f32 v[176:177], v[76:77], v[140:141] op_sel:[0,1] op_sel_hi:[1,1]
    v_pk_mul_f32 v[178:179], v[78:79], v[140:141] op_sel:[0,1] op_sel_hi:[1,1]
    v_pk_mul_f32 v[180:181], v[108:109], v[140:141] op_sel:[0,1] op_sel_hi:[1,1]
    v_pk_mul_f32 v[182:183], v[110:111], v[140:141] op_sel:[0,1] op_sel_hi:[1,1]
    v_exp_f32 v176, v176
    v_exp_f32 v177, v177
    v_pk_fma_f32 v[92:93], v[164:165], v[140:141], v[92:93] op_sel_hi:[1,0,1] neg_lo:[0,1,0] neg_hi:[0,1,0]
    v_exp_f32 v178, v178
    v_exp_f32 v179, v179
    v_pk_fma_f32 v[94:95], v[166:167], v[140:141], v[94:95] op_sel_hi:[1,0,1] neg_lo:[0,1,0] neg_hi:[0,1,0]
    v_exp_f32 v180, v180
    v_exp_f32 v181, v181
    v_pk_fma_f32 v[124:125], v[172:173], v[140:141], v[124:125] op_sel_hi:[1,0,1] neg_lo:[0,1,0] neg_hi:[0,1,0]
    v_exp_f32 v182, v182
    v_exp_f32 v183, v183
    v_pk_fma_f32 v[126:127], v[174:175], v[140:141], v[126:127] op_sel_hi:[1,0,1] neg_lo:[0,1,0] neg_hi:[0,1,0]
    v_pk_fma_f32 v[176:177], v[176:177], v[142:143], v[142:143] op_sel_hi:[1,0,0]
    v_pk_fma_f32 v[178:179], v[178:179], v[142:143], v[142:143] op_sel_hi:[1,0,0]
    v_pk_fma_f32 v[180:181], v[180:181], v[142:143], v[142:143] op_sel_hi:[1,0,0]
    v_pk_fma_f32 v[182:183], v[182:183], v[142:143], v[142:143] op_sel_hi:[1,0,0]
    v_rcp_f32 v176, v176
    v_rcp_f32 v177, v177
    v_pk_mul_f32 v[76:77], v[76:77], v[92:93]
    v_rcp_f32 v178, v178
    v_rcp_f32 v179, v179
    v_pk_mul_f32 v[78:79], v[78:79], v[94:95]
    v_rcp_f32 v180, v180
    v_rcp_f32 v181, v181
    v_pk_mul_f32 v[108:109], v[108:109], v[124:125]
    v_rcp_f32 v182, v182
    v_rcp_f32 v183, v183
    v_pk_mul_f32 v[110:111], v[110:111], v[126:127]
    v_pk_mul_f32 v[76:77], v[76:77], v[176:177]
    v_pk_mul_f32 v[78:79], v[78:79], v[178:179]
    v_pk_mul_f32 v[108:109], v[108:109], v[180:181]
    v_pk_mul_f32 v[110:111], v[110:111], v[182:183]
    v_cvt_pk_bf16_f32 v188, v76, v77
    v_cvt_pk_bf16_f32 v189, v78, v79
    v_cvt_pk_bf16_f32 v190, v108, v109
    v_cvt_pk_bf16_f32 v191, v110, v111
    global_store_dwordx4 v195, v[188:191], s[34:35] offset:3072 sc1
    s_lshl_b32 s70, s62, 1
    s_and_b32 s71, s65, 1
    s_add_u32 s70, s70, s71
    s_lshl_b32 s71, s64, 1
    s_lshr_b32 s72, s65, 1
    s_add_u32 s71, s71, s72
    s_lshl_b32 s70, s70, 5
    s_add_u32 s70, s70, s71
    s_lshl_b32 s70, s70, 7
    s_add_u32 s73, s70, 12582912
    s_and_b32 s74, s65, 1
    s_mul_i32 s74, s74, 3
    s_add_u32 s74, s74, s23
    s_and_b32 s75, s65, 2
    s_lshl_b32 s70, s74, 4
    v_and_b32 v196, 15, v254
    v_add_u32 v196, s70, v196
    v_lshrrev_b32 v197, 4, v254
    s_lshl_b32 s71, s75, 4
    s_add_u32 s71, s71, s68
    v_lshl_add_u32 v197, v197, 2, s71
    v_mul_u32_u24 v198, 640, v196
    v_add_u32 v198, v198, v197
    v_lshlrev_b32 v199, 2, v198
    v_lshlrev_b32 v198, 1, v198
    v_lshlrev_b32 v197, 1, v197
    v_lshlrev_b32 v200, 3, v196
    v_add_u32 v200, 16384, v200
    s_and_b32 s70, s65, 1
    s_mul_i32 s70, s70, 48
    v_and_b32 v196, 15, v254
    v_add_u32 v196, s70, v196
    v_lshrrev_b32 v197, 4, v254
    v_lshlrev_b32 v197, 3, v197
    s_lshl_b32 s70, s75, 5
    s_add_u32 s70, s70, 131072
    v_add_u32 v197, s70, v197
    v_lshl_add_u32 v198, v196, 7, v197
    v_lshlrev_b32 v196, 2, v196
    v_add_u32 v196, 144384, v196
    ds_read_b64 v[128:129], v198 offset:0
    ds_read_b64 v[130:131], v198 offset:32
    ds_read_b32 v140, v196 offset:0
    ds_read_b64 v[132:133], v198 offset:2048
    ds_read_b64 v[134:135], v198 offset:2080
    ds_read_b32 v142, v196 offset:64
    ds_read_b64 v[136:137], v198 offset:4096
    ds_read_b64 v[138:139], v198 offset:4128
    ds_read_b32 v144, v196 offset:128
    ds_read_b64 v[148:149], v197 offset:12288
    ds_read_b64 v[152:153], v197 offset:12320
    v_lshrrev_b32 v196, 4, v254
    v_bfe_u32 v197, v254, 2, 2
    v_lshl_add_u32 v197, v196, 2, v197
    v_bfe_u32 v201, v197, 1, 2
    s_lshl_b32 s70, s75, 5
    v_add_u32 v197, s70, v197
    v_lshlrev_b32 v197, 7, v197
    v_and_b32 v198, 3, v254
    v_lshl_add_u32 v197, v198, 3, v197
    v_and_b32 v198, 1, v196
    s_lshl_b32 s70, s75, 1
    v_add_u32 v198, s70, v198
    v_bfe_u32 v202, v254, 1, 3
    v_xor_b32 v198, v198, v202
    v_lshrrev_b32 v196, 1, v196
    v_lshlrev_b32 v196, 13, v196
    v_lshl_add_u32 v196, v198, 4, v196
    v_and_b32 v202, 15, v254
    v_lshl_add_u32 v196, v202, 7, v196
    s_xor_b32 s70, s75, 0
    v_xor_b32 v198, s70, v201
    v_lshl_add_u32 v204, v198, 5, v197
    s_lshl_b32 s70, s70, 11
    v_add_u32 v208, s70, v196
    s_xor_b32 s70, s75, 1
    v_xor_b32 v198, s70, v201
    v_lshl_add_u32 v205, v198, 5, v197
    s_lshl_b32 s70, s70, 11
    v_add_u32 v209, s70, v196
    s_xor_b32 s70, s75, 2
    v_xor_b32 v198, s70, v201
    v_lshl_add_u32 v206, v198, 5, v197
    s_lshl_b32 s70, s70, 11
    v_add_u32 v210, s70, v196
    s_xor_b32 s70, s75, 3
    v_xor_b32 v198, s70, v201
    v_lshl_add_u32 v207, v198, 5, v197
    s_lshl_b32 s70, s70, 11
    v_add_u32 v211, s70, v196
    v_lshlrev_b32 v196, 4, v254
    s_lshl_b32 s71, s67, 2
    s_sub_u32 s71, s74, s71
    s_add_u32 s70, s71, 0
    s_lshr_b32 s72, s70, 2
    s_mul_i32 s72, s72, 348
    s_add_u32 s70, s70, s72
    s_lshl_b32 s70, s70, 10
    v_add_u32 v220, s70, v196
    s_add_u32 s70, s71, 1
    s_lshr_b32 s72, s70, 2
    s_mul_i32 s72, s72, 348
    s_add_u32 s70, s70, s72
    s_lshl_b32 s70, s70, 10
    v_add_u32 v221, s70, v196
    s_add_u32 s70, s71, 2
    s_lshr_b32 s72, s70, 2
    s_mul_i32 s72, s72, 348
    s_add_u32 s70, s70, s72
    s_lshl_b32 s70, s70, 10
    v_add_u32 v222, s70, v196
    s_mul_i32 s70, s67, 360448
    s_lshl_b32 s71, s75, 12
    s_add_u32 s70, s70, s71
    s_add_u32 s70, s70, 1048576
    s_add_u32 s56, s34, s70
    s_addc_u32 s57, s35, 0
    s_mov_b32 s58, 712704
    s_mov_b32 s59, 0x20000
    s_lshl_b32 s100, s98, 14
    s_lshl_b32 s70, s67, 12
    s_add_u32 s70, s70, 12582912
    v_and_b32 v248, 63, v254
    v_lshlrev_b32 v248, 7, v248
    v_add_u32 v248, s70, v248
    s_lshr_b32 s71, s65, 1
    s_lshl_b32 s71, 0x555555, s71
    v_lshlrev_b32 v196, 17, v254
    v_add_u32 v196, s73, v196
    v_mov_b32 v197, s66
    s_mov_b32 s87, 0
    s_waitcnt vmcnt(0)
    s_mov_b64 exec, 1
    global_store_dword v196, v197, s[34:35] sc1
    s_mov_b64 exec, -1
    s_waitcnt lgkmcnt(0)
    v_mov_b32 v250, s3
    ds_write_b32 v253, v250 offset:84
    s_branch L_st_19
    s_waitcnt vmcnt(1)
L_st_18:
    s_mov_b64 s[88:89], 0
    v_cmp_ne_u32 vcc, s66, v141
    s_nop 1
    s_or_b64 s[88:89], s[88:89], vcc
    v_cmp_ne_u32 vcc, s66, v143
    s_nop 1
    s_or_b64 s[88:89], s[88:89], vcc
    v_cmp_ne_u32 vcc, s66, v145
    s_nop 1
    s_or_b64 s[88:89], s[88:89], vcc
    s_cmp_eq_u64 s[88:89], 0
    s_cbranch_scc1 L_st_19
    global_load_dwordx2 v[140:141], v200, s[34:35] offset:0 sc1
    global_load_dwordx2 v[142:143], v200, s[34:35] offset:128 sc1
    global_load_dwordx2 v[144:145], v200, s[34:35] offset:256 sc1
    s_waitcnt vmcnt(0)
    s_sleep 1
    s_sub_u32 s94, s94, 1
    s_cmp_lg_u32 s94, 0
    s_cbranch_scc1 L_st_18
    s_mov_b32 s94, 1
L_st_19:
    v_and_b32 v151, 0xffff0000, v149
    v_lshlrev_b32 v150, 16, v149
    v_and_b32 v149, 0xffff0000, v148
    v_lshlrev_b32 v148, 16, v148
    v_and_b32 v155, 0xffff0000, v153
    v_lshlrev_b32 v154, 16, v153
    v_and_b32 v153, 0xffff0000, v152
    v_lshlrev_b32 v152, 16, v152
    v_and_b32 v141, 0xffff0000, v140
    v_lshlrev_b32 v140, 16, v140
    v_rcp_f32 v141, v141
    v_and_b32 v3, 0xffff0000, v129
    v_lshlrev_b32 v2, 16, v129
    v_and_b32 v1, 0xffff0000, v128
    v_lshlrev_b32 v0, 16, v128
    v_pk_add_f32 v[156:157], v[0:1], v[140:141] op_sel_hi:[1,0] neg_lo:[0,1] neg_hi:[0,1]
    v_pk_add_f32 v[158:159], v[2:3], v[140:141] op_sel_hi:[1,0] neg_lo:[0,1] neg_hi:[0,1]
    v_cvt_pk_bf16_f32 v160, v156, v157
    v_cvt_pk_bf16_f32 v161, v158, v159
    v_and_b32 v159, 0xffff0000, v161
    v_lshlrev_b32 v158, 16, v161
    v_and_b32 v157, 0xffff0000, v160
    v_lshlrev_b32 v156, 16, v160
    v_pk_mul_f32 v[156:157], v[156:157], v[140:141] op_sel:[0,1] op_sel_hi:[1,1]
    v_pk_mul_f32 v[158:159], v[158:159], v[140:141] op_sel:[0,1] op_sel_hi:[1,1]
    v_cvt_pk_bf16_f32 v160, v156, v157
    v_cvt_pk_bf16_f32 v161, v158, v159
    v_and_b32 v159, 0xffff0000, v161
    v_lshlrev_b32 v158, 16, v161
    v_and_b32 v157, 0xffff0000, v160
    v_lshlrev_b32 v156, 16, v160
    v_pk_mul_f32 v[156:157], v[156:157], v[148:149]
    v_pk_mul_f32 v[158:159], v[158:159], v[150:151]
    v_cvt_pk_bf16_f32 v160, v156, v157
    v_cvt_pk_bf16_f32 v161, v158, v159
    v_and_b32 v159, 0xffff0000, v161
    v_lshlrev_b32 v158, 16, v161
    v_and_b32 v157, 0xffff0000, v160
    v_lshlrev_b32 v156, 16, v160
    v_pk_add_f32 v[0:1], v[0:1], v[156:157]
    v_pk_add_f32 v[2:3], v[2:3], v[158:159]
    v_and_b32 v15, 0xffff0000, v131
    v_lshlrev_b32 v14, 16, v131
    v_and_b32 v13, 0xffff0000, v130
    v_lshlrev_b32 v12, 16, v130
    v_pk_add_f32 v[156:157], v[12:13], v[140:141] op_sel_hi:[1,0] neg_lo:[0,1] neg_hi:[0,1]
    v_pk_add_f32 v[158:159], v[14:15], v[140:141] op_sel_hi:[1,0] neg_lo:[0,1] neg_hi:[0,1]
    v_cvt_pk_bf16_f32 v160, v156, v157
    v_cvt_pk_bf16_f32 v161, v158, v159
    v_and_b32 v159, 0xffff0000, v161
    v_lshlrev_b32 v158, 16, v161
    v_and_b32 v157, 0xffff0000, v160
    v_lshlrev_b32 v156, 16, v160
    v_pk_mul_f32 v[156:157], v[156:157], v[140:141] op_sel:[0,1] op_sel_hi:[1,1]
    v_pk_mul_f32 v[158:159], v[158:159], v[140:141] op_sel:[0,1] op_sel_hi:[1,1]
    v_cvt_pk_bf16_f32 v160, v156, v157
    v_cvt_pk_bf16_f32 v161, v158, v159
    v_and_b32 v159, 0xffff0000, v161
    v_lshlrev_b32 v158, 16, v161
    v_and_b32 v157, 0xffff0000, v160
    v_lshlrev_b32 v156, 16, v160
    v_pk_mul_f32 v[156:157], v[156:157], v[152:153]
    v_pk_mul_f32 v[158:159], v[158:159], v[154:155]
    v_cvt_pk_bf16_f32 v160, v156, v157
    v_cvt_pk_bf16_f32 v161, v158, v159
    v_and_b32 v159, 0xffff0000, v161
    v_lshlrev_b32 v158, 16, v161
    v_and_b32 v157, 0xffff0000, v160
    v_lshlrev_b32 v156, 16, v160
    v_pk_add_f32 v[12:13], v[12:13], v[156:157]
    v_pk_add_f32 v[14:15], v[14:15], v[158:159]
    v_and_b32 v143, 0xffff0000, v142
    v_lshlrev_b32 v142, 16, v142
    v_rcp_f32 v143, v143
    v_and_b32 v7, 0xffff0000, v133
    v_lshlrev_b32 v6, 16, v133
    v_and_b32 v5, 0xffff0000, v132
    v_lshlrev_b32 v4, 16, v132
    v_pk_add_f32 v[156:157], v[4:5], v[142:143] op_sel_hi:[1,0] neg_lo:[0,1] neg_hi:[0,1]
    v_pk_add_f32 v[158:159], v[6:7], v[142:143] op_sel_hi:[1,0] neg_lo:[0,1] neg_hi:[0,1]
    v_cvt_pk_bf16_f32 v160, v156, v157
    v_cvt_pk_bf16_f32 v161, v158, v159
    v_and_b32 v159, 0xffff0000, v161
    v_lshlrev_b32 v158, 16, v161
    v_and_b32 v157, 0xffff0000, v160
    v_lshlrev_b32 v156, 16, v160
    v_pk_mul_f32 v[156:157], v[156:157], v[142:143] op_sel:[0,1] op_sel_hi:[1,1]
    v_pk_mul_f32 v[158:159], v[158:159], v[142:143] op_sel:[0,1] op_sel_hi:[1,1]
    v_cvt_pk_bf16_f32 v160, v156, v157
    v_cvt_pk_bf16_f32 v161, v158, v159
    v_and_b32 v159, 0xffff0000, v161
    v_lshlrev_b32 v158, 16, v161
    v_and_b32 v157, 0xffff0000, v160
    v_lshlrev_b32 v156, 16, v160
    v_pk_mul_f32 v[156:157], v[156:157], v[148:149]
    v_pk_mul_f32 v[158:159], v[158:159], v[150:151]
    v_cvt_pk_bf16_f32 v160, v156, v157
    v_cvt_pk_bf16_f32 v161, v158, v159
    v_and_b32 v159, 0xffff0000, v161
    v_lshlrev_b32 v158, 16, v161
    v_and_b32 v157, 0xffff0000, v160
    v_lshlrev_b32 v156, 16, v160
    v_pk_add_f32 v[4:5], v[4:5], v[156:157]
    v_pk_add_f32 v[6:7], v[6:7], v[158:159]
    v_and_b32 v19, 0xffff0000, v135
    v_lshlrev_b32 v18, 16, v135
    v_and_b32 v17, 0xffff0000, v134
    v_lshlrev_b32 v16, 16, v134
    v_pk_add_f32 v[156:157], v[16:17], v[142:143] op_sel_hi:[1,0] neg_lo:[0,1] neg_hi:[0,1]
    v_pk_add_f32 v[158:159], v[18:19], v[142:143] op_sel_hi:[1,0] neg_lo:[0,1] neg_hi:[0,1]
    v_cvt_pk_bf16_f32 v160, v156, v157
    v_cvt_pk_bf16_f32 v161, v158, v159
    v_and_b32 v159, 0xffff0000, v161
    v_lshlrev_b32 v158, 16, v161
    v_and_b32 v157, 0xffff0000, v160
    v_lshlrev_b32 v156, 16, v160
    v_pk_mul_f32 v[156:157], v[156:157], v[142:143] op_sel:[0,1] op_sel_hi:[1,1]
    v_pk_mul_f32 v[158:159], v[158:159], v[142:143] op_sel:[0,1] op_sel_hi:[1,1]
    v_cvt_pk_bf16_f32 v160, v156, v157
    v_cvt_pk_bf16_f32 v161, v158, v159
    v_and_b32 v159, 0xffff0000, v161
    v_lshlrev_b32 v158, 16, v161
    v_and_b32 v157, 0xffff0000, v160
    v_lshlrev_b32 v156, 16, v160
    v_pk_mul_f32 v[156:157], v[156:157], v[152:153]
    v_pk_mul_f32 v[158:159], v[158:159], v[154:155]
    v_cvt_pk_bf16_f32 v160, v156, v157
    v_cvt_pk_bf16_f32 v161, v158, v159
    v_and_b32 v159, 0xffff0000, v161
    v_lshlrev_b32 v158, 16, v161
    v_and_b32 v157, 0xffff0000, v160
    v_lshlrev_b32 v156, 16, v160
    v_pk_add_f32 v[16:17], v[16:17], v[156:157]
    v_pk_add_f32 v[18:19], v[18:19], v[158:159]
    v_and_b32 v145, 0xffff0000, v144
    v_lshlrev_b32 v144, 16, v144
    v_rcp_f32 v145, v145
    v_and_b32 v11, 0xffff0000, v137
    v_lshlrev_b32 v10, 16, v137
    v_and_b32 v9, 0xffff0000, v136
    v_lshlrev_b32 v8, 16, v136
    v_pk_add_f32 v[156:157], v[8:9], v[144:145] op_sel_hi:[1,0] neg_lo:[0,1] neg_hi:[0,1]
    v_pk_add_f32 v[158:159], v[10:11], v[144:145] op_sel_hi:[1,0] neg_lo:[0,1] neg_hi:[0,1]
    v_cvt_pk_bf16_f32 v160, v156, v157
    v_cvt_pk_bf16_f32 v161, v158, v159
    v_and_b32 v159, 0xffff0000, v161
    v_lshlrev_b32 v158, 16, v161
    v_and_b32 v157, 0xffff0000, v160
    v_lshlrev_b32 v156, 16, v160
    v_pk_mul_f32 v[156:157], v[156:157], v[144:145] op_sel:[0,1] op_sel_hi:[1,1]
    v_pk_mul_f32 v[158:159], v[158:159], v[144:145] op_sel:[0,1] op_sel_hi:[1,1]
    v_cvt_pk_bf16_f32 v160, v156, v157
    v_cvt_pk_bf16_f32 v161, v158, v159
    v_and_b32 v159, 0xffff0000, v161
    v_lshlrev_b32 v158, 16, v161
    v_and_b32 v157, 0xffff0000, v160
    v_lshlrev_b32 v156, 16, v160
    v_pk_mul_f32 v[156:157], v[156:157], v[148:149]
    v_pk_mul_f32 v[158:159], v[158:159], v[150:151]
    v_cvt_pk_bf16_f32 v160, v156, v157
    v_cvt_pk_bf16_f32 v161, v158, v159
    v_and_b32 v159, 0xffff0000, v161
    v_lshlrev_b32 v158, 16, v161
    v_and_b32 v157, 0xffff0000, v160
    v_lshlrev_b32 v156, 16, v160
    v_pk_add_f32 v[8:9], v[8:9], v[156:157]
    v_pk_add_f32 v[10:11], v[10:11], v[158:159]
    v_and_b32 v23, 0xffff0000, v139
    v_lshlrev_b32 v22, 16, v139
    v_and_b32 v21, 0xffff0000, v138
    v_lshlrev_b32 v20, 16, v138
    v_pk_add_f32 v[156:157], v[20:21], v[144:145] op_sel_hi:[1,0] neg_lo:[0,1] neg_hi:[0,1]
    v_pk_add_f32 v[158:159], v[22:23], v[144:145] op_sel_hi:[1,0] neg_lo:[0,1] neg_hi:[0,1]
    v_cvt_pk_bf16_f32 v160, v156, v157
    v_cvt_pk_bf16_f32 v161, v158, v159
    v_and_b32 v159, 0xffff0000, v161
    v_lshlrev_b32 v158, 16, v161
    v_and_b32 v157, 0xffff0000, v160
    v_lshlrev_b32 v156, 16, v160
    v_pk_mul_f32 v[156:157], v[156:157], v[144:145] op_sel:[0,1] op_sel_hi:[1,1]
    v_pk_mul_f32 v[158:159], v[158:159], v[144:145] op_sel:[0,1] op_sel_hi:[1,1]
    v_cvt_pk_bf16_f32 v160, v156, v157
    v_cvt_pk_bf16_f32 v161, v158, v159
    v_and_b32 v159, 0xffff0000, v161
    v_lshlrev_b32 v158, 16, v161
    v_and_b32 v157, 0xffff0000, v160
    v_lshlrev_b32 v156, 16, v160
    v_pk_mul_f32 v[156:157], v[156:157], v[152:153]
    v_pk_mul_f32 v[158:159], v[158:159], v[154:155]
    v_cvt_pk_bf16_f32 v160, v156, v157
    v_cvt_pk_bf16_f32 v161, v158, v159
    v_and_b32 v159, 0xffff0000, v161
    v_lshlrev_b32 v158, 16, v161
    v_and_b32 v157, 0xffff0000, v160
    v_lshlrev_b32 v156, 16, v160
    v_pk_add_f32 v[20:21], v[20:21], v[156:157]
    v_pk_add_f32 v[22:23], v[22:23], v[158:159]
    v_mov_b32 v251, 162816
    s_cmp_lg_u32 s65, 0
    s_cbranch_scc1 L_go_20
    s_mov_b32 s71, 0xffffff
    s_mov_b32 exec_lo, s71
    s_mov_b32 exec_hi, s71
L_fl_16:
    global_load_dword v223, v248, s[34:35] sc1
    s_waitcnt vmcnt(0)
    v_cmp_ne_u32 vcc, s66, v223
    s_cbranch_vccz L_fl_17
    s_sleep 1
    s_sub_u32 s94, s94, 1
    s_cmp_lg_u32 s94, 0
    s_cbranch_scc1 L_fl_16
    s_mov_b32 s94, 1
L_fl_17:
    s_mov_b64 exec, 1
    ds_write_b32 v251, v251
    s_branch L_go_20x
L_go_20:
    ds_read_b32 v223, v251
    s_waitcnt lgkmcnt(0)
    v_cmp_eq_u32 vcc, 0, v223
    s_cbranch_vccz L_go_20x
    s_sleep 1
    s_sub_u32 s94, s94, 1
    s_cmp_lg_u32 s94, 0
    s_cbranch_scc1 L_go_20
    s_mov_b32 s94, 1
L_go_20x:
    s_mov_b64 exec, -1
    s_add_u32 s74, s100, 4096
    v_lshlrev_b32 v248, 4, v254
    v_add_u32 v248, 161792, v248
    v_and_b32 v249, 3, v254
    v_lshlrev_b32 v249, 9, v249
    v_add_u32 v249, 157948, v249
    buffer_load_dwordx4 v[112:115], v220, s[56:59], s100 offen sc1
    buffer_load_dwordx4 v[116:119], v221, s[56:59], s100 offen sc1
    buffer_load_dwordx4 v[120:123], v222, s[56:59], s100 offen sc1
    buffer_load_dwordx4 v[124:127], v220, s[56:59], s74 offen sc1
    buffer_load_dwordx4 v[128:131], v221, s[56:59], s74 offen sc1
    buffer_load_dwordx4 v[132:135], v222, s[56:59], s74 offen sc1
    s_add_u32 s100, s100, 16384
    s_cmp_eq_u32 s100, 196608
    s_cselect_b32 s100, 0, s100
    s_add_u32 s74, s100, 4096
    buffer_load_dwordx4 v[136:139], v220, s[56:59], s100 offen sc1
    buffer_load_dwordx4 v[140:143], v221, s[56:59], s100 offen sc1
    buffer_load_dwordx4 v[144:147], v222, s[56:59], s100 offen sc1
    buffer_load_dwordx4 v[148:151], v220, s[56:59], s74 offen sc1
    buffer_load_dwordx4 v[152:155], v221, s[56:59], s74 offen sc1
    buffer_load_dwordx4 v[156:159], v222, s[56:59], s74 offen sc1
    s_add_u32 s100, s100, 16384
    s_cmp_eq_u32 s100, 196608
    s_cselect_b32 s100, 0, s100
    s_add_u32 s74, s100, 4096
    v_mov_b32 v250, s3
    ds_read_b32 v251, v249 offset:88
    s_waitcnt lgkmcnt(0)
    v_cmp_ne_u32 vcc, s3, v251
    s_cbranch_vccnz L_sw_21
L_bk_22:
    v_add_u32 v212, 0, v204
    v_add_u32 v213, 0, v205
    v_add_u32 v214, 0, v206
    v_add_u32 v215, 0, v207
    ds_read_b64_tr_b16 v[48:49], v212 offset:0
    ds_read_b64_tr_b16 v[50:51], v212 offset:2048
    ds_read_b64_tr_b16 v[52:53], v213 offset:0
    ds_read_b64_tr_b16 v[54:55], v213 offset:2048
    ds_read_b64_tr_b16 v[56:57], v214 offset:0
    ds_read_b64_tr_b16 v[58:59], v214 offset:2048
    ds_read_b64_tr_b16 v[60:61], v215 offset:0
    ds_read_b64_tr_b16 v[62:63], v215 offset:2048
    ds_read_b64_tr_b16 v[64:65], v212 offset:4096
    ds_read_b64_tr_b16 v[66:67], v212 offset:6144
    ds_read_b64_tr_b16 v[68:69], v213 offset:4096
    ds_read_b64_tr_b16 v[70:71], v213 offset:6144
    ds_read_b64_tr_b16 v[72:73], v214 offset:4096
    ds_read_b64_tr_b16 v[74:75], v214 offset:6144
    ds_read_b64_tr_b16 v[76:77], v215 offset:4096
    ds_read_b64_tr_b16 v[78:79], v215 offset:6144
    ds_read_b32 v251, v249 offset:92
    s_waitcnt lgkmcnt(0)
    s_waitcnt vmcnt(6)
    v_mfma_f32_16x16x32_bf16 v[0:3], v[48:51], v[112:115], v[0:3]
    v_cmp_ne_u32 vcc, s3, v251
    v_add_u32 v212, 16384, v204
    v_mfma_f32_16x16x32_bf16 v[4:7], v[48:51], v[116:119], v[4:7]
    v_add_u32 v213, 16384, v205
    v_add_u32 v214, 16384, v206
    v_mfma_f32_16x16x32_bf16 v[8:11], v[48:51], v[120:123], v[8:11]
    s_cbranch_vccnz L_sw_26
L_bk_27:
    v_add_u32 v215, 16384, v207
    v_mfma_f32_16x16x32_bf16 v[12:15], v[52:55], v[112:115], v[12:15]
    ds_read_b64_tr_b16 v[80:81], v212 offset:0
    ds_read_b64_tr_b16 v[82:83], v212 offset:2048
    v_mfma_f32_16x16x32_bf16 v[16:19], v[52:55], v[116:119], v[16:19]
    ds_read_b64_tr_b16 v[84:85], v213 offset:0
    ds_read_b64_tr_b16 v[86:87], v213 offset:2048
    v_mfma_f32_16x16x32_bf16 v[20:23], v[52:55], v[120:123], v[20:23]
    ds_read_b64_tr_b16 v[88:89], v214 offset:0
    ds_read_b64_tr_b16 v[90:91], v214 offset:2048
    v_mfma_f32_16x16x32_bf16 v[24:27], v[56:59], v[112:115], 0
    ds_read_b64_tr_b16 v[92:93], v215 offset:0
    ds_read_b64_tr_b16 v[94:95], v215 offset:2048
    v_mfma_f32_16x16x32_bf16 v[28:31], v[56:59], v[116:119], 0
    ds_read_b64_tr_b16 v[96:97], v212 offset:4096
    ds_read_b64_tr_b16 v[98:99], v212 offset:6144
    v_mfma_f32_16x16x32_bf16 v[32:35], v[56:59], v[120:123], 0
    ds_read_b64_tr_b16 v[100:101], v213 offset:4096
    ds_read_b64_tr_b16 v[102:103], v213 offset:6144
    v_mfma_f32_16x16x32_bf16 v[36:39], v[60:63], v[112:115], 0
    ds_read_b64_tr_b16 v[104:105], v214 offset:4096
    ds_read_b64_tr_b16 v[106:107], v214 offset:6144
    v_mfma_f32_16x16x32_bf16 v[40:43], v[60:63], v[116:119], 0
    ds_read_b64_tr_b16 v[108:109], v215 offset:4096
    ds_read_b64_tr_b16 v[110:111], v215 offset:6144
    v_mfma_f32_16x16x32_bf16 v[44:47], v[60:63], v[120:123], 0
    ds_read_b32 v251, v249 offset:96
    v_mfma_f32_16x16x32_bf16 v[0:3], v[64:67], v[124:127], v[0:3]
    ds_write_b32 v253, v250 offset:88
    buffer_load_dwordx4 v[160:163], v220, s[56:59], s100 offen sc1
    v_mfma_f32_16x16x32_bf16 v[4:7], v[64:67], v[128:131], v[4:7]
    v_mfma_f32_16x16x32_bf16 v[8:11], v[64:67], v[132:135], v[8:11]
    buffer_load_dwordx4 v[164:167], v221, s[56:59], s100 offen sc1
    v_mfma_f32_16x16x32_bf16 v[12:15], v[68:71], v[124:127], v[12:15]
    v_mfma_f32_16x16x32_bf16 v[16:19], v[68:71], v[128:131], v[16:19]
    buffer_load_dwordx4 v[168:171], v222, s[56:59], s100 offen sc1
    v_mfma_f32_16x16x32_bf16 v[20:23], v[68:71], v[132:135], v[20:23]
    v_mfma_f32_16x16x32_bf16 v[24:27], v[72:75], v[124:127], v[24:27]
    buffer_load_dwordx4 v[172:175], v220, s[56:59], s74 offen sc1
    v_mfma_f32_16x16x32_bf16 v[28:31], v[72:75], v[128:131], v[28:31]
    v_mfma_f32_16x16x32_bf16 v[32:35], v[72:75], v[132:135], v[32:35]
    buffer_load_dwordx4 v[176:179], v221, s[56:59], s74 offen sc1
    v_mfma_f32_16x16x32_bf16 v[36:39], v[76:79], v[124:127], v[36:39]
    v_mfma_f32_16x16x32_bf16 v[40:43], v[76:79], v[128:131], v[40:43]
    buffer_load_dwordx4 v[180:183], v222, s[56:59], s74 offen sc1
    s_add_u32 s100, s100, 16384
    s_cmp_eq_u32 s100, 196608
    s_cselect_b32 s100, 0, s100
    s_add_u32 s74, s100, 4096
    v_mfma_f32_16x16x32_bf16 v[44:47], v[76:79], v[132:135], v[44:47]
    s_waitcnt lgkmcnt(1)
    s_waitcnt vmcnt(6)
    v_mfma_f32_16x16x32_bf16 v[0:3], v[80:83], v[136:139], v[0:3]
    v_cmp_ne_u32 vcc, s3, v251
    v_add_u32 v212, 32768, v204
    v_mfma_f32_16x16x32_bf16 v[4:7], v[80:83], v[140:143], v[4:7]
    v_add_u32 v213, 32768, v205
    v_add_u32 v214, 32768, v206
    v_mfma_f32_16x16x32_bf16 v[8:11], v[80:83], v[144:147], v[8:11]
    s_cbranch_vccnz L_sw_29
L_bk_30:
    v_add_u32 v215, 32768, v207
    v_mfma_f32_16x16x32_bf16 v[12:15], v[84:87], v[136:139], v[12:15]
    ds_read_b64_tr_b16 v[48:49], v212 offset:0
    ds_read_b64_tr_b16 v[50:51], v212 offset:2048
    v_mfma_f32_16x16x32_bf16 v[16:19], v[84:87], v[140:143], v[16:19]
    ds_read_b64_tr_b16 v[52:53], v213 offset:0
    ds_read_b64_tr_b16 v[54:55], v213 offset:2048
    v_mfma_f32_16x16x32_bf16 v[20:23], v[84:87], v[144:147], v[20:23]
    ds_read_b64_tr_b16 v[56:57], v214 offset:0
    ds_read_b64_tr_b16 v[58:59], v214 offset:2048
    v_mfma_f32_16x16x32_bf16 v[24:27], v[88:91], v[136:139], v[24:27]
    ds_read_b64_tr_b16 v[60:61], v215 offset:0
    ds_read_b64_tr_b16 v[62:63], v215 offset:2048
    v_mfma_f32_16x16x32_bf16 v[28:31], v[88:91], v[140:143], v[28:31]
    ds_read_b64_tr_b16 v[64:65], v212 offset:4096
    ds_read_b64_tr_b16 v[66:67], v212 offset:6144
    v_mfma_f32_16x16x32_bf16 v[32:35], v[88:91], v[144:147], v[32:35]
    ds_read_b64_tr_b16 v[68:69], v213 offset:4096
    ds_read_b64_tr_b16 v[70:71], v213 offset:6144
    v_mfma_f32_16x16x32_bf16 v[36:39], v[92:95], v[136:139], v[36:39]
    ds_read_b64_tr_b16 v[72:73], v214 offset:4096
    ds_read_b64_tr_b16 v[74:75], v214 offset:6144
    v_mfma_f32_16x16x32_bf16 v[40:43], v[92:95], v[140:143], v[40:43]
    ds_read_b64_tr_b16 v[76:77], v215 offset:4096
    ds_read_b64_tr_b16 v[78:79], v215 offset:6144
    v_mfma_f32_16x16x32_bf16 v[44:47], v[92:95], v[144:147], v[44:47]
    ds_read_b32 v251, v249 offset:100
    v_mfma_f32_16x16x32_bf16 v[0:3], v[96:99], v[148:151], v[0:3]
    ds_write_b32 v253, v250 offset:92
    buffer_load_dwordx4 v[112:115], v220, s[56:59], s100 offen sc1
    v_mfma_f32_16x16x32_bf16 v[4:7], v[96:99], v[152:155], v[4:7]
    v_mfma_f32_16x16x32_bf16 v[8:11], v[96:99], v[156:159], v[8:11]
    buffer_load_dwordx4 v[116:119], v221, s[56:59], s100 offen sc1
    v_mfma_f32_16x16x32_bf16 v[12:15], v[100:103], v[148:151], v[12:15]
    v_mfma_f32_16x16x32_bf16 v[16:19], v[100:103], v[152:155], v[16:19]
    buffer_load_dwordx4 v[120:123], v222, s[56:59], s100 offen sc1
    v_mfma_f32_16x16x32_bf16 v[20:23], v[100:103], v[156:159], v[20:23]
    v_mfma_f32_16x16x32_bf16 v[24:27], v[104:107], v[148:151], v[24:27]
    buffer_load_dwordx4 v[124:127], v220, s[56:59], s74 offen sc1
    v_mfma_f32_16x16x32_bf16 v[28:31], v[104:107], v[152:155], v[28:31]
    v_mfma_f32_16x16x32_bf16 v[32:35], v[104:107], v[156:159], v[32:35]
    buffer_load_dwordx4 v[128:131], v221, s[56:59], s74 offen sc1
    v_mfma_f32_16x16x32_bf16 v[36:39], v[108:111], v[148:151], v[36:39]
    v_mfma_f32_16x16x32_bf16 v[40:43], v[108:111], v[152:155], v[40:43]
    buffer_load_dwordx4 v[132:135], v222, s[56:59], s74 offen sc1
    s_add_u32 s100, s100, 16384
    s_cmp_eq_u32 s100, 196608
    s_cselect_b32 s100, 0, s100
    s_add_u32 s74, s100, 4096
    v_mfma_f32_16x16x32_bf16 v[44:47], v[108:111], v[156:159], v[44:47]
    s_waitcnt lgkmcnt(1)
    s_waitcnt vmcnt(6)
    v_mfma_f32_16x16x32_bf16 v[0:3], v[48:51], v[160:163], v[0:3]
    v_cmp_ne_u32 vcc, s3, v251
    v_add_u32 v212, 49152, v204
    v_mfma_f32_16x16x32_bf16 v[4:7], v[48:51], v[164:167], v[4:7]
    v_add_u32 v213, 49152, v205
    v_add_u32 v214, 49152, v206
    v_mfma_f32_16x16x32_bf16 v[8:11], v[48:51], v[168:171], v[8:11]
    s_cbranch_vccnz L_sw_32
L_bk_33:
    v_add_u32 v215, 49152, v207
    v_mfma_f32_16x16x32_bf16 v[12:15], v[52:55], v[160:163], v[12:15]
    ds_read_b64_tr_b16 v[80:81], v212 offset:0
    ds_read_b64_tr_b16 v[82:83], v212 offset:2048
    v_mfma_f32_16x16x32_bf16 v[16:19], v[52:55], v[164:167], v[16:19]
    ds_read_b64_tr_b16 v[84:85], v213 offset:0
    ds_read_b64_tr_b16 v[86:87], v213 offset:2048
    v_mfma_f32_16x16x32_bf16 v[20:23], v[52:55], v[168:171], v[20:23]
    ds_read_b64_tr_b16 v[88:89], v214 offset:0
    ds_read_b64_tr_b16 v[90:91], v214 offset:2048
    v_mfma_f32_16x16x32_bf16 v[24:27], v[56:59], v[160:163], v[24:27]
    ds_read_b64_tr_b16 v[92:93], v215 offset:0
    ds_read_b64_tr_b16 v[94:95], v215 offset:2048
    v_mfma_f32_16x16x32_bf16 v[28:31], v[56:59], v[164:167], v[28:31]
    ds_read_b64_tr_b16 v[96:97], v212 offset:4096
    ds_read_b64_tr_b16 v[98:99], v212 offset:6144
    v_mfma_f32_16x16x32_bf16 v[32:35], v[56:59], v[168:171], v[32:35]
    ds_read_b64_tr_b16 v[100:101], v213 offset:4096
    ds_read_b64_tr_b16 v[102:103], v213 offset:6144
    v_mfma_f32_16x16x32_bf16 v[36:39], v[60:63], v[160:163], v[36:39]
    ds_read_b64_tr_b16 v[104:105], v214 offset:4096
    ds_read_b64_tr_b16 v[106:107], v214 offset:6144
    v_mfma_f32_16x16x32_bf16 v[40:43], v[60:63], v[164:167], v[40:43]
    ds_read_b64_tr_b16 v[108:109], v215 offset:4096
    ds_read_b64_tr_b16 v[110:111], v215 offset:6144
    v_mfma_f32_16x16x32_bf16 v[44:47], v[60:63], v[168:171], v[44:47]
    ds_read_b32 v251, v249 offset:104
    v_mfma_f32_16x16x32_bf16 v[0:3], v[64:67], v[172:175], v[0:3]
    ds_write_b32 v253, v250 offset:96
    buffer_load_dwordx4 v[136:139], v220, s[56:59], s100 offen sc1
    v_mfma_f32_16x16x32_bf16 v[4:7], v[64:67], v[176:179], v[4:7]
    v_mfma_f32_16x16x32_bf16 v[8:11], v[64:67], v[180:183], v[8:11]
    buffer_load_dwordx4 v[140:143], v221, s[56:59], s100 offen sc1
    v_mfma_f32_16x16x32_bf16 v[12:15], v[68:71], v[172:175], v[12:15]
    v_mfma_f32_16x16x32_bf16 v[16:19], v[68:71], v[176:179], v[16:19]
    buffer_load_dwordx4 v[144:147], v222, s[56:59], s100 offen sc1
    v_mfma_f32_16x16x32_bf16 v[20:23], v[68:71], v[180:183], v[20:23]
    v_mfma_f32_16x16x32_bf16 v[24:27], v[72:75], v[172:175], v[24:27]
    buffer_load_dwordx4 v[148:151], v220, s[56:59], s74 offen sc1
    v_mfma_f32_16x16x32_bf16 v[28:31], v[72:75], v[176:179], v[28:31]
    v_mfma_f32_16x16x32_bf16 v[32:35], v[72:75], v[180:183], v[32:35]
    buffer_load_dwordx4 v[152:155], v221, s[56:59], s74 offen sc1
    v_mfma_f32_16x16x32_bf16 v[36:39], v[76:79], v[172:175], v[36:39]
    v_mfma_f32_16x16x32_bf16 v[40:43], v[76:79], v[176:179], v[40:43]
    buffer_load_dwordx4 v[156:159], v222, s[56:59], s74 offen sc1
    s_add_u32 s100, s100, 16384
    s_cmp_eq_u32 s100, 196608
    s_cselect_b32 s100, 0, s100
    s_add_u32 s74, s100, 4096
    v_mfma_f32_16x16x32_bf16 v[44:47], v[76:79], v[180:183], v[44:47]
    s_waitcnt lgkmcnt(1)
    s_waitcnt vmcnt(6)
    v_mfma_f32_16x16x32_bf16 v[0:3], v[80:83], v[112:115], v[0:3]
    v_cmp_ne_u32 vcc, s3, v251
    v_add_u32 v212, 65536, v204
    v_mfma_f32_16x16x32_bf16 v[4:7], v[80:83], v[116:119], v[4:7]
    v_add_u32 v213, 65536, v205
    v_add_u32 v214, 65536, v206
    v_mfma_f32_16x16x32_bf16 v[8:11], v[80:83], v[120:123], v[8:11]
    s_cbranch_vccnz L_sw_35
L_bk_36:
    v_add_u32 v215, 65536, v207
    v_mfma_f32_16x16x32_bf16 v[12:15], v[84:87], v[112:115], v[12:15]
    ds_read_b64_tr_b16 v[48:49], v212 offset:0
    ds_read_b64_tr_b16 v[50:51], v212 offset:2048
    v_mfma_f32_16x16x32_bf16 v[16:19], v[84:87], v[116:119], v[16:19]
    ds_read_b64_tr_b16 v[52:53], v213 offset:0
    ds_read_b64_tr_b16 v[54:55], v213 offset:2048
    v_mfma_f32_16x16x32_bf16 v[20:23], v[84:87], v[120:123], v[20:23]
    ds_read_b64_tr_b16 v[56:57], v214 offset:0
    ds_read_b64_tr_b16 v[58:59], v214 offset:2048
    v_mfma_f32_16x16x32_bf16 v[24:27], v[88:91], v[112:115], v[24:27]
    ds_read_b64_tr_b16 v[60:61], v215 offset:0
    ds_read_b64_tr_b16 v[62:63], v215 offset:2048
    v_mfma_f32_16x16x32_bf16 v[28:31], v[88:91], v[116:119], v[28:31]
    ds_read_b64_tr_b16 v[64:65], v212 offset:4096
    ds_read_b64_tr_b16 v[66:67], v212 offset:6144
    v_mfma_f32_16x16x32_bf16 v[32:35], v[88:91], v[120:123], v[32:35]
    ds_read_b64_tr_b16 v[68:69], v213 offset:4096
    ds_read_b64_tr_b16 v[70:71], v213 offset:6144
    v_mfma_f32_16x16x32_bf16 v[36:39], v[92:95], v[112:115], v[36:39]
    ds_read_b64_tr_b16 v[72:73], v214 offset:4096
    ds_read_b64_tr_b16 v[74:75], v214 offset:6144
    v_mfma_f32_16x16x32_bf16 v[40:43], v[92:95], v[116:119], v[40:43]
    ds_read_b64_tr_b16 v[76:77], v215 offset:4096
    ds_read_b64_tr_b16 v[78:79], v215 offset:6144
    v_mfma_f32_16x16x32_bf16 v[44:47], v[92:95], v[120:123], v[44:47]
    ds_read_b32 v251, v249 offset:108
    v_mfma_f32_16x16x32_bf16 v[0:3], v[96:99], v[124:127], v[0:3]
    ds_write_b32 v253, v250 offset:100
    buffer_load_dwordx4 v[160:163], v220, s[56:59], s100 offen sc1
    v_mfma_f32_16x16x32_bf16 v[4:7], v[96:99], v[128:131], v[4:7]
    v_mfma_f32_16x16x32_bf16 v[8:11], v[96:99], v[132:135], v[8:11]
    buffer_load_dwordx4 v[164:167], v221, s[56:59], s100 offen sc1
    v_mfma_f32_16x16x32_bf16 v[12:15], v[100:103], v[124:127], v[12:15]
    v_mfma_f32_16x16x32_bf16 v[16:19], v[100:103], v[128:131], v[16:19]
    buffer_load_dwordx4 v[168:171], v222, s[56:59], s100 offen sc1
    v_mfma_f32_16x16x32_bf16 v[20:23], v[100:103], v[132:135], v[20:23]
    v_mfma_f32_16x16x32_bf16 v[24:27], v[104:107], v[124:127], v[24:27]
    buffer_load_dwordx4 v[172:175], v220, s[56:59], s74 offen sc1
    v_mfma_f32_16x16x32_bf16 v[28:31], v[104:107], v[128:131], v[28:31]
    v_mfma_f32_16x16x32_bf16 v[32:35], v[104:107], v[132:135], v[32:35]
    buffer_load_dwordx4 v[176:179], v221, s[56:59], s74 offen sc1
    v_mfma_f32_16x16x32_bf16 v[36:39], v[108:111], v[124:127], v[36:39]
    v_mfma_f32_16x16x32_bf16 v[40:43], v[108:111], v[128:131], v[40:43]
    buffer_load_dwordx4 v[180:183], v222, s[56:59], s74 offen sc1
    s_add_u32 s100, s100, 16384
    s_cmp_eq_u32 s100, 196608
    s_cselect_b32 s100, 0, s100
    s_add_u32 s74, s100, 4096
    v_mfma_f32_16x16x32_bf16 v[44:47], v[108:111], v[132:135], v[44:47]
    s_waitcnt lgkmcnt(1)
    s_waitcnt vmcnt(6)
    v_mfma_f32_16x16x32_bf16 v[0:3], v[48:51], v[136:139], v[0:3]
    v_cmp_ne_u32 vcc, s3, v251
    v_add_u32 v212, 81920, v204
    v_mfma_f32_16x16x32_bf16 v[4:7], v[48:51], v[140:143], v[4:7]
    v_add_u32 v213, 81920, v205
    v_add_u32 v214, 81920, v206
    v_mfma_f32_16x16x32_bf16 v[8:11], v[48:51], v[144:147], v[8:11]
    s_cbranch_vccnz L_sw_38
L_bk_39:
    v_add_u32 v215, 81920, v207
    v_mfma_f32_16x16x32_bf16 v[12:15], v[52:55], v[136:139], v[12:15]
    ds_read_b64_tr_b16 v[80:81], v212 offset:0
    ds_read_b64_tr_b16 v[82:83], v212 offset:2048
    v_mfma_f32_16x16x32_bf16 v[16:19], v[52:55], v[140:143], v[16:19]
    ds_read_b64_tr_b16 v[84:85], v213 offset:0
    ds_read_b64_tr_b16 v[86:87], v213 offset:2048
    v_mfma_f32_16x16x32_bf16 v[20:23], v[52:55], v[144:147], v[20:23]
    ds_read_b64_tr_b16 v[88:89], v214 offset:0
    ds_read_b64_tr_b16 v[90:91], v214 offset:2048
    v_mfma_f32_16x16x32_bf16 v[24:27], v[56:59], v[136:139], v[24:27]
    ds_read_b64_tr_b16 v[92:93], v215 offset:0
    ds_read_b64_tr_b16 v[94:95], v215 offset:2048
    v_mfma_f32_16x16x32_bf16 v[28:31], v[56:59], v[140:143], v[28:31]
    ds_read_b64_tr_b16 v[96:97], v212 offset:4096
    ds_read_b64_tr_b16 v[98:99], v212 offset:6144
    v_mfma_f32_16x16x32_bf16 v[32:35], v[56:59], v[144:147], v[32:35]
    ds_read_b64_tr_b16 v[100:101], v213 offset:4096
    ds_read_b64_tr_b16 v[102:103], v213 offset:6144
    v_mfma_f32_16x16x32_bf16 v[36:39], v[60:63], v[136:139], v[36:39]
    ds_read_b64_tr_b16 v[104:105], v214 offset:4096
    ds_read_b64_tr_b16 v[106:107], v214 offset:6144
    v_mfma_f32_16x16x32_bf16 v[40:43], v[60:63], v[140:143], v[40:43]
    ds_read_b64_tr_b16 v[108:109], v215 offset:4096
    ds_read_b64_tr_b16 v[110:111], v215 offset:6144
    v_mfma_f32_16x16x32_bf16 v[44:47], v[60:63], v[144:147], v[44:47]
    ds_read_b32 v251, v249 offset:112
    v_mfma_f32_16x16x32_bf16 v[0:3], v[64:67], v[148:151], v[0:3]
    ds_write_b32 v253, v250 offset:104
    buffer_load_dwordx4 v[112:115], v220, s[56:59], s100 offen sc1
    v_mfma_f32_16x16x32_bf16 v[4:7], v[64:67], v[152:155], v[4:7]
    v_mfma_f32_16x16x32_bf16 v[8:11], v[64:67], v[156:159], v[8:11]
    buffer_load_dwordx4 v[116:119], v221, s[56:59], s100 offen sc1
    v_mfma_f32_16x16x32_bf16 v[12:15], v[68:71], v[148:151], v[12:15]
    v_mfma_f32_16x16x32_bf16 v[16:19], v[68:71], v[152:155], v[16:19]
    buffer_load_dwordx4 v[120:123], v222, s[56:59], s100 offen sc1
    v_mfma_f32_16x16x32_bf16 v[20:23], v[68:71], v[156:159], v[20:23]
    v_mfma_f32_16x16x32_bf16 v[24:27], v[72:75], v[148:151], v[24:27]
    buffer_load_dwordx4 v[124:127], v220, s[56:59], s74 offen sc1
    v_mfma_f32_16x16x32_bf16 v[28:31], v[72:75], v[152:155], v[28:31]
    v_mfma_f32_16x16x32_bf16 v[32:35], v[72:75], v[156:159], v[32:35]
    buffer_load_dwordx4 v[128:131], v221, s[56:59], s74 offen sc1
    v_mfma_f32_16x16x32_bf16 v[36:39], v[76:79], v[148:151], v[36:39]
    v_mfma_f32_16x16x32_bf16 v[40:43], v[76:79], v[152:155], v[40:43]
    buffer_load_dwordx4 v[132:135], v222, s[56:59], s74 offen sc1
    s_add_u32 s100, s100, 16384
    s_cmp_eq_u32 s100, 196608
    s_cselect_b32 s100, 0, s100
    s_add_u32 s74, s100, 4096
    v_mfma_f32_16x16x32_bf16 v[44:47], v[76:79], v[156:159], v[44:47]
    s_waitcnt lgkmcnt(1)
    s_waitcnt vmcnt(6)
    v_mfma_f32_16x16x32_bf16 v[0:3], v[80:83], v[160:163], v[0:3]
    v_cmp_ne_u32 vcc, s3, v251
    v_add_u32 v212, 98304, v204
    v_mfma_f32_16x16x32_bf16 v[4:7], v[80:83], v[164:167], v[4:7]
    v_add_u32 v213, 98304, v205
    v_add_u32 v214, 98304, v206
    v_mfma_f32_16x16x32_bf16 v[8:11], v[80:83], v[168:171], v[8:11]
    s_cbranch_vccnz L_sw_41
L_bk_42:
    v_add_u32 v215, 98304, v207
    v_mfma_f32_16x16x32_bf16 v[12:15], v[84:87], v[160:163], v[12:15]
    ds_read_b64_tr_b16 v[48:49], v212 offset:0
    ds_read_b64_tr_b16 v[50:51], v212 offset:2048
    v_mfma_f32_16x16x32_bf16 v[16:19], v[84:87], v[164:167], v[16:19]
    ds_read_b64_tr_b16 v[52:53], v213 offset:0
    ds_read_b64_tr_b16 v[54:55], v213 offset:2048
    v_mfma_f32_16x16x32_bf16 v[20:23], v[84:87], v[168:171], v[20:23]
    ds_read_b64_tr_b16 v[56:57], v214 offset:0
    ds_read_b64_tr_b16 v[58:59], v214 offset:2048
    v_mfma_f32_16x16x32_bf16 v[24:27], v[88:91], v[160:163], v[24:27]
    ds_read_b64_tr_b16 v[60:61], v215 offset:0
    ds_read_b64_tr_b16 v[62:63], v215 offset:2048
    v_mfma_f32_16x16x32_bf16 v[28:31], v[88:91], v[164:167], v[28:31]
    ds_read_b64_tr_b16 v[64:65], v212 offset:4096
    ds_read_b64_tr_b16 v[66:67], v212 offset:6144
    v_mfma_f32_16x16x32_bf16 v[32:35], v[88:91], v[168:171], v[32:35]
    ds_read_b64_tr_b16 v[68:69], v213 offset:4096
    ds_read_b64_tr_b16 v[70:71], v213 offset:6144
    v_mfma_f32_16x16x32_bf16 v[36:39], v[92:95], v[160:163], v[36:39]
    ds_read_b64_tr_b16 v[72:73], v214 offset:4096
    ds_read_b64_tr_b16 v[74:75], v214 offset:6144
    v_mfma_f32_16x16x32_bf16 v[40:43], v[92:95], v[164:167], v[40:43]
    ds_read_b64_tr_b16 v[76:77], v215 offset:4096
    ds_read_b64_tr_b16 v[78:79], v215 offset:6144
    v_mfma_f32_16x16x32_bf16 v[44:47], v[92:95], v[168:171], v[44:47]
    ds_read_b32 v251, v249 offset:116
    v_mfma_f32_16x16x32_bf16 v[0:3], v[96:99], v[172:175], v[0:3]
    ds_write_b32 v253, v250 offset:108
    buffer_load_dwordx4 v[136:139], v220, s[56:59], s100 offen sc1
    v_mfma_f32_16x16x32_bf16 v[4:7], v[96:99], v[176:179], v[4:7]
    v_mfma_f32_16x16x32_bf16 v[8:11], v[96:99], v[180:183], v[8:11]
    buffer_load_dwordx4 v[140:143], v221, s[56:59], s100 offen sc1
    v_mfma_f32_16x16x32_bf16 v[12:15], v[100:103], v[172:175], v[12:15]
    v_mfma_f32_16x16x32_bf16 v[16:19], v[100:103], v[176:179], v[16:19]
    buffer_load_dwordx4 v[144:147], v222, s[56:59], s100 offen sc1
    v_mfma_f32_16x16x32_bf16 v[20:23], v[100:103], v[180:183], v[20:23]
    v_mfma_f32_16x16x32_bf16 v[24:27], v[104:107], v[172:175], v[24:27]
    buffer_load_dwordx4 v[148:151], v220, s[56:59], s74 offen sc1
    v_mfma_f32_16x16x32_bf16 v[28:31], v[104:107], v[176:179], v[28:31]
    v_mfma_f32_16x16x32_bf16 v[32:35], v[104:107], v[180:183], v[32:35]
    buffer_load_dwordx4 v[152:155], v221, s[56:59], s74 offen sc1
    v_mfma_f32_16x16x32_bf16 v[36:39], v[108:111], v[172:175], v[36:39]
    v_mfma_f32_16x16x32_bf16 v[40:43], v[108:111], v[176:179], v[40:43]
    buffer_load_dwordx4 v[156:159], v222, s[56:59], s74 offen sc1
    s_add_u32 s100, s100, 16384
    s_cmp_eq_u32 s100, 196608
    s_cselect_b32 s100, 0, s100
    s_add_u32 s74, s100, 4096
    v_mfma_f32_16x16x32_bf16 v[44:47], v[108:111], v[180:183], v[44:47]
    s_waitcnt lgkmcnt(1)
    s_waitcnt vmcnt(6)
    v_mfma_f32_16x16x32_bf16 v[0:3], v[48:51], v[112:115], v[0:3]
    v_cmp_ne_u32 vcc, s3, v251
    v_add_u32 v212, 114688, v204
    v_mfma_f32_16x16x32_bf16 v[4:7], v[48:51], v[116:119], v[4:7]
    v_add_u32 v213, 114688, v205
    v_add_u32 v214, 114688, v206
    v_mfma_f32_16x16x32_bf16 v[8:11], v[48:51], v[120:123], v[8:11]
    s_cbranch_vccnz L_sw_44
L_bk_45:
    v_add_u32 v215, 114688, v207
    v_mfma_f32_16x16x32_bf16 v[12:15], v[52:55], v[112:115], v[12:15]
    ds_read_b64_tr_b16 v[80:81], v212 offset:0
    ds_read_b64_tr_b16 v[82:83], v212 offset:2048
    v_mfma_f32_16x16x32_bf16 v[16:19], v[52:55], v[116:119], v[16:19]
    ds_read_b64_tr_b16 v[84:85], v213 offset:0
    ds_read_b64_tr_b16 v[86:87], v213 offset:2048
    v_mfma_f32_16x16x32_bf16 v[20:23], v[52:55], v[120:123], v[20:23]
    ds_read_b64_tr_b16 v[88:89], v214 offset:0
    ds_read_b64_tr_b16 v[90:91], v214 offset:2048
    v_mfma_f32_16x16x32_bf16 v[24:27], v[56:59], v[112:115], v[24:27]
    ds_read_b64_tr_b16 v[92:93], v215 offset:0
    ds_read_b64_tr_b16 v[94:95], v215 offset:2048
    v_mfma_f32_16x16x32_bf16 v[28:31], v[56:59], v[116:119], v[28:31]
    ds_read_b64_tr_b16 v[96:97], v212 offset:4096
    ds_read_b64_tr_b16 v[98:99], v212 offset:6144
    v_mfma_f32_16x16x32_bf16 v[32:35], v[56:59], v[120:123], v[32:35]
    ds_read_b64_tr_b16 v[100:101], v213 offset:4096
    ds_read_b64_tr_b16 v[102:103], v213 offset:6144
    v_mfma_f32_16x16x32_bf16 v[36:39], v[60:63], v[112:115], v[36:39]
    ds_read_b64_tr_b16 v[104:105], v214 offset:4096
    ds_read_b64_tr_b16 v[106:107], v214 offset:6144
    v_mfma_f32_16x16x32_bf16 v[40:43], v[60:63], v[116:119], v[40:43]
    ds_read_b64_tr_b16 v[108:109], v215 offset:4096
    ds_read_b64_tr_b16 v[110:111], v215 offset:6144
    v_mfma_f32_16x16x32_bf16 v[44:47], v[60:63], v[120:123], v[44:47]
    ds_read_b32 v251, v249 offset:120
    v_mfma_f32_16x16x32_bf16 v[0:3], v[64:67], v[124:127], v[0:3]
    ds_write_b32 v253, v250 offset:112
    buffer_load_dwordx4 v[160:163], v220, s[56:59], s100 offen sc1
    v_mfma_f32_16x16x32_bf16 v[4:7], v[64:67], v[128:131], v[4:7]
    v_mfma_f32_16x16x32_bf16 v[8:11], v[64:67], v[132:135], v[8:11]
    buffer_load_dwordx4 v[164:167], v221, s[56:59], s100 offen sc1
    v_mfma_f32_16x16x32_bf16 v[12:15], v[68:71], v[124:127], v[12:15]
    v_mfma_f32_16x16x32_bf16 v[16:19], v[68:71], v[128:131], v[16:19]
    buffer_load_dwordx4 v[168:171], v222, s[56:59], s100 offen sc1
    v_mfma_f32_16x16x32_bf16 v[20:23], v[68:71], v[132:135], v[20:23]
    v_mfma_f32_16x16x32_bf16 v[24:27], v[72:75], v[124:127], v[24:27]
    buffer_load_dwordx4 v[172:175], v220, s[56:59], s74 offen sc1
    v_mfma_f32_16x16x32_bf16 v[28:31], v[72:75], v[128:131], v[28:31]
    v_mfma_f32_16x16x32_bf16 v[32:35], v[72:75], v[132:135], v[32:35]
    buffer_load_dwordx4 v[176:179], v221, s[56:59], s74 offen sc1
    v_mfma_f32_16x16x32_bf16 v[36:39], v[76:79], v[124:127], v[36:39]
    v_mfma_f32_16x16x32_bf16 v[40:43], v[76:79], v[128:131], v[40:43]
    buffer_load_dwordx4 v[180:183], v222, s[56:59], s74 offen sc1
    s_add_u32 s100, s100, 16384
    s_cmp_eq_u32 s100, 196608
    s_cselect_b32 s100, 0, s100
    s_add_u32 s74, s100, 4096
    v_mfma_f32_16x16x32_bf16 v[44:47], v[76:79], v[132:135], v[44:47]
    s_waitcnt lgkmcnt(1)
    s_waitcnt vmcnt(6)
    v_mfma_f32_16x16x32_bf16 v[0:3], v[80:83], v[136:139], v[0:3]
    v_cmp_ne_u32 vcc, s3, v251
    v_add_u32 v212, 131072, v204
    v_mfma_f32_16x16x32_bf16 v[4:7], v[80:83], v[140:143], v[4:7]
    v_add_u32 v213, 131072, v205
    v_add_u32 v214, 131072, v206
    v_mfma_f32_16x16x32_bf16 v[8:11], v[80:83], v[144:147], v[8:11]
    s_cbranch_vccnz L_sw_47
L_bk_48:
    v_add_u32 v215, 131072, v207
    v_mfma_f32_16x16x32_bf16 v[12:15], v[84:87], v[136:139], v[12:15]
    ds_read_b64_tr_b16 v[48:49], v212 offset:0
    ds_read_b64_tr_b16 v[50:51], v212 offset:2048
    v_mfma_f32_16x16x32_bf16 v[16:19], v[84:87], v[140:143], v[16:19]
    ds_read_b64_tr_b16 v[52:53], v213 offset:0
    ds_read_b64_tr_b16 v[54:55], v213 offset:2048
    v_mfma_f32_16x16x32_bf16 v[20:23], v[84:87], v[144:147], v[20:23]
    ds_read_b64_tr_b16 v[56:57], v214 offset:0
    ds_read_b64_tr_b16 v[58:59], v214 offset:2048
    v_mfma_f32_16x16x32_bf16 v[24:27], v[88:91], v[136:139], v[24:27]
    ds_read_b64_tr_b16 v[60:61], v215 offset:0
    ds_read_b64_tr_b16 v[62:63], v215 offset:2048
    v_mfma_f32_16x16x32_bf16 v[28:31], v[88:91], v[140:143], v[28:31]
    ds_read_b64_tr_b16 v[64:65], v212 offset:4096
    ds_read_b64_tr_b16 v[66:67], v212 offset:6144
    v_mfma_f32_16x16x32_bf16 v[32:35], v[88:91], v[144:147], v[32:35]
    ds_read_b64_tr_b16 v[68:69], v213 offset:4096
    ds_read_b64_tr_b16 v[70:71], v213 offset:6144
    v_mfma_f32_16x16x32_bf16 v[36:39], v[92:95], v[136:139], v[36:39]
    ds_read_b64_tr_b16 v[72:73], v214 offset:4096
    ds_read_b64_tr_b16 v[74:75], v214 offset:6144
    v_mfma_f32_16x16x32_bf16 v[40:43], v[92:95], v[140:143], v[40:43]
    ds_read_b64_tr_b16 v[76:77], v215 offset:4096
    ds_read_b64_tr_b16 v[78:79], v215 offset:6144
    v_mfma_f32_16x16x32_bf16 v[44:47], v[92:95], v[144:147], v[44:47]
    ds_read_b32 v251, v249 offset:124
    v_mfma_f32_16x16x32_bf16 v[0:3], v[96:99], v[148:151], v[0:3]
    ds_write_b32 v253, v250 offset:116
    buffer_load_dwordx4 v[112:115], v220, s[56:59], s100 offen sc1
    v_mfma_f32_16x16x32_bf16 v[4:7], v[96:99], v[152:155], v[4:7]
    v_mfma_f32_16x16x32_bf16 v[8:11], v[96:99], v[156:159], v[8:11]
    buffer_load_dwordx4 v[116:119], v221, s[56:59], s100 offen sc1
    v_mfma_f32_16x16x32_bf16 v[12:15], v[100:103], v[148:151], v[12:15]
    v_mfma_f32_16x16x32_bf16 v[16:19], v[100:103], v[152:155], v[16:19]
    buffer_load_dwordx4 v[120:123], v222, s[56:59], s100 offen sc1
    v_mfma_f32_16x16x32_bf16 v[20:23], v[100:103], v[156:159], v[20:23]
    v_mfma_f32_16x16x32_bf16 v[24:27], v[104:107], v[148:151], v[24:27]
    buffer_load_dwordx4 v[124:127], v220, s[56:59], s74 offen sc1
    v_mfma_f32_16x16x32_bf16 v[28:31], v[104:107], v[152:155], v[28:31]
    v_mfma_f32_16x16x32_bf16 v[32:35], v[104:107], v[156:159], v[32:35]
    buffer_load_dwordx4 v[128:131], v221, s[56:59], s74 offen sc1
    v_mfma_f32_16x16x32_bf16 v[36:39], v[108:111], v[148:151], v[36:39]
    v_mfma_f32_16x16x32_bf16 v[40:43], v[108:111], v[152:155], v[40:43]
    buffer_load_dwordx4 v[132:135], v222, s[56:59], s74 offen sc1
    s_add_u32 s100, s100, 16384
    s_cmp_eq_u32 s100, 196608
    s_cselect_b32 s100, 0, s100
    s_add_u32 s74, s100, 4096
    v_mfma_f32_16x16x32_bf16 v[44:47], v[108:111], v[156:159], v[44:47]
    s_waitcnt lgkmcnt(1)
    s_waitcnt vmcnt(6)
    v_mfma_f32_16x16x32_bf16 v[0:3], v[48:51], v[160:163], v[0:3]
    v_cmp_ne_u32 vcc, s3, v251
    v_add_u32 v212, 0, v204
    v_mfma_f32_16x16x32_bf16 v[4:7], v[48:51], v[164:167], v[4:7]
    v_add_u32 v213, 0, v205
    v_add_u32 v214, 0, v206
    v_mfma_f32_16x16x32_bf16 v[8:11], v[48:51], v[168:171], v[8:11]
    s_cbranch_vccnz L_sw_50
L_bk_51:
    v_add_u32 v215, 0, v207
    v_mfma_f32_16x16x32_bf16 v[12:15], v[52:55], v[160:163], v[12:15]
    ds_read_b64_tr_b16 v[80:81], v212 offset:0
    ds_read_b64_tr_b16 v[82:83], v212 offset:2048
    v_mfma_f32_16x16x32_bf16 v[16:19], v[52:55], v[164:167], v[16:19]
    ds_read_b64_tr_b16 v[84:85], v213 offset:0
    ds_read_b64_tr_b16 v[86:87], v213 offset:2048
    v_mfma_f32_16x16x32_bf16 v[20:23], v[52:55], v[168:171], v[20:23]
    ds_read_b64_tr_b16 v[88:89], v214 offset:0
    ds_read_b64_tr_b16 v[90:91], v214 offset:2048
    v_mfma_f32_16x16x32_bf16 v[24:27], v[56:59], v[160:163], v[24:27]
    ds_read_b64_tr_b16 v[92:93], v215 offset:0
    ds_read_b64_tr_b16 v[94:95], v215 offset:2048
    v_mfma_f32_16x16x32_bf16 v[28:31], v[56:59], v[164:167], v[28:31]
    ds_read_b64_tr_b16 v[96:97], v212 offset:4096
    ds_read_b64_tr_b16 v[98:99], v212 offset:6144
    v_mfma_f32_16x16x32_bf16 v[32:35], v[56:59], v[168:171], v[32:35]
    ds_read_b64_tr_b16 v[100:101], v213 offset:4096
    ds_read_b64_tr_b16 v[102:103], v213 offset:6144
    v_mfma_f32_16x16x32_bf16 v[36:39], v[60:63], v[160:163], v[36:39]
    ds_read_b64_tr_b16 v[104:105], v214 offset:4096
    ds_read_b64_tr_b16 v[106:107], v214 offset:6144
    v_mfma_f32_16x16x32_bf16 v[40:43], v[60:63], v[164:167], v[40:43]
    ds_read_b64_tr_b16 v[108:109], v215 offset:4096
    ds_read_b64_tr_b16 v[110:111], v215 offset:6144
    v_mfma_f32_16x16x32_bf16 v[44:47], v[60:63], v[168:171], v[44:47]
    ds_read_b32 v251, v249 offset:128
    v_mfma_f32_16x16x32_bf16 v[0:3], v[64:67], v[172:175], v[0:3]
    ds_write_b32 v253, v250 offset:120
    buffer_load_dwordx4 v[136:139], v220, s[56:59], s100 offen sc1
    v_mfma_f32_16x16x32_bf16 v[4:7], v[64:67], v[176:179], v[4:7]
    v_mfma_f32_16x16x32_bf16 v[8:11], v[64:67], v[180:183], v[8:11]
    buffer_load_dwordx4 v[140:143], v221, s[56:59], s100 offen sc1
    v_mfma_f32_16x16x32_bf16 v[12:15], v[68:71], v[172:175], v[12:15]
    v_mfma_f32_16x16x32_bf16 v[16:19], v[68:71], v[176:179], v[16:19]
    buffer_load_dwordx4 v[144:147], v222, s[56:59], s100 offen sc1
    v_mfma_f32_16x16x32_bf16 v[20:23], v[68:71], v[180:183], v[20:23]
    v_mfma_f32_16x16x32_bf16 v[24:27], v[72:75], v[172:175], v[24:27]
    buffer_load_dwordx4 v[148:151], v220, s[56:59], s74 offen sc1
    v_mfma_f32_16x16x32_bf16 v[28:31], v[72:75], v[176:179], v[28:31]
    v_mfma_f32_16x16x32_bf16 v[32:35], v[72:75], v[180:183], v[32:35]
    buffer_load_dwordx4 v[152:155], v221, s[56:59], s74 offen sc1
    v_mfma_f32_16x16x32_bf16 v[36:39], v[76:79], v[172:175], v[36:39]
    v_mfma_f32_16x16x32_bf16 v[40:43], v[76:79], v[176:179], v[40:43]
    buffer_load_dwordx4 v[156:159], v222, s[56:59], s74 offen sc1
    s_add_u32 s100, s100, 16384
    s_cmp_eq_u32 s100, 196608
    s_cselect_b32 s100, 0, s100
    s_add_u32 s74, s100, 4096
    v_mfma_f32_16x16x32_bf16 v[44:47], v[76:79], v[180:183], v[44:47]
    s_waitcnt lgkmcnt(1)
    s_waitcnt vmcnt(6)
    v_mfma_f32_16x16x32_bf16 v[0:3], v[80:83], v[112:115], v[0:3]
    v_cmp_ne_u32 vcc, s3, v251
    v_add_u32 v212, 16384, v204
    v_mfma_f32_16x16x32_bf16 v[4:7], v[80:83], v[116:119], v[4:7]
    v_add_u32 v213, 16384, v205
    v_add_u32 v214, 16384, v206
    v_mfma_f32_16x16x32_bf16 v[8:11], v[80:83], v[120:123], v[8:11]
    s_cbranch_vccnz L_sw_53
L_bk_54:
    v_add_u32 v215, 16384, v207
    v_mfma_f32_16x16x32_bf16 v[12:15], v[84:87], v[112:115], v[12:15]
    ds_read_b64_tr_b16 v[48:49], v212 offset:0
    ds_read_b64_tr_b16 v[50:51], v212 offset:2048
    v_mfma_f32_16x16x32_bf16 v[16:19], v[84:87], v[116:119], v[16:19]
    ds_read_b64_tr_b16 v[52:53], v213 offset:0
    ds_read_b64_tr_b16 v[54:55], v213 offset:2048
    v_mfma_f32_16x16x32_bf16 v[20:23], v[84:87], v[120:123], v[20:23]
    ds_read_b64_tr_b16 v[56:57], v214 offset:0
    ds_read_b64_tr_b16 v[58:59], v214 offset:2048
    v_mfma_f32_16x16x32_bf16 v[24:27], v[88:91], v[112:115], v[24:27]
    ds_read_b64_tr_b16 v[60:61], v215 offset:0
    ds_read_b64_tr_b16 v[62:63], v215 offset:2048
    v_mfma_f32_16x16x32_bf16 v[28:31], v[88:91], v[116:119], v[28:31]
    ds_read_b64_tr_b16 v[64:65], v212 offset:4096
    ds_read_b64_tr_b16 v[66:67], v212 offset:6144
    v_mfma_f32_16x16x32_bf16 v[32:35], v[88:91], v[120:123], v[32:35]
    ds_read_b64_tr_b16 v[68:69], v213 offset:4096
    ds_read_b64_tr_b16 v[70:71], v213 offset:6144
    v_mfma_f32_16x16x32_bf16 v[36:39], v[92:95], v[112:115], v[36:39]
    ds_read_b64_tr_b16 v[72:73], v214 offset:4096
    ds_read_b64_tr_b16 v[74:75], v214 offset:6144
    v_mfma_f32_16x16x32_bf16 v[40:43], v[92:95], v[116:119], v[40:43]
    ds_read_b64_tr_b16 v[76:77], v215 offset:4096
    ds_read_b64_tr_b16 v[78:79], v215 offset:6144
    v_mfma_f32_16x16x32_bf16 v[44:47], v[92:95], v[120:123], v[44:47]
    ds_read_b32 v251, v249 offset:132
    v_mfma_f32_16x16x32_bf16 v[0:3], v[96:99], v[124:127], v[0:3]
    ds_read_b32 v223, v248
    buffer_load_dwordx4 v[160:163], v220, s[56:59], s100 offen sc1
    v_mfma_f32_16x16x32_bf16 v[4:7], v[96:99], v[128:131], v[4:7]
    ds_write_b32 v253, v250 offset:124
    v_mfma_f32_16x16x32_bf16 v[8:11], v[96:99], v[132:135], v[8:11]
    buffer_load_dwordx4 v[164:167], v221, s[56:59], s100 offen sc1
    v_mfma_f32_16x16x32_bf16 v[12:15], v[100:103], v[124:127], v[12:15]
    v_mfma_f32_16x16x32_bf16 v[16:19], v[100:103], v[128:131], v[16:19]
    buffer_load_dwordx4 v[168:171], v222, s[56:59], s100 offen sc1
    v_mfma_f32_16x16x32_bf16 v[20:23], v[100:103], v[132:135], v[20:23]
    v_mfma_f32_16x16x32_bf16 v[24:27], v[104:107], v[124:127], v[24:27]
    buffer_load_dwordx4 v[172:175], v220, s[56:59], s74 offen sc1
    v_mfma_f32_16x16x32_bf16 v[28:31], v[104:107], v[128:131], v[28:31]
    v_mfma_f32_16x16x32_bf16 v[32:35], v[104:107], v[132:135], v[32:35]
    buffer_load_dwordx4 v[176:179], v221, s[56:59], s74 offen sc1
    v_mfma_f32_16x16x32_bf16 v[36:39], v[108:111], v[124:127], v[36:39]
    v_mfma_f32_16x16x32_bf16 v[40:43], v[108:111], v[128:131], v[40:43]
    buffer_load_dwordx4 v[180:183], v222, s[56:59], s74 offen sc1
    s_mul_i32 s100, s99, 16384
    s_add_u32 s100, s100, 196608
    s_add_u32 s74, s100, 4096
    v_mfma_f32_16x16x32_bf16 v[44:47], v[108:111], v[132:135], v[44:47]
    s_waitcnt lgkmcnt(1)
    v_cmp_le_u32 vcc, 3, v223
    s_cbranch_vccz L_late_24
    s_waitcnt lgkmcnt(1)
    s_waitcnt vmcnt(6)
    v_mfma_f32_16x16x32_bf16 v[0:3], v[48:51], v[136:139], v[0:3]
    v_cmp_ne_u32 vcc, s3, v251
    v_add_u32 v212, 32768, v204
    v_mfma_f32_16x16x32_bf16 v[4:7], v[48:51], v[140:143], v[4:7]
    v_add_u32 v213, 32768, v205
    v_add_u32 v214, 32768, v206
    v_mfma_f32_16x16x32_bf16 v[8:11], v[48:51], v[144:147], v[8:11]
    s_cbranch_vccnz L_sw_64
L_bk_65:
    v_add_u32 v215, 32768, v207
    v_mfma_f32_16x16x32_bf16 v[12:15], v[52:55], v[136:139], v[12:15]
    ds_read_b64_tr_b16 v[80:81], v212 offset:0
    ds_read_b64_tr_b16 v[82:83], v212 offset:2048
    v_mfma_f32_16x16x32_bf16 v[16:19], v[52:55], v[140:143], v[16:19]
    ds_read_b64_tr_b16 v[84:85], v213 offset:0
    ds_read_b64_tr_b16 v[86:87], v213 offset:2048
    v_mfma_f32_16x16x32_bf16 v[20:23], v[52:55], v[144:147], v[20:23]
    ds_read_b64_tr_b16 v[88:89], v214 offset:0
    ds_read_b64_tr_b16 v[90:91], v214 offset:2048
    v_mfma_f32_16x16x32_bf16 v[24:27], v[56:59], v[136:139], v[24:27]
    ds_read_b64_tr_b16 v[92:93], v215 offset:0
    ds_read_b64_tr_b16 v[94:95], v215 offset:2048
    v_mfma_f32_16x16x32_bf16 v[28:31], v[56:59], v[140:143], v[28:31]
    ds_read_b64_tr_b16 v[96:97], v212 offset:4096
    ds_read_b64_tr_b16 v[98:99], v212 offset:6144
    v_mfma_f32_16x16x32_bf16 v[32:35], v[56:59], v[144:147], v[32:35]
    ds_read_b64_tr_b16 v[100:101], v213 offset:4096
    ds_read_b64_tr_b16 v[102:103], v213 offset:6144
    v_mfma_f32_16x16x32_bf16 v[36:39], v[60:63], v[136:139], v[36:39]
    ds_read_b64_tr_b16 v[104:105], v214 offset:4096
    ds_read_b64_tr_b16 v[106:107], v214 offset:6144
    v_mfma_f32_16x16x32_bf16 v[40:43], v[60:63], v[140:143], v[40:43]
    ds_read_b64_tr_b16 v[108:109], v215 offset:4096
    ds_read_b64_tr_b16 v[110:111], v215 offset:6144
    v_mfma_f32_16x16x32_bf16 v[44:47], v[60:63], v[144:147], v[44:47]
    ds_read_b32 v251, v249 offset:136
    v_mfma_f32_16x16x32_bf16 v[0:3], v[64:67], v[148:151], v[0:3]
    ds_write_b32 v253, v250 offset:128
    buffer_load_dwordx4 v[112:115], v220, s[56:59], s100 offen sc1
    v_mfma_f32_16x16x32_bf16 v[4:7], v[64:67], v[152:155], v[4:7]
    v_mfma_f32_16x16x32_bf16 v[8:11], v[64:67], v[156:159], v[8:11]
    buffer_load_dwordx4 v[116:119], v221, s[56:59], s100 offen sc1
    v_mfma_f32_16x16x32_bf16 v[12:15], v[68:71], v[148:151], v[12:15]
    v_mfma_f32_16x16x32_bf16 v[16:19], v[68:71], v[152:155], v[16:19]
    buffer_load_dwordx4 v[120:123], v222, s[56:59], s100 offen sc1
    v_mfma_f32_16x16x32_bf16 v[20:23], v[68:71], v[156:159], v[20:23]
    v_mfma_f32_16x16x32_bf16 v[24:27], v[72:75], v[148:151], v[24:27]
    buffer_load_dwordx4 v[124:127], v220, s[56:59], s74 offen sc1
    v_mfma_f32_16x16x32_bf16 v[28:31], v[72:75], v[152:155], v[28:31]
    v_mfma_f32_16x16x32_bf16 v[32:35], v[72:75], v[156:159], v[32:35]
    buffer_load_dwordx4 v[128:131], v221, s[56:59], s74 offen sc1
    v_mfma_f32_16x16x32_bf16 v[36:39], v[76:79], v[148:151], v[36:39]
    v_mfma_f32_16x16x32_bf16 v[40:43], v[76:79], v[152:155], v[40:43]
    buffer_load_dwordx4 v[132:135], v222, s[56:59], s74 offen sc1
    s_add_u32 s100, s100, 16384
    s_cmp_eq_u32 s100, 360448
    s_cselect_b32 s100, 196608, s100
    s_add_u32 s74, s100, 4096
    v_mfma_f32_16x16x32_bf16 v[44:47], v[76:79], v[156:159], v[44:47]
    s_waitcnt lgkmcnt(1)
    s_waitcnt vmcnt(6)
    v_mfma_f32_16x16x32_bf16 v[0:3], v[80:83], v[160:163], v[0:3]
    v_cmp_ne_u32 vcc, s3, v251
    v_add_u32 v212, 49152, v208
    v_mfma_f32_16x16x32_bf16 v[4:7], v[80:83], v[164:167], v[4:7]
    v_add_u32 v213, 49152, v209
    v_add_u32 v214, 49152, v210
    v_mfma_f32_16x16x32_bf16 v[8:11], v[80:83], v[168:171], v[8:11]
    s_cbranch_vccnz L_sw_67
L_bk_68:
    v_add_u32 v215, 49152, v211
    v_mfma_f32_16x16x32_bf16 v[12:15], v[84:87], v[160:163], v[12:15]
    ds_read_b128 v[48:51], v212
    v_xor_b32 v216, 32, v212
    v_mfma_f32_16x16x32_bf16 v[16:19], v[84:87], v[164:167], v[16:19]
    ds_read_b128 v[52:55], v213
    v_xor_b32 v217, 32, v213
    v_mfma_f32_16x16x32_bf16 v[20:23], v[84:87], v[168:171], v[20:23]
    ds_read_b128 v[56:59], v214
    v_xor_b32 v218, 32, v214
    v_mfma_f32_16x16x32_bf16 v[24:27], v[88:91], v[160:163], v[24:27]
    ds_read_b128 v[60:63], v215
    v_xor_b32 v219, 32, v215
    v_mfma_f32_16x16x32_bf16 v[28:31], v[88:91], v[164:167], v[28:31]
    ds_read_b128 v[64:67], v216
    v_mfma_f32_16x16x32_bf16 v[32:35], v[88:91], v[168:171], v[32:35]
    ds_read_b128 v[68:71], v217
    v_mfma_f32_16x16x32_bf16 v[36:39], v[92:95], v[160:163], v[36:39]
    ds_read_b128 v[72:75], v218
    v_mfma_f32_16x16x32_bf16 v[40:43], v[92:95], v[164:167], v[40:43]
    ds_read_b128 v[76:79], v219
    v_mfma_f32_16x16x32_bf16 v[44:47], v[92:95], v[168:171], v[44:47]
    ds_read_b32 v251, v249 offset:140
    v_mfma_f32_16x16x32_bf16 v[0:3], v[96:99], v[172:175], v[0:3]
    ds_write_b32 v253, v250 offset:132
    buffer_load_dwordx4 v[136:139], v220, s[56:59], s100 offen sc1
    v_mfma_f32_16x16x32_bf16 v[4:7], v[96:99], v[176:179], v[4:7]
    v_mfma_f32_16x16x32_bf16 v[8:11], v[96:99], v[180:183], v[8:11]
    buffer_load_dwordx4 v[140:143], v221, s[56:59], s100 offen sc1
    v_mfma_f32_16x16x32_bf16 v[12:15], v[100:103], v[172:175], v[12:15]
    v_mfma_f32_16x16x32_bf16 v[16:19], v[100:103], v[176:179], v[16:19]
    buffer_load_dwordx4 v[144:147], v222, s[56:59], s100 offen sc1
    v_mfma_f32_16x16x32_bf16 v[20:23], v[100:103], v[180:183], v[20:23]
    v_mfma_f32_16x16x32_bf16 v[24:27], v[104:107], v[172:175], v[24:27]
    buffer_load_dwordx4 v[148:151], v220, s[56:59], s74 offen sc1
    v_mfma_f32_16x16x32_bf16 v[28:31], v[104:107], v[176:179], v[28:31]
    v_mfma_f32_16x16x32_bf16 v[32:35], v[104:107], v[180:183], v[32:35]
    buffer_load_dwordx4 v[152:155], v221, s[56:59], s74 offen sc1
    v_mfma_f32_16x16x32_bf16 v[36:39], v[108:111], v[172:175], v[36:39]
    v_mfma_f32_16x16x32_bf16 v[40:43], v[108:111], v[176:179], v[40:43]
    buffer_load_dwordx4 v[156:159], v222, s[56:59], s74 offen sc1
    s_add_u32 s100, s100, 16384
    s_cmp_eq_u32 s100, 360448
    s_cselect_b32 s100, 196608, s100
    s_add_u32 s74, s100, 4096
    v_mfma_f32_16x16x32_bf16 v[44:47], v[108:111], v[180:183], v[44:47]
L_join_25:
    s_waitcnt lgkmcnt(1)
    s_waitcnt vmcnt(6)
    v_mfma_f32_16x16x32_bf16 v[0:3], v[48:51], v[112:115], v[0:3]
    v_cmp_ne_u32 vcc, s3, v251
    v_add_u32 v212, 65536, v208
    v_mfma_f32_16x16x32_bf16 v[4:7], v[48:51], v[116:119], v[4:7]
    v_add_u32 v213, 65536, v209
    v_add_u32 v214, 65536, v210
    v_mfma_f32_16x16x32_bf16 v[8:11], v[48:51], v[120:123], v[8:11]
    s_cbranch_vccnz L_sw_70
L_bk_71:
    v_add_u32 v215, 65536, v211
    v_mfma_f32_16x16x32_bf16 v[12:15], v[52:55], v[112:115], v[12:15]
    ds_read_b128 v[80:83], v212
    v_xor_b32 v216, 32, v212
    v_mfma_f32_16x16x32_bf16 v[16:19], v[52:55], v[116:119], v[16:19]
    ds_read_b128 v[84:87], v213
    v_xor_b32 v217, 32, v213
    v_mfma_f32_16x16x32_bf16 v[20:23], v[52:55], v[120:123], v[20:23]
    ds_read_b128 v[88:91], v214
    v_xor_b32 v218, 32, v214
    v_mfma_f32_16x16x32_bf16 v[24:27], v[56:59], v[112:115], v[24:27]
    ds_read_b128 v[92:95], v215
    v_xor_b32 v219, 32, v215
    v_mfma_f32_16x16x32_bf16 v[28:31], v[56:59], v[116:119], v[28:31]
    ds_read_b128 v[96:99], v216
    v_mfma_f32_16x16x32_bf16 v[32:35], v[56:59], v[120:123], v[32:35]
    ds_read_b128 v[100:103], v217
    v_mfma_f32_16x16x32_bf16 v[36:39], v[60:63], v[112:115], v[36:39]
    ds_read_b128 v[104:107], v218
    v_mfma_f32_16x16x32_bf16 v[40:43], v[60:63], v[116:119], v[40:43]
    ds_read_b128 v[108:111], v219
    v_mfma_f32_16x16x32_bf16 v[44:47], v[60:63], v[120:123], v[44:47]
    ds_read_b32 v251, v249 offset:144
    v_mfma_f32_16x16x32_bf16 v[0:3], v[64:67], v[124:127], v[0:3]
    ds_write_b32 v253, v250 offset:136
    buffer_load_dwordx4 v[160:163], v220, s[56:59], s100 offen sc1
    v_mfma_f32_16x16x32_bf16 v[4:7], v[64:67], v[128:131], v[4:7]
    v_mfma_f32_16x16x32_bf16 v[8:11], v[64:67], v[132:135], v[8:11]
    buffer_load_dwordx4 v[164:167], v221, s[56:59], s100 offen sc1
    v_mfma_f32_16x16x32_bf16 v[12:15], v[68:71], v[124:127], v[12:15]
    v_mfma_f32_16x16x32_bf16 v[16:19], v[68:71], v[128:131], v[16:19]
    buffer_load_dwordx4 v[168:171], v222, s[56:59], s100 offen sc1
    v_mfma_f32_16x16x32_bf16 v[20:23], v[68:71], v[132:135], v[20:23]
    v_mfma_f32_16x16x32_bf16 v[24:27], v[72:75], v[124:127], v[24:27]
    buffer_load_dwordx4 v[172:175], v220, s[56:59], s74 offen sc1
    v_mfma_f32_16x16x32_bf16 v[28:31], v[72:75], v[128:131], v[28:31]
    v_mfma_f32_16x16x32_bf16 v[32:35], v[72:75], v[132:135], v[32:35]
    buffer_load_dwordx4 v[176:179], v221, s[56:59], s74 offen sc1
    v_mfma_f32_16x16x32_bf16 v[36:39], v[76:79], v[124:127], v[36:39]
    v_mfma_f32_16x16x32_bf16 v[40:43], v[76:79], v[128:131], v[40:43]
    buffer_load_dwordx4 v[180:183], v222, s[56:59], s74 offen sc1
    s_add_u32 s100, s100, 16384
    s_cmp_eq_u32 s100, 360448
    s_cselect_b32 s100, 196608, s100
    s_add_u32 s74, s100, 4096
    v_mfma_f32_16x16x32_bf16 v[44:47], v[76:79], v[132:135], v[44:47]
    s_waitcnt lgkmcnt(1)
    s_waitcnt vmcnt(6)
    v_mfma_f32_16x16x32_bf16 v[0:3], v[80:83], v[136:139], v[0:3]
    v_cmp_ne_u32 vcc, s3, v251
    v_add_u32 v212, 81920, v208
    v_mfma_f32_16x16x32_bf16 v[4:7], v[80:83], v[140:143], v[4:7]
    v_add_u32 v213, 81920, v209
    v_add_u32 v214, 81920, v210
    v_mfma_f32_16x16x32_bf16 v[8:11], v[80:83], v[144:147], v[8:11]
    s_cbranch_vccnz L_sw_73
L_bk_74:
    v_add_u32 v215, 81920, v211
    v_mfma_f32_16x16x32_bf16 v[12:15], v[84:87], v[136:139], v[12:15]
    ds_read_b128 v[48:51], v212
    v_xor_b32 v216, 32, v212
    v_mfma_f32_16x16x32_bf16 v[16:19], v[84:87], v[140:143], v[16:19]
    ds_read_b128 v[52:55], v213
    v_xor_b32 v217, 32, v213
    v_mfma_f32_16x16x32_bf16 v[20:23], v[84:87], v[144:147], v[20:23]
    ds_read_b128 v[56:59], v214
    v_xor_b32 v218, 32, v214
    v_mfma_f32_16x16x32_bf16 v[24:27], v[88:91], v[136:139], v[24:27]
    ds_read_b128 v[60:63], v215
    v_xor_b32 v219, 32, v215
    v_mfma_f32_16x16x32_bf16 v[28:31], v[88:91], v[140:143], v[28:31]
    ds_read_b128 v[64:67], v216
    v_mfma_f32_16x16x32_bf16 v[32:35], v[88:91], v[144:147], v[32:35]
    ds_read_b128 v[68:71], v217
    v_mfma_f32_16x16x32_bf16 v[36:39], v[92:95], v[136:139], v[36:39]
    ds_read_b128 v[72:75], v218
    v_mfma_f32_16x16x32_bf16 v[40:43], v[92:95], v[140:143], v[40:43]
    ds_read_b128 v[76:79], v219
    v_mfma_f32_16x16x32_bf16 v[44:47], v[92:95], v[144:147], v[44:47]
    ds_read_b32 v251, v249 offset:148
    v_mfma_f32_16x16x32_bf16 v[0:3], v[96:99], v[148:151], v[0:3]
    ds_write_b32 v253, v250 offset:140
    buffer_load_dwordx4 v[112:115], v220, s[56:59], s100 offen sc1
    v_mfma_f32_16x16x32_bf16 v[4:7], v[96:99], v[152:155], v[4:7]
    v_mfma_f32_16x16x32_bf16 v[8:11], v[96:99], v[156:159], v[8:11]
    buffer_load_dwordx4 v[116:119], v221, s[56:59], s100 offen sc1
    v_mfma_f32_16x16x32_bf16 v[12:15], v[100:103], v[148:151], v[12:15]
    v_mfma_f32_16x16x32_bf16 v[16:19], v[100:103], v[152:155], v[16:19]
    buffer_load_dwordx4 v[120:123], v222, s[56:59], s100 offen sc1
    v_mfma_f32_16x16x32_bf16 v[20:23], v[100:103], v[156:159], v[20:23]
    v_mfma_f32_16x16x32_bf16 v[24:27], v[104:107], v[148:151], v[24:27]
    buffer_load_dwordx4 v[124:127], v220, s[56:59], s74 offen sc1
    v_mfma_f32_16x16x32_bf16 v[28:31], v[104:107], v[152:155], v[28:31]
    v_mfma_f32_16x16x32_bf16 v[32:35], v[104:107], v[156:159], v[32:35]
    buffer_load_dwordx4 v[128:131], v221, s[56:59], s74 offen sc1
    v_mfma_f32_16x16x32_bf16 v[36:39], v[108:111], v[148:151], v[36:39]
    v_mfma_f32_16x16x32_bf16 v[40:43], v[108:111], v[152:155], v[40:43]
    buffer_load_dwordx4 v[132:135], v222, s[56:59], s74 offen sc1
    s_add_u32 s100, s100, 16384
    s_cmp_eq_u32 s100, 360448
    s_cselect_b32 s100, 196608, s100
    s_add_u32 s74, s100, 4096
    v_mfma_f32_16x16x32_bf16 v[44:47], v[108:111], v[156:159], v[44:47]
    s_waitcnt lgkmcnt(1)
    s_waitcnt vmcnt(6)
    v_mfma_f32_16x16x32_bf16 v[0:3], v[48:51], v[160:163], v[0:3]
    v_cmp_ne_u32 vcc, s3, v251
    v_add_u32 v212, 98304, v208
    v_mfma_f32_16x16x32_bf16 v[4:7], v[48:51], v[164:167], v[4:7]
    v_add_u32 v213, 98304, v209
    v_add_u32 v214, 98304, v210
    v_mfma_f32_16x16x32_bf16 v[8:11], v[48:51], v[168:171], v[8:11]
    s_cbranch_vccnz L_sw_76
L_bk_77:
    v_add_u32 v215, 98304, v211
    v_mfma_f32_16x16x32_bf16 v[12:15], v[52:55], v[160:163], v[12:15]
    ds_read_b128 v[80:83], v212
    v_xor_b32 v216, 32, v212
    v_mfma_f32_16x16x32_bf16 v[16:19], v[52:55], v[164:167], v[16:19]
    ds_read_b128 v[84:87], v213
    v_xor_b32 v217, 32, v213
    v_mfma_f32_16x16x32_bf16 v[20:23], v[52:55], v[168:171], v[20:23]
    ds_read_b128 v[88:91], v214
    v_xor_b32 v218, 32, v214
    v_mfma_f32_16x16x32_bf16 v[24:27], v[56:59], v[160:163], v[24:27]
    ds_read_b128 v[92:95], v215
    v_xor_b32 v219, 32, v215
    v_mfma_f32_16x16x32_bf16 v[28:31], v[56:59], v[164:167], v[28:31]
    ds_read_b128 v[96:99], v216
    v_mfma_f32_16x16x32_bf16 v[32:35], v[56:59], v[168:171], v[32:35]
    ds_read_b128 v[100:103], v217
    v_mfma_f32_16x16x32_bf16 v[36:39], v[60:63], v[160:163], v[36:39]
    ds_read_b128 v[104:107], v218
    v_mfma_f32_16x16x32_bf16 v[40:43], v[60:63], v[164:167], v[40:43]
    ds_read_b128 v[108:111], v219
    v_mfma_f32_16x16x32_bf16 v[44:47], v[60:63], v[168:171], v[44:47]
    ds_read_b32 v251, v249 offset:152
    v_mfma_f32_16x16x32_bf16 v[0:3], v[64:67], v[172:175], v[0:3]
    ds_write_b32 v253, v250 offset:144
    buffer_load_dwordx4 v[136:139], v220, s[56:59], s100 offen sc1
    v_mfma_f32_16x16x32_bf16 v[4:7], v[64:67], v[176:179], v[4:7]
    v_mfma_f32_16x16x32_bf16 v[8:11], v[64:67], v[180:183], v[8:11]
    buffer_load_dwordx4 v[140:143], v221, s[56:59], s100 offen sc1
    v_mfma_f32_16x16x32_bf16 v[12:15], v[68:71], v[172:175], v[12:15]
    v_mfma_f32_16x16x32_bf16 v[16:19], v[68:71], v[176:179], v[16:19]
    buffer_load_dwordx4 v[144:147], v222, s[56:59], s100 offen sc1
    v_mfma_f32_16x16x32_bf16 v[20:23], v[68:71], v[180:183], v[20:23]
    v_mfma_f32_16x16x32_bf16 v[24:27], v[72:75], v[172:175], v[24:27]
    buffer_load_dwordx4 v[148:151], v220, s[56:59], s74 offen sc1
    v_mfma_f32_16x16x32_bf16 v[28:31], v[72:75], v[176:179], v[28:31]
    v_mfma_f32_16x16x32_bf16 v[32:35], v[72:75], v[180:183], v[32:35]
    buffer_load_dwordx4 v[152:155], v221, s[56:59], s74 offen sc1
    v_mfma_f32_16x16x32_bf16 v[36:39], v[76:79], v[172:175], v[36:39]
    v_mfma_f32_16x16x32_bf16 v[40:43], v[76:79], v[176:179], v[40:43]
    buffer_load_dwordx4 v[156:159], v222, s[56:59], s74 offen sc1
    s_add_u32 s100, s100, 16384
    s_cmp_eq_u32 s100, 360448
    s_cselect_b32 s100, 196608, s100
    s_add_u32 s74, s100, 4096
    v_mfma_f32_16x16x32_bf16 v[44:47], v[76:79], v[180:183], v[44:47]
    s_waitcnt lgkmcnt(1)
    s_waitcnt vmcnt(6)
    v_mfma_f32_16x16x32_bf16 v[0:3], v[80:83], v[112:115], v[0:3]
    v_cmp_ne_u32 vcc, s3, v251
    v_add_u32 v212, 114688, v208
    v_mfma_f32_16x16x32_bf16 v[4:7], v[80:83], v[116:119], v[4:7]
    v_add_u32 v213, 114688, v209
    v_add_u32 v214, 114688, v210
    v_mfma_f32_16x16x32_bf16 v[8:11], v[80:83], v[120:123], v[8:11]
    s_cbranch_vccnz L_sw_79
L_bk_80:
    v_add_u32 v215, 114688, v211
    v_mfma_f32_16x16x32_bf16 v[12:15], v[84:87], v[112:115], v[12:15]
    ds_read_b128 v[48:51], v212
    v_xor_b32 v216, 32, v212
    v_mfma_f32_16x16x32_bf16 v[16:19], v[84:87], v[116:119], v[16:19]
    ds_read_b128 v[52:55], v213
    v_xor_b32 v217, 32, v213
    v_mfma_f32_16x16x32_bf16 v[20:23], v[84:87], v[120:123], v[20:23]
    ds_read_b128 v[56:59], v214
    v_xor_b32 v218, 32, v214
    v_mfma_f32_16x16x32_bf16 v[24:27], v[88:91], v[112:115], v[24:27]
    ds_read_b128 v[60:63], v215
    v_xor_b32 v219, 32, v215
    v_mfma_f32_16x16x32_bf16 v[28:31], v[88:91], v[116:119], v[28:31]
    ds_read_b128 v[64:67], v216
    v_mfma_f32_16x16x32_bf16 v[32:35], v[88:91], v[120:123], v[32:35]
    ds_read_b128 v[68:71], v217
    v_mfma_f32_16x16x32_bf16 v[36:39], v[92:95], v[112:115], v[36:39]
    ds_read_b128 v[72:75], v218
    v_mfma_f32_16x16x32_bf16 v[40:43], v[92:95], v[116:119], v[40:43]
    ds_read_b128 v[76:79], v219
    v_mfma_f32_16x16x32_bf16 v[44:47], v[92:95], v[120:123], v[44:47]
    ds_read_b32 v251, v249 offset:156
    v_mfma_f32_16x16x32_bf16 v[0:3], v[96:99], v[124:127], v[0:3]
    ds_write_b32 v253, v250 offset:148
    buffer_load_dwordx4 v[160:163], v220, s[56:59], s100 offen sc1
    v_mfma_f32_16x16x32_bf16 v[4:7], v[96:99], v[128:131], v[4:7]
    v_mfma_f32_16x16x32_bf16 v[8:11], v[96:99], v[132:135], v[8:11]
    buffer_load_dwordx4 v[164:167], v221, s[56:59], s100 offen sc1
    v_mfma_f32_16x16x32_bf16 v[12:15], v[100:103], v[124:127], v[12:15]
    v_mfma_f32_16x16x32_bf16 v[16:19], v[100:103], v[128:131], v[16:19]
    buffer_load_dwordx4 v[168:171], v222, s[56:59], s100 offen sc1
    v_mfma_f32_16x16x32_bf16 v[20:23], v[100:103], v[132:135], v[20:23]
    v_mfma_f32_16x16x32_bf16 v[24:27], v[104:107], v[124:127], v[24:27]
    buffer_load_dwordx4 v[172:175], v220, s[56:59], s74 offen sc1
    v_mfma_f32_16x16x32_bf16 v[28:31], v[104:107], v[128:131], v[28:31]
    v_mfma_f32_16x16x32_bf16 v[32:35], v[104:107], v[132:135], v[32:35]
    buffer_load_dwordx4 v[176:179], v221, s[56:59], s74 offen sc1
    v_mfma_f32_16x16x32_bf16 v[36:39], v[108:111], v[124:127], v[36:39]
    v_mfma_f32_16x16x32_bf16 v[40:43], v[108:111], v[128:131], v[40:43]
    buffer_load_dwordx4 v[180:183], v222, s[56:59], s74 offen sc1
    s_add_u32 s100, s100, 16384
    s_cmp_eq_u32 s100, 360448
    s_cselect_b32 s100, 196608, s100
    s_add_u32 s74, s100, 4096
    v_mfma_f32_16x16x32_bf16 v[44:47], v[108:111], v[132:135], v[44:47]
    s_waitcnt lgkmcnt(1)
    s_waitcnt vmcnt(6)
    v_mfma_f32_16x16x32_bf16 v[0:3], v[48:51], v[136:139], v[0:3]
    v_cmp_ne_u32 vcc, s3, v251
    v_add_u32 v212, 131072, v208
    v_mfma_f32_16x16x32_bf16 v[4:7], v[48:51], v[140:143], v[4:7]
    v_add_u32 v213, 131072, v209
    v_add_u32 v214, 131072, v210
    v_mfma_f32_16x16x32_bf16 v[8:11], v[48:51], v[144:147], v[8:11]
    s_cbranch_vccnz L_sw_82
L_bk_83:
    v_add_u32 v215, 131072, v211
    v_mfma_f32_16x16x32_bf16 v[12:15], v[52:55], v[136:139], v[12:15]
    ds_read_b128 v[80:83], v212
    v_xor_b32 v216, 32, v212
    v_mfma_f32_16x16x32_bf16 v[16:19], v[52:55], v[140:143], v[16:19]
    ds_read_b128 v[84:87], v213
    v_xor_b32 v217, 32, v213
    v_mfma_f32_16x16x32_bf16 v[20:23], v[52:55], v[144:147], v[20:23]
    ds_read_b128 v[88:91], v214
    v_xor_b32 v218, 32, v214
    v_mfma_f32_16x16x32_bf16 v[24:27], v[56:59], v[136:139], v[24:27]
    ds_read_b128 v[92:95], v215
    v_xor_b32 v219, 32, v215
    v_mfma_f32_16x16x32_bf16 v[28:31], v[56:59], v[140:143], v[28:31]
    ds_read_b128 v[96:99], v216
    v_mfma_f32_16x16x32_bf16 v[32:35], v[56:59], v[144:147], v[32:35]
    ds_read_b128 v[100:103], v217
    v_mfma_f32_16x16x32_bf16 v[36:39], v[60:63], v[136:139], v[36:39]
    ds_read_b128 v[104:107], v218
    v_mfma_f32_16x16x32_bf16 v[40:43], v[60:63], v[140:143], v[40:43]
    ds_read_b128 v[108:111], v219
    v_mfma_f32_16x16x32_bf16 v[44:47], v[60:63], v[144:147], v[44:47]
    ds_read_b32 v251, v249 offset:160
    v_mfma_f32_16x16x32_bf16 v[0:3], v[64:67], v[148:151], v[0:3]
    ds_write_b32 v253, v250 offset:152
    buffer_load_dwordx4 v[112:115], v220, s[56:59], s100 offen sc1
    v_mfma_f32_16x16x32_bf16 v[4:7], v[64:67], v[152:155], v[4:7]
    v_mfma_f32_16x16x32_bf16 v[8:11], v[64:67], v[156:159], v[8:11]
    buffer_load_dwordx4 v[116:119], v221, s[56:59], s100 offen sc1
    v_mfma_f32_16x16x32_bf16 v[12:15], v[68:71], v[148:151], v[12:15]
    v_mfma_f32_16x16x32_bf16 v[16:19], v[68:71], v[152:155], v[16:19]
    buffer_load_dwordx4 v[120:123], v222, s[56:59], s100 offen sc1
    v_mfma_f32_16x16x32_bf16 v[20:23], v[68:71], v[156:159], v[20:23]
    v_mfma_f32_16x16x32_bf16 v[24:27], v[72:75], v[148:151], v[24:27]
    buffer_load_dwordx4 v[124:127], v220, s[56:59], s74 offen sc1
    v_mfma_f32_16x16x32_bf16 v[28:31], v[72:75], v[152:155], v[28:31]
    v_mfma_f32_16x16x32_bf16 v[32:35], v[72:75], v[156:159], v[32:35]
    buffer_load_dwordx4 v[128:131], v221, s[56:59], s74 offen sc1
    v_mfma_f32_16x16x32_bf16 v[36:39], v[76:79], v[148:151], v[36:39]
    v_mfma_f32_16x16x32_bf16 v[40:43], v[76:79], v[152:155], v[40:43]
    buffer_load_dwordx4 v[132:135], v222, s[56:59], s74 offen sc1
    s_add_u32 s100, s100, 16384
    s_cmp_eq_u32 s100, 360448
    s_cselect_b32 s100, 196608, s100
    s_add_u32 s74, s100, 4096
    v_mfma_f32_16x16x32_bf16 v[44:47], v[76:79], v[156:159], v[44:47]
    s_waitcnt lgkmcnt(1)
    s_waitcnt vmcnt(6)
    v_mfma_f32_16x16x32_bf16 v[0:3], v[80:83], v[160:163], v[0:3]
    v_cmp_ne_u32 vcc, s3, v251
    v_add_u32 v212, 0, v208
    v_mfma_f32_16x16x32_bf16 v[4:7], v[80:83], v[164:167], v[4:7]
    v_add_u32 v213, 0, v209
    v_add_u32 v214, 0, v210
    v_mfma_f32_16x16x32_bf16 v[8:11], v[80:83], v[168:171], v[8:11]
    s_cbranch_vccnz L_sw_85
L_bk_86:
    v_add_u32 v215, 0, v211
    v_mfma_f32_16x16x32_bf16 v[12:15], v[84:87], v[160:163], v[12:15]
    ds_read_b128 v[48:51], v212
    v_xor_b32 v216, 32, v212
    v_mfma_f32_16x16x32_bf16 v[16:19], v[84:87], v[164:167], v[16:19]
    ds_read_b128 v[52:55], v213
    v_xor_b32 v217, 32, v213
    v_mfma_f32_16x16x32_bf16 v[20:23], v[84:87], v[168:171], v[20:23]
    ds_read_b128 v[56:59], v214
    v_xor_b32 v218, 32, v214
    v_mfma_f32_16x16x32_bf16 v[24:27], v[88:91], v[160:163], v[24:27]
    ds_read_b128 v[60:63], v215
    v_xor_b32 v219, 32, v215
    v_mfma_f32_16x16x32_bf16 v[28:31], v[88:91], v[164:167], v[28:31]
    ds_read_b128 v[64:67], v216
    v_mfma_f32_16x16x32_bf16 v[32:35], v[88:91], v[168:171], v[32:35]
    ds_read_b128 v[68:71], v217
    v_mfma_f32_16x16x32_bf16 v[36:39], v[92:95], v[160:163], v[36:39]
    ds_read_b128 v[72:75], v218
    v_mfma_f32_16x16x32_bf16 v[40:43], v[92:95], v[164:167], v[40:43]
    ds_read_b128 v[76:79], v219
    v_mfma_f32_16x16x32_bf16 v[44:47], v[92:95], v[168:171], v[44:47]
    ds_read_b32 v251, v249 offset:164
    v_mfma_f32_16x16x32_bf16 v[0:3], v[96:99], v[172:175], v[0:3]
    ds_write_b32 v253, v250 offset:156
    buffer_load_dwordx4 v[136:139], v220, s[56:59], s100 offen sc1
    v_mfma_f32_16x16x32_bf16 v[4:7], v[96:99], v[176:179], v[4:7]
    v_mfma_f32_16x16x32_bf16 v[8:11], v[96:99], v[180:183], v[8:11]
    buffer_load_dwordx4 v[140:143], v221, s[56:59], s100 offen sc1
    v_mfma_f32_16x16x32_bf16 v[12:15], v[100:103], v[172:175], v[12:15]
    v_mfma_f32_16x16x32_bf16 v[16:19], v[100:103], v[176:179], v[16:19]
    buffer_load_dwordx4 v[144:147], v222, s[56:59], s100 offen sc1
    v_mfma_f32_16x16x32_bf16 v[20:23], v[100:103], v[180:183], v[20:23]
    v_mfma_f32_16x16x32_bf16 v[24:27], v[104:107], v[172:175], v[24:27]
    buffer_load_dwordx4 v[148:151], v220, s[56:59], s74 offen sc1
    v_mfma_f32_16x16x32_bf16 v[28:31], v[104:107], v[176:179], v[28:31]
    v_mfma_f32_16x16x32_bf16 v[32:35], v[104:107], v[180:183], v[32:35]
    buffer_load_dwordx4 v[152:155], v221, s[56:59], s74 offen sc1
    v_mfma_f32_16x16x32_bf16 v[36:39], v[108:111], v[172:175], v[36:39]
    v_mfma_f32_16x16x32_bf16 v[40:43], v[108:111], v[176:179], v[40:43]
    buffer_load_dwordx4 v[156:159], v222, s[56:59], s74 offen sc1
    s_add_u32 s100, s100, 16384
    s_cmp_eq_u32 s100, 360448
    s_cselect_b32 s100, 196608, s100
    s_add_u32 s74, s100, 4096
    v_mfma_f32_16x16x32_bf16 v[44:47], v[108:111], v[180:183], v[44:47]
    s_waitcnt lgkmcnt(1)
    s_waitcnt vmcnt(6)
    v_mfma_f32_16x16x32_bf16 v[0:3], v[48:51], v[112:115], v[0:3]
    v_cmp_ne_u32 vcc, s3, v251
    v_add_u32 v212, 16384, v208
    v_mfma_f32_16x16x32_bf16 v[4:7], v[48:51], v[116:119], v[4:7]
    v_add_u32 v213, 16384, v209
    v_add_u32 v214, 16384, v210
    v_mfma_f32_16x16x32_bf16 v[8:11], v[48:51], v[120:123], v[8:11]
    s_cbranch_vccnz L_sw_88
L_bk_89:
    v_add_u32 v215, 16384, v211
    v_mfma_f32_16x16x32_bf16 v[12:15], v[52:55], v[112:115], v[12:15]
    ds_read_b128 v[80:83], v212
    v_xor_b32 v216, 32, v212
    v_mfma_f32_16x16x32_bf16 v[16:19], v[52:55], v[116:119], v[16:19]
    ds_read_b128 v[84:87], v213
    v_xor_b32 v217, 32, v213
    v_mfma_f32_16x16x32_bf16 v[20:23], v[52:55], v[120:123], v[20:23]
    ds_read_b128 v[88:91], v214
    v_xor_b32 v218, 32, v214
    v_mfma_f32_16x16x32_bf16 v[24:27], v[56:59], v[112:115], v[24:27]
    ds_read_b128 v[92:95], v215
    v_xor_b32 v219, 32, v215
    v_mfma_f32_16x16x32_bf16 v[28:31], v[56:59], v[116:119], v[28:31]
    ds_read_b128 v[96:99], v216
    v_mfma_f32_16x16x32_bf16 v[32:35], v[56:59], v[120:123], v[32:35]
    ds_read_b128 v[100:103], v217
    v_mfma_f32_16x16x32_bf16 v[36:39], v[60:63], v[112:115], v[36:39]
    ds_read_b128 v[104:107], v218
    v_mfma_f32_16x16x32_bf16 v[40:43], v[60:63], v[116:119], v[40:43]
    ds_read_b128 v[108:111], v219
    v_mfma_f32_16x16x32_bf16 v[44:47], v[60:63], v[120:123], v[44:47]
    ds_read_b32 v251, v249 offset:168
    v_mfma_f32_16x16x32_bf16 v[0:3], v[64:67], v[124:127], v[0:3]
    ds_write_b32 v253, v250 offset:160
    buffer_load_dwordx4 v[160:163], v220, s[56:59], s100 offen sc1
    v_mfma_f32_16x16x32_bf16 v[4:7], v[64:67], v[128:131], v[4:7]
    v_mfma_f32_16x16x32_bf16 v[8:11], v[64:67], v[132:135], v[8:11]
    buffer_load_dwordx4 v[164:167], v221, s[56:59], s100 offen sc1
    v_mfma_f32_16x16x32_bf16 v[12:15], v[68:71], v[124:127], v[12:15]
    v_mfma_f32_16x16x32_bf16 v[16:19], v[68:71], v[128:131], v[16:19]
    buffer_load_dwordx4 v[168:171], v222, s[56:59], s100 offen sc1
    v_mfma_f32_16x16x32_bf16 v[20:23], v[68:71], v[132:135], v[20:23]
    v_mfma_f32_16x16x32_bf16 v[24:27], v[72:75], v[124:127], v[24:27]
    buffer_load_dwordx4 v[172:175], v220, s[56:59], s74 offen sc1
    v_mfma_f32_16x16x32_bf16 v[28:31], v[72:75], v[128:131], v[28:31]
    v_mfma_f32_16x16x32_bf16 v[32:35], v[72:75], v[132:135], v[32:35]
    buffer_load_dwordx4 v[176:179], v221, s[56:59], s74 offen sc1
    v_mfma_f32_16x16x32_bf16 v[36:39], v[76:79], v[124:127], v[36:39]
    v_mfma_f32_16x16x32_bf16 v[40:43], v[76:79], v[128:131], v[40:43]
    buffer_load_dwordx4 v[180:183], v222, s[56:59], s74 offen sc1
    s_add_u32 s100, s100, 16384
    s_cmp_eq_u32 s100, 360448
    s_cselect_b32 s100, 196608, s100
    s_add_u32 s74, s100, 4096
    v_mfma_f32_16x16x32_bf16 v[44:47], v[76:79], v[132:135], v[44:47]
    s_waitcnt lgkmcnt(1)
    s_waitcnt vmcnt(6)
    v_mfma_f32_16x16x32_bf16 v[0:3], v[80:83], v[136:139], v[0:3]
    v_cmp_ne_u32 vcc, s3, v251
    v_add_u32 v212, 32768, v208
    v_mfma_f32_16x16x32_bf16 v[4:7], v[80:83], v[140:143], v[4:7]
    v_add_u32 v213, 32768, v209
    v_add_u32 v214, 32768, v210
    v_mfma_f32_16x16x32_bf16 v[8:11], v[80:83], v[144:147], v[8:11]
    s_cbranch_vccnz L_sw_91
L_bk_92:
    v_add_u32 v215, 32768, v211
    v_mfma_f32_16x16x32_bf16 v[12:15], v[84:87], v[136:139], v[12:15]
    ds_read_b128 v[48:51], v212
    v_xor_b32 v216, 32, v212
    v_mfma_f32_16x16x32_bf16 v[16:19], v[84:87], v[140:143], v[16:19]
    ds_read_b128 v[52:55], v213
    v_xor_b32 v217, 32, v213
    v_mfma_f32_16x16x32_bf16 v[20:23], v[84:87], v[144:147], v[20:23]
    ds_read_b128 v[56:59], v214
    v_xor_b32 v218, 32, v214
    v_mfma_f32_16x16x32_bf16 v[24:27], v[88:91], v[136:139], v[24:27]
    ds_read_b128 v[60:63], v215
    v_xor_b32 v219, 32, v215
    v_mfma_f32_16x16x32_bf16 v[28:31], v[88:91], v[140:143], v[28:31]
    ds_read_b128 v[64:67], v216
    v_mfma_f32_16x16x32_bf16 v[32:35], v[88:91], v[144:147], v[32:35]
    ds_read_b128 v[68:71], v217
    v_mfma_f32_16x16x32_bf16 v[36:39], v[92:95], v[136:139], v[36:39]
    ds_read_b128 v[72:75], v218
    v_mfma_f32_16x16x32_bf16 v[40:43], v[92:95], v[140:143], v[40:43]
    ds_read_b128 v[76:79], v219
    v_mfma_f32_16x16x32_bf16 v[44:47], v[92:95], v[144:147], v[44:47]
    ds_read_b32 v251, v249 offset:172
    v_mfma_f32_16x16x32_bf16 v[0:3], v[96:99], v[148:151], v[0:3]
    ds_write_b32 v253, v250 offset:164
    buffer_load_dwordx4 v[112:115], v220, s[56:59], s100 offen sc1
    v_mfma_f32_16x16x32_bf16 v[4:7], v[96:99], v[152:155], v[4:7]
    v_mfma_f32_16x16x32_bf16 v[8:11], v[96:99], v[156:159], v[8:11]
    buffer_load_dwordx4 v[116:119], v221, s[56:59], s100 offen sc1
    v_mfma_f32_16x16x32_bf16 v[12:15], v[100:103], v[148:151], v[12:15]
    v_mfma_f32_16x16x32_bf16 v[16:19], v[100:103], v[152:155], v[16:19]
    buffer_load_dwordx4 v[120:123], v222, s[56:59], s100 offen sc1
    v_mfma_f32_16x16x32_bf16 v[20:23], v[100:103], v[156:159], v[20:23]
    v_mfma_f32_16x16x32_bf16 v[24:27], v[104:107], v[148:151], v[24:27]
    buffer_load_dwordx4 v[124:127], v220, s[56:59], s74 offen sc1
    v_mfma_f32_16x16x32_bf16 v[28:31], v[104:107], v[152:155], v[28:31]
    v_mfma_f32_16x16x32_bf16 v[32:35], v[104:107], v[156:159], v[32:35]
    buffer_load_dwordx4 v[128:131], v221, s[56:59], s74 offen sc1
    v_mfma_f32_16x16x32_bf16 v[36:39], v[108:111], v[148:151], v[36:39]
    v_mfma_f32_16x16x32_bf16 v[40:43], v[108:111], v[152:155], v[40:43]
    buffer_load_dwordx4 v[132:135], v222, s[56:59], s74 offen sc1
    v_mfma_f32_16x16x32_bf16 v[44:47], v[108:111], v[156:159], v[44:47]
    s_waitcnt lgkmcnt(1)
    s_waitcnt vmcnt(6)
    v_mfma_f32_16x16x32_bf16 v[0:3], v[48:51], v[160:163], v[0:3]
    v_cmp_ne_u32 vcc, s3, v251
    v_add_u32 v212, 49152, v208
    v_mfma_f32_16x16x32_bf16 v[4:7], v[48:51], v[164:167], v[4:7]
    v_add_u32 v213, 49152, v209
    v_add_u32 v214, 49152, v210
    v_mfma_f32_16x16x32_bf16 v[8:11], v[48:51], v[168:171], v[8:11]
    s_cbranch_vccnz L_sw_94
L_bk_95:
    v_add_u32 v215, 49152, v211
    v_mfma_f32_16x16x32_bf16 v[12:15], v[52:55], v[160:163], v[12:15]
    ds_read_b128 v[80:83], v212
    v_xor_b32 v216, 32, v212
    v_mfma_f32_16x16x32_bf16 v[16:19], v[52:55], v[164:167], v[16:19]
    ds_read_b128 v[84:87], v213
    v_xor_b32 v217, 32, v213
    v_mfma_f32_16x16x32_bf16 v[20:23], v[52:55], v[168:171], v[20:23]
    ds_read_b128 v[88:91], v214
    v_xor_b32 v218, 32, v214
    v_mfma_f32_16x16x32_bf16 v[24:27], v[56:59], v[160:163], v[24:27]
    ds_read_b128 v[92:95], v215
    v_xor_b32 v219, 32, v215
    v_mfma_f32_16x16x32_bf16 v[28:31], v[56:59], v[164:167], v[28:31]
    ds_read_b128 v[96:99], v216
    v_mfma_f32_16x16x32_bf16 v[32:35], v[56:59], v[168:171], v[32:35]
    ds_read_b128 v[100:103], v217
    v_mfma_f32_16x16x32_bf16 v[36:39], v[60:63], v[160:163], v[36:39]
    ds_read_b128 v[104:107], v218
    v_mfma_f32_16x16x32_bf16 v[40:43], v[60:63], v[164:167], v[40:43]
    ds_read_b128 v[108:111], v219
    v_mfma_f32_16x16x32_bf16 v[44:47], v[60:63], v[168:171], v[44:47]
    ds_write_b32 v253, v250 offset:168
    v_mfma_f32_16x16x32_bf16 v[0:3], v[64:67], v[172:175], v[0:3]
    v_mfma_f32_16x16x32_bf16 v[4:7], v[64:67], v[176:179], v[4:7]
    v_mfma_f32_16x16x32_bf16 v[8:11], v[64:67], v[180:183], v[8:11]
    v_mfma_f32_16x16x32_bf16 v[12:15], v[68:71], v[172:175], v[12:15]
    v_mfma_f32_16x16x32_bf16 v[16:19], v[68:71], v[176:179], v[16:19]
    v_mfma_f32_16x16x32_bf16 v[20:23], v[68:71], v[180:183], v[20:23]
    v_mfma_f32_16x16x32_bf16 v[24:27], v[72:75], v[172:175], v[24:27]
    v_mfma_f32_16x16x32_bf16 v[28:31], v[72:75], v[176:179], v[28:31]
    v_mfma_f32_16x16x32_bf16 v[32:35], v[72:75], v[180:183], v[32:35]
    v_mfma_f32_16x16x32_bf16 v[36:39], v[76:79], v[172:175], v[36:39]
    v_mfma_f32_16x16x32_bf16 v[40:43], v[76:79], v[176:179], v[40:43]
    v_mfma_f32_16x16x32_bf16 v[44:47], v[76:79], v[180:183], v[44:47]
    s_waitcnt lgkmcnt(1)
    s_waitcnt vmcnt(0)
    v_mfma_f32_16x16x32_bf16 v[0:3], v[80:83], v[112:115], v[0:3]
    ds_read_b32 v251, v249 offset:2192
    v_lshlrev_b32 v212, 4, v254
    v_mfma_f32_16x16x32_bf16 v[4:7], v[80:83], v[116:119], v[4:7]
    s_mul_i32 s70, s65, 6144
    s_add_u32 s70, s70, 65536
    v_mfma_f32_16x16x32_bf16 v[8:11], v[80:83], v[120:123], v[8:11]
    v_add_u32 v213, s70, v212
    s_xor_b32 s71, s65, 2
    v_mfma_f32_16x16x32_bf16 v[12:15], v[84:87], v[112:115], v[12:15]
    s_mul_i32 s70, s71, 6144
    s_add_u32 s70, s70, 65536
    v_mfma_f32_16x16x32_bf16 v[16:19], v[84:87], v[116:119], v[16:19]
    v_add_u32 v212, s70, v212
    s_lshl_b32 s71, s71, 9
    v_mfma_f32_16x16x32_bf16 v[20:23], v[84:87], v[120:123], v[20:23]
    s_add_u32 s71, s71, 159996
    v_mov_b32 v214, s71
    v_mfma_f32_16x16x32_bf16 v[24:27], v[88:91], v[112:115], v[24:27]
    v_mfma_f32_16x16x32_bf16 v[28:31], v[88:91], v[116:119], v[28:31]
    v_mfma_f32_16x16x32_bf16 v[32:35], v[88:91], v[120:123], v[32:35]
    v_mfma_f32_16x16x32_bf16 v[36:39], v[92:95], v[112:115], v[36:39]
    v_mfma_f32_16x16x32_bf16 v[40:43], v[92:95], v[116:119], v[40:43]
    v_mfma_f32_16x16x32_bf16 v[44:47], v[92:95], v[120:123], v[44:47]
    v_mfma_f32_16x16x32_bf16 v[0:3], v[96:99], v[124:127], v[0:3]
    v_mfma_f32_16x16x32_bf16 v[4:7], v[96:99], v[128:131], v[4:7]
    v_mfma_f32_16x16x32_bf16 v[8:11], v[96:99], v[132:135], v[8:11]
    v_mfma_f32_16x16x32_bf16 v[12:15], v[100:103], v[124:127], v[12:15]
    v_mfma_f32_16x16x32_bf16 v[16:19], v[100:103], v[128:131], v[16:19]
    v_mfma_f32_16x16x32_bf16 v[20:23], v[100:103], v[132:135], v[20:23]
    v_mfma_f32_16x16x32_bf16 v[24:27], v[104:107], v[124:127], v[24:27]
    v_mfma_f32_16x16x32_bf16 v[28:31], v[104:107], v[128:131], v[28:31]
    v_mfma_f32_16x16x32_bf16 v[32:35], v[104:107], v[132:135], v[32:35]
    v_mfma_f32_16x16x32_bf16 v[36:39], v[108:111], v[124:127], v[36:39]
    v_mfma_f32_16x16x32_bf16 v[40:43], v[108:111], v[128:131], v[40:43]
    v_mfma_f32_16x16x32_bf16 v[44:47], v[108:111], v[132:135], v[44:47]
    s_waitcnt lgkmcnt(0)
    v_cmp_ne_u32 vcc, s3, v251
    s_cbranch_vccnz L_sw_97
L_bk_98:
    s_nop 4
    ds_write_b128 v213, v[24:27] offset:0
    ds_write_b128 v213, v[28:31] offset:1024
    ds_write_b128 v213, v[32:35] offset:2048
    ds_write_b128 v213, v[36:39] offset:3072
    ds_write_b128 v213, v[40:43] offset:4096
    ds_write_b128 v213, v[44:47] offset:5120
    ds_write_b32 v253, v250 offset:176
    ds_read_b32 v251, v214 offset:176
    s_waitcnt lgkmcnt(0)
    v_cmp_ne_u32 vcc, s3, v251
    s_cbranch_vccnz L_sw_100
L_bk_101:
    ds_read_b128 v[24:27], v212 offset:0
    ds_read_b128 v[28:31], v212 offset:1024
    ds_read_b128 v[32:35], v212 offset:2048
    ds_read_b128 v[36:39], v212 offset:3072
    ds_read_b128 v[40:43], v212 offset:4096
    ds_read_b128 v[44:47], v212 offset:5120
    s_waitcnt lgkmcnt(0)
    v_pk_add_f32 v[0:1], v[0:1], v[24:25]
    v_pk_add_f32 v[2:3], v[2:3], v[26:27]
    global_store_dwordx4 v199, v[0:3], s[30:31] offset:0 nt
    v_pk_add_f32 v[12:13], v[12:13], v[36:37]
    v_pk_add_f32 v[14:15], v[14:15], v[38:39]
    global_store_dwordx4 v199, v[12:15], s[30:31] offset:64 nt
    v_add_u32 v199, 40960, v199
    v_pk_add_f32 v[4:5], v[4:5], v[28:29]
    v_pk_add_f32 v[6:7], v[6:7], v[30:31]
    global_store_dwordx4 v199, v[4:7], s[30:31] offset:0 nt
    v_pk_add_f32 v[16:17], v[16:17], v[40:41]
    v_pk_add_f32 v[18:19], v[18:19], v[42:43]
    global_store_dwordx4 v199, v[16:19], s[30:31] offset:64 nt
    v_add_u32 v199, 40960, v199
    v_pk_add_f32 v[8:9], v[8:9], v[32:33]
    v_pk_add_f32 v[10:11], v[10:11], v[34:35]
    global_store_dwordx4 v199, v[8:11], s[30:31] offset:0 nt
    v_pk_add_f32 v[20:21], v[20:21], v[44:45]
    v_pk_add_f32 v[22:23], v[22:23], v[46:47]
    global_store_dwordx4 v199, v[20:23], s[30:31] offset:64 nt
    s_endpgm
L_sw_1:
L_sr_3:
    ds_read_b32 v250, v248 offset:4
    s_waitcnt lgkmcnt(0)
    v_cmp_ne_u32 vcc, s3, v250
    s_cbranch_vccz L_bk_2
    s_sub_u32 s94, s94, 1
    s_cmp_lg_u32 s94, 0
    s_cbranch_scc1 L_sr_3
    s_mov_b32 s94, 1
    s_branch L_bk_2
L_sw_4:
L_sr_6:
    ds_read_b32 v250, v248 offset:0
    s_waitcnt lgkmcnt(0)
    v_cmp_ne_u32 vcc, s3, v250
    s_cbranch_vccz L_bk_5
    s_sub_u32 s94, s94, 1
    s_cmp_lg_u32 s94, 0
    s_cbranch_scc1 L_sr_6
    s_mov_b32 s94, 1
    s_branch L_bk_5
L_sw_7:
L_sr_9:
    ds_read_b32 v250, v248 offset:0
    s_waitcnt lgkmcnt(0)
    v_cmp_ne_u32 vcc, s3, v250
    s_cbranch_vccz L_bk_8
    s_sub_u32 s94, s94, 1
    s_cmp_lg_u32 s94, 0
    s_cbranch_scc1 L_sr_9
    s_mov_b32 s94, 1
    s_branch L_bk_8
L_sw_21:
L_sr_23:
    ds_read_b32 v251, v249 offset:88
    s_waitcnt lgkmcnt(0)
    v_cmp_ne_u32 vcc, s3, v251
    s_cbranch_vccz L_bk_22
    s_sub_u32 s94, s94, 1
    s_cmp_lg_u32 s94, 0
    s_cbranch_scc1 L_sr_23
    s_mov_b32 s94, 1
    s_branch L_bk_22
L_sw_26:
L_sr_28:
    ds_read_b32 v251, v249 offset:92
    s_waitcnt lgkmcnt(0)
    v_cmp_ne_u32 vcc, s3, v251
    s_cbranch_vccz L_bk_27
    s_sub_u32 s94, s94, 1
    s_cmp_lg_u32 s94, 0
    s_cbranch_scc1 L_sr_28
    s_mov_b32 s94, 1
    s_branch L_bk_27
L_sw_29:
L_sr_31:
    ds_read_b32 v251, v249 offset:96
    s_waitcnt lgkmcnt(0)
    v_cmp_ne_u32 vcc, s3, v251
    s_cbranch_vccz L_bk_30
    s_sub_u32 s94, s94, 1
    s_cmp_lg_u32 s94, 0
    s_cbranch_scc1 L_sr_31
    s_mov_b32 s94, 1
    s_branch L_bk_30
L_sw_32:
L_sr_34:
    ds_read_b32 v251, v249 offset:100
    s_waitcnt lgkmcnt(0)
    v_cmp_ne_u32 vcc, s3, v251
    s_cbranch_vccz L_bk_33
    s_sub_u32 s94, s94, 1
    s_cmp_lg_u32 s94, 0
    s_cbranch_scc1 L_sr_34
    s_mov_b32 s94, 1
    s_branch L_bk_33
L_sw_35:
L_sr_37:
    ds_read_b32 v251, v249 offset:104
    s_waitcnt lgkmcnt(0)
    v_cmp_ne_u32 vcc, s3, v251
    s_cbranch_vccz L_bk_36
    s_sub_u32 s94, s94, 1
    s_cmp_lg_u32 s94, 0
    s_cbranch_scc1 L_sr_37
    s_mov_b32 s94, 1
    s_branch L_bk_36
L_sw_38:
L_sr_40:
    ds_read_b32 v251, v249 offset:108
    s_waitcnt lgkmcnt(0)
    v_cmp_ne_u32 vcc, s3, v251
    s_cbranch_vccz L_bk_39
    s_sub_u32 s94, s94, 1
    s_cmp_lg_u32 s94, 0
    s_cbranch_scc1 L_sr_40
    s_mov_b32 s94, 1
    s_branch L_bk_39
L_sw_41:
L_sr_43:
    ds_read_b32 v251, v249 offset:112
    s_waitcnt lgkmcnt(0)
    v_cmp_ne_u32 vcc, s3, v251
    s_cbranch_vccz L_bk_42
    s_sub_u32 s94, s94, 1
    s_cmp_lg_u32 s94, 0
    s_cbranch_scc1 L_sr_43
    s_mov_b32 s94, 1
    s_branch L_bk_42
L_sw_44:
L_sr_46:
    ds_read_b32 v251, v249 offset:116
    s_waitcnt lgkmcnt(0)
    v_cmp_ne_u32 vcc, s3, v251
    s_cbranch_vccz L_bk_45
    s_sub_u32 s94, s94, 1
    s_cmp_lg_u32 s94, 0
    s_cbranch_scc1 L_sr_46
    s_mov_b32 s94, 1
    s_branch L_bk_45
L_sw_47:
L_sr_49:
    ds_read_b32 v251, v249 offset:120
    s_waitcnt lgkmcnt(0)
    v_cmp_ne_u32 vcc, s3, v251
    s_cbranch_vccz L_bk_48
    s_sub_u32 s94, s94, 1
    s_cmp_lg_u32 s94, 0
    s_cbranch_scc1 L_sr_49
    s_mov_b32 s94, 1
    s_branch L_bk_48
L_sw_50:
L_sr_52:
    ds_read_b32 v251, v249 offset:124
    s_waitcnt lgkmcnt(0)
    v_cmp_ne_u32 vcc, s3, v251
    s_cbranch_vccz L_bk_51
    s_sub_u32 s94, s94, 1
    s_cmp_lg_u32 s94, 0
    s_cbranch_scc1 L_sr_52
    s_mov_b32 s94, 1
    s_branch L_bk_51
L_sw_53:
L_sr_55:
    ds_read_b32 v251, v249 offset:128
    s_waitcnt lgkmcnt(0)
    v_cmp_ne_u32 vcc, s3, v251
    s_cbranch_vccz L_bk_54
    s_sub_u32 s94, s94, 1
    s_cmp_lg_u32 s94, 0
    s_cbranch_scc1 L_sr_55
    s_mov_b32 s94, 1
    s_branch L_bk_54
L_sw_56:
L_sr_58:
    ds_read_b32 v251, v249 offset:132
    s_waitcnt lgkmcnt(0)
    v_cmp_ne_u32 vcc, s3, v251
    s_cbranch_vccz L_bk_57
    s_sub_u32 s94, s94, 1
    s_cmp_lg_u32 s94, 0
    s_cbranch_scc1 L_sr_58
    s_mov_b32 s94, 1
    s_branch L_bk_57
L_sw_59:
L_sr_61:
    ds_read_b32 v251, v249 offset:136
    s_waitcnt lgkmcnt(0)
    v_cmp_ne_u32 vcc, s3, v251
    s_cbranch_vccz L_bk_60
    s_sub_u32 s94, s94, 1
    s_cmp_lg_u32 s94, 0
    s_cbranch_scc1 L_sr_61
    s_mov_b32 s94, 1
    s_branch L_bk_60
L_late_24:
    s_waitcnt lgkmcnt(1)
    s_waitcnt vmcnt(6)
    v_mfma_f32_16x16x32_bf16 v[0:3], v[48:51], v[136:139], v[0:3]
    v_cmp_ne_u32 vcc, s3, v251
    v_add_u32 v212, 32768, v204
    v_mfma_f32_16x16x32_bf16 v[4:7], v[48:51], v[140:143], v[4:7]
    v_add_u32 v213, 32768, v205
    v_add_u32 v214, 32768, v206
    v_mfma_f32_16x16x32_bf16 v[8:11], v[48:51], v[144:147], v[8:11]
    s_cbranch_vccnz L_sw_56
L_bk_57:
    v_add_u32 v215, 32768, v207
    v_mfma_f32_16x16x32_bf16 v[12:15], v[52:55], v[136:139], v[12:15]
    ds_read_b64_tr_b16 v[80:81], v212 offset:0
    ds_read_b64_tr_b16 v[82:83], v212 offset:2048
    v_mfma_f32_16x16x32_bf16 v[16:19], v[52:55], v[140:143], v[16:19]
    ds_read_b64_tr_b16 v[84:85], v213 offset:0
    ds_read_b64_tr_b16 v[86:87], v213 offset:2048
    v_mfma_f32_16x16x32_bf16 v[20:23], v[52:55], v[144:147], v[20:23]
    ds_read_b64_tr_b16 v[88:89], v214 offset:0
    ds_read_b64_tr_b16 v[90:91], v214 offset:2048
    v_mfma_f32_16x16x32_bf16 v[24:27], v[56:59], v[136:139], v[24:27]
    ds_read_b64_tr_b16 v[92:93], v215 offset:0
    ds_read_b64_tr_b16 v[94:95], v215 offset:2048
    v_mfma_f32_16x16x32_bf16 v[28:31], v[56:59], v[140:143], v[28:31]
    ds_read_b64_tr_b16 v[96:97], v212 offset:4096
    ds_read_b64_tr_b16 v[98:99], v212 offset:6144
    v_mfma_f32_16x16x32_bf16 v[32:35], v[56:59], v[144:147], v[32:35]
    ds_read_b64_tr_b16 v[100:101], v213 offset:4096
    ds_read_b64_tr_b16 v[102:103], v213 offset:6144
    v_mfma_f32_16x16x32_bf16 v[36:39], v[60:63], v[136:139], v[36:39]
    ds_read_b64_tr_b16 v[104:105], v214 offset:4096
    ds_read_b64_tr_b16 v[106:107], v214 offset:6144
    v_mfma_f32_16x16x32_bf16 v[40:43], v[60:63], v[140:143], v[40:43]
    ds_read_b64_tr_b16 v[108:109], v215 offset:4096
    ds_read_b64_tr_b16 v[110:111], v215 offset:6144
    v_mfma_f32_16x16x32_bf16 v[44:47], v[60:63], v[144:147], v[44:47]
    ds_read_b32 v251, v249 offset:136
    v_mfma_f32_16x16x32_bf16 v[0:3], v[64:67], v[148:151], v[0:3]
    ds_write_b32 v253, v250 offset:128
    v_mfma_f32_16x16x32_bf16 v[4:7], v[64:67], v[152:155], v[4:7]
    v_mfma_f32_16x16x32_bf16 v[8:11], v[64:67], v[156:159], v[8:11]
    v_mfma_f32_16x16x32_bf16 v[12:15], v[68:71], v[148:151], v[12:15]
    v_mfma_f32_16x16x32_bf16 v[16:19], v[68:71], v[152:155], v[16:19]
    v_mfma_f32_16x16x32_bf16 v[20:23], v[68:71], v[156:159], v[20:23]
    v_mfma_f32_16x16x32_bf16 v[24:27], v[72:75], v[148:151], v[24:27]
    v_mfma_f32_16x16x32_bf16 v[28:31], v[72:75], v[152:155], v[28:31]
    v_mfma_f32_16x16x32_bf16 v[32:35], v[72:75], v[156:159], v[32:35]
    v_mfma_f32_16x16x32_bf16 v[36:39], v[76:79], v[148:151], v[36:39]
    v_mfma_f32_16x16x32_bf16 v[40:43], v[76:79], v[152:155], v[40:43]
    v_mfma_f32_16x16x32_bf16 v[44:47], v[76:79], v[156:159], v[44:47]
    s_waitcnt lgkmcnt(1)
    s_waitcnt vmcnt(0)
    v_mfma_f32_16x16x32_bf16 v[0:3], v[80:83], v[160:163], v[0:3]
    v_cmp_ne_u32 vcc, s3, v251
    v_add_u32 v212, 49152, v208
    v_mfma_f32_16x16x32_bf16 v[4:7], v[80:83], v[164:167], v[4:7]
    v_add_u32 v213, 49152, v209
    v_add_u32 v214, 49152, v210
    v_mfma_f32_16x16x32_bf16 v[8:11], v[80:83], v[168:171], v[8:11]
    s_cbranch_vccnz L_sw_59
L_bk_60:
    v_add_u32 v215, 49152, v211
    v_mfma_f32_16x16x32_bf16 v[12:15], v[84:87], v[160:163], v[12:15]
    ds_read_b128 v[48:51], v212
    v_xor_b32 v216, 32, v212
    v_mfma_f32_16x16x32_bf16 v[16:19], v[84:87], v[164:167], v[16:19]
    ds_read_b128 v[52:55], v213
    v_xor_b32 v217, 32, v213
    v_mfma_f32_16x16x32_bf16 v[20:23], v[84:87], v[168:171], v[20:23]
    ds_read_b128 v[56:59], v214
    v_xor_b32 v218, 32, v214
    v_mfma_f32_16x16x32_bf16 v[24:27], v[88:91], v[160:163], v[24:27]
    ds_read_b128 v[60:63], v215
    v_xor_b32 v219, 32, v215
    v_mfma_f32_16x16x32_bf16 v[28:31], v[88:91], v[164:167], v[28:31]
    ds_read_b128 v[64:67], v216
    v_mfma_f32_16x16x32_bf16 v[32:35], v[88:91], v[168:171], v[32:35]
    ds_read_b128 v[68:71], v217
    v_mfma_f32_16x16x32_bf16 v[36:39], v[92:95], v[160:163], v[36:39]
    ds_read_b128 v[72:75], v218
    v_mfma_f32_16x16x32_bf16 v[40:43], v[92:95], v[164:167], v[40:43]
    ds_read_b128 v[76:79], v219
    v_mfma_f32_16x16x32_bf16 v[44:47], v[92:95], v[168:171], v[44:47]
    ds_read_b32 v251, v249 offset:140
    v_mfma_f32_16x16x32_bf16 v[0:3], v[96:99], v[172:175], v[0:3]
    ds_write_b32 v253, v250 offset:132
    v_mfma_f32_16x16x32_bf16 v[4:7], v[96:99], v[176:179], v[4:7]
    v_mfma_f32_16x16x32_bf16 v[8:11], v[96:99], v[180:183], v[8:11]
    v_mfma_f32_16x16x32_bf16 v[12:15], v[100:103], v[172:175], v[12:15]
    v_mfma_f32_16x16x32_bf16 v[16:19], v[100:103], v[176:179], v[16:19]
    v_mfma_f32_16x16x32_bf16 v[20:23], v[100:103], v[180:183], v[20:23]
    v_mfma_f32_16x16x32_bf16 v[24:27], v[104:107], v[172:175], v[24:27]
    v_mfma_f32_16x16x32_bf16 v[28:31], v[104:107], v[176:179], v[28:31]
    v_mfma_f32_16x16x32_bf16 v[32:35], v[104:107], v[180:183], v[32:35]
    v_mfma_f32_16x16x32_bf16 v[36:39], v[108:111], v[172:175], v[36:39]
    v_mfma_f32_16x16x32_bf16 v[40:43], v[108:111], v[176:179], v[40:43]
    v_mfma_f32_16x16x32_bf16 v[44:47], v[108:111], v[180:183], v[44:47]
L_fs_62:
    ds_read_b32 v223, v248
    s_waitcnt lgkmcnt(0)
    v_cmp_le_u32 vcc, 3, v223
    s_cbranch_vccnz L_fs_63
    s_sleep 1
    s_sub_u32 s94, s94, 1
    s_cmp_lg_u32 s94, 0
    s_cbranch_scc1 L_fs_62
    s_mov_b32 s94, 1
L_fs_63:
    buffer_load_dwordx4 v[112:115], v220, s[56:59], s100 offen sc1
    buffer_load_dwordx4 v[116:119], v221, s[56:59], s100 offen sc1
    buffer_load_dwordx4 v[120:123], v222, s[56:59], s100 offen sc1
    buffer_load_dwordx4 v[124:127], v220, s[56:59], s74 offen sc1
    buffer_load_dwordx4 v[128:131], v221, s[56:59], s74 offen sc1
    buffer_load_dwordx4 v[132:135], v222, s[56:59], s74 offen sc1
    s_add_u32 s100, s100, 16384
    s_cmp_eq_u32 s100, 360448
    s_cselect_b32 s100, 196608, s100
    s_add_u32 s74, s100, 4096
    buffer_load_dwordx4 v[136:139], v220, s[56:59], s100 offen sc1
    buffer_load_dwordx4 v[140:143], v221, s[56:59], s100 offen sc1
    buffer_load_dwordx4 v[144:147], v222, s[56:59], s100 offen sc1
    buffer_load_dwordx4 v[148:151], v220, s[56:59], s74 offen sc1
    buffer_load_dwordx4 v[152:155], v221, s[56:59], s74 offen sc1
    buffer_load_dwordx4 v[156:159], v222, s[56:59], s74 offen sc1
    s_add_u32 s100, s100, 16384
    s_cmp_eq_u32 s100, 360448
    s_cselect_b32 s100, 196608, s100
    s_add_u32 s74, s100, 4096
    s_branch L_join_25
L_sw_64:
L_sr_66:
    ds_read_b32 v251, v249 offset:132
    s_waitcnt lgkmcnt(0)
    v_cmp_ne_u32 vcc, s3, v251
    s_cbranch_vccz L_bk_65
    s_sub_u32 s94, s94, 1
    s_cmp_lg_u32 s94, 0
    s_cbranch_scc1 L_sr_66
    s_mov_b32 s94, 1
    s_branch L_bk_65
L_sw_67:
L_sr_69:
    ds_read_b32 v251, v249 offset:136
    s_waitcnt lgkmcnt(0)
    v_cmp_ne_u32 vcc, s3, v251
    s_cbranch_vccz L_bk_68
    s_sub_u32 s94, s94, 1
    s_cmp_lg_u32 s94, 0
    s_cbranch_scc1 L_sr_69
    s_mov_b32 s94, 1
    s_branch L_bk_68
L_sw_70:
L_sr_72:
    ds_read_b32 v251, v249 offset:140
    s_waitcnt lgkmcnt(0)
    v_cmp_ne_u32 vcc, s3, v251
    s_cbranch_vccz L_bk_71
    s_sub_u32 s94, s94, 1
    s_cmp_lg_u32 s94, 0
    s_cbranch_scc1 L_sr_72
    s_mov_b32 s94, 1
    s_branch L_bk_71
L_sw_73:
L_sr_75:
    ds_read_b32 v251, v249 offset:144
    s_waitcnt lgkmcnt(0)
    v_cmp_ne_u32 vcc, s3, v251
    s_cbranch_vccz L_bk_74
    s_sub_u32 s94, s94, 1
    s_cmp_lg_u32 s94, 0
    s_cbranch_scc1 L_sr_75
    s_mov_b32 s94, 1
    s_branch L_bk_74
L_sw_76:
L_sr_78:
    ds_read_b32 v251, v249 offset:148
    s_waitcnt lgkmcnt(0)
    v_cmp_ne_u32 vcc, s3, v251
    s_cbranch_vccz L_bk_77
    s_sub_u32 s94, s94, 1
    s_cmp_lg_u32 s94, 0
    s_cbranch_scc1 L_sr_78
    s_mov_b32 s94, 1
    s_branch L_bk_77
L_sw_79:
L_sr_81:
    ds_read_b32 v251, v249 offset:152
    s_waitcnt lgkmcnt(0)
    v_cmp_ne_u32 vcc, s3, v251
    s_cbranch_vccz L_bk_80
    s_sub_u32 s94, s94, 1
    s_cmp_lg_u32 s94, 0
    s_cbranch_scc1 L_sr_81
    s_mov_b32 s94, 1
    s_branch L_bk_80
L_sw_82:
L_sr_84:
    ds_read_b32 v251, v249 offset:156
    s_waitcnt lgkmcnt(0)
    v_cmp_ne_u32 vcc, s3, v251
    s_cbranch_vccz L_bk_83
    s_sub_u32 s94, s94, 1
    s_cmp_lg_u32 s94, 0
    s_cbranch_scc1 L_sr_84
    s_mov_b32 s94, 1
    s_branch L_bk_83
L_sw_85:
L_sr_87:
    ds_read_b32 v251, v249 offset:160
    s_waitcnt lgkmcnt(0)
    v_cmp_ne_u32 vcc, s3, v251
    s_cbranch_vccz L_bk_86
    s_sub_u32 s94, s94, 1
    s_cmp_lg_u32 s94, 0
    s_cbranch_scc1 L_sr_87
    s_mov_b32 s94, 1
    s_branch L_bk_86
L_sw_88:
L_sr_90:
    ds_read_b32 v251, v249 offset:164
    s_waitcnt lgkmcnt(0)
    v_cmp_ne_u32 vcc, s3, v251
    s_cbranch_vccz L_bk_89
    s_sub_u32 s94, s94, 1
    s_cmp_lg_u32 s94, 0
    s_cbranch_scc1 L_sr_90
    s_mov_b32 s94, 1
    s_branch L_bk_89
L_sw_91:
L_sr_93:
    ds_read_b32 v251, v249 offset:168
    s_waitcnt lgkmcnt(0)
    v_cmp_ne_u32 vcc, s3, v251
    s_cbranch_vccz L_bk_92
    s_sub_u32 s94, s94, 1
    s_cmp_lg_u32 s94, 0
    s_cbranch_scc1 L_sr_93
    s_mov_b32 s94, 1
    s_branch L_bk_92
L_sw_94:
L_sr_96:
    ds_read_b32 v251, v249 offset:172
    s_waitcnt lgkmcnt(0)
    v_cmp_ne_u32 vcc, s3, v251
    s_cbranch_vccz L_bk_95
    s_sub_u32 s94, s94, 1
    s_cmp_lg_u32 s94, 0
    s_cbranch_scc1 L_sr_96
    s_mov_b32 s94, 1
    s_branch L_bk_95
L_sw_97:
L_sr_99:
    ds_read_b32 v251, v249 offset:2192
    s_waitcnt lgkmcnt(0)
    v_cmp_ne_u32 vcc, s3, v251
    s_cbranch_vccz L_bk_98
    s_sub_u32 s94, s94, 1
    s_cmp_lg_u32 s94, 0
    s_cbranch_scc1 L_sr_99
    s_mov_b32 s94, 1
    s_branch L_bk_98
L_sw_100:
L_sr_102:
    ds_read_b32 v251, v214 offset:176
    s_waitcnt lgkmcnt(0)
    v_cmp_ne_u32 vcc, s3, v251
    s_cbranch_vccz L_bk_101
    s_sub_u32 s94, s94, 1
    s_cmp_lg_u32 s94, 0
    s_cbranch_scc1 L_sr_102
    s_mov_b32 s94, 1
    s_branch L_bk_101
L_ssm_compute:
    v_mov_b32 v0, 0
    v_mov_b32 v1, 0
    v_mov_b32 v2, 0
    v_mov_b32 v3, 0
    v_mov_b32 v4, 0
    v_mov_b32 v5, 0
    v_mov_b32 v6, 0
    v_mov_b32 v7, 0
    v_mov_b32 v8, 0
    v_mov_b32 v9, 0
    v_mov_b32 v10, 0
    v_mov_b32 v11, 0
    v_mov_b32 v12, 0
    v_mov_b32 v13, 0
    v_mov_b32 v14, 0
    v_mov_b32 v15, 0
    v_mov_b32 v16, 0
    v_mov_b32 v17, 0
    v_mov_b32 v18, 0
    v_mov_b32 v19, 0
    v_mov_b32 v20, 0
    v_mov_b32 v21, 0
    v_mov_b32 v22, 0
    v_mov_b32 v23, 0
    v_mov_b32 v24, 0
    v_mov_b32 v25, 0
    v_mov_b32 v26, 0
    v_mov_b32 v27, 0
    v_mov_b32 v28, 0
    v_mov_b32 v29, 0
    v_mov_b32 v30, 0
    v_mov_b32 v31, 0
    v_mov_b32 v32, 0
    v_mov_b32 v33, 0
    v_mov_b32 v34, 0
    v_mov_b32 v35, 0
    v_mov_b32 v36, 0
    v_mov_b32 v37, 0
    v_mov_b32 v38, 0
    v_mov_b32 v39, 0
    v_mov_b32 v40, 0
    v_mov_b32 v41, 0
    v_mov_b32 v42, 0
    v_mov_b32 v43, 0
    v_mov_b32 v44, 0
    v_mov_b32 v45, 0
    v_mov_b32 v46, 0
    v_mov_b32 v47, 0
    v_mov_b32 v48, 0
    v_mov_b32 v49, 0
    v_mov_b32 v50, 0
    v_mov_b32 v51, 0
    v_mov_b32 v52, 0
    v_mov_b32 v53, 0
    v_mov_b32 v54, 0
    v_mov_b32 v55, 0
    v_mov_b32 v56, 0
    v_mov_b32 v57, 0
    v_mov_b32 v58, 0
    v_mov_b32 v59, 0
    v_mov_b32 v60, 0
    v_mov_b32 v61, 0
    v_mov_b32 v62, 0
    v_mov_b32 v63, 0
    v_mov_b32 v64, 0
    v_mov_b32 v65, 0
    v_mov_b32 v66, 0
    v_mov_b32 v67, 0
    v_mov_b32 v68, 0
    v_mov_b32 v69, 0
    v_mov_b32 v70, 0
    v_mov_b32 v71, 0
    v_mov_b32 v72, 0
    v_mov_b32 v73, 0
    v_mov_b32 v74, 0
    v_mov_b32 v75, 0
    v_mov_b32 v76, 0
    v_mov_b32 v77, 0
    v_mov_b32 v78, 0
    v_mov_b32 v79, 0
    v_mov_b32 v80, 0
    v_mov_b32 v81, 0
    v_mov_b32 v82, 0
    v_mov_b32 v83, 0
    v_mov_b32 v84, 0
    v_mov_b32 v85, 0
    v_mov_b32 v86, 0
    v_mov_b32 v87, 0
    v_mov_b32 v88, 0
    v_mov_b32 v89, 0
    v_mov_b32 v90, 0
    v_mov_b32 v91, 0
    v_mov_b32 v92, 0
    v_mov_b32 v93, 0
    v_mov_b32 v94, 0
    v_mov_b32 v95, 0
    v_mov_b32 v96, 0
    v_mov_b32 v97, 0
    v_mov_b32 v98, 0
    v_mov_b32 v99, 0
    v_mov_b32 v100, 0
    v_mov_b32 v101, 0
    v_mov_b32 v102, 0
    v_mov_b32 v103, 0
    v_mov_b32 v104, 0
    v_mov_b32 v105, 0
    v_mov_b32 v106, 0
    v_mov_b32 v107, 0
    v_mov_b32 v108, 0
    v_mov_b32 v109, 0
    v_mov_b32 v110, 0
    v_mov_b32 v111, 0
    v_mov_b32 v112, 0
    v_mov_b32 v113, 0
    v_mov_b32 v114, 0
    v_mov_b32 v115, 0
    v_mov_b32 v116, 0
    v_mov_b32 v117, 0
    v_mov_b32 v118, 0
    v_mov_b32 v119, 0
    v_mov_b32 v120, 0
    v_mov_b32 v121, 0
    v_mov_b32 v122, 0
    v_mov_b32 v123, 0
    v_mov_b32 v124, 0
    v_mov_b32 v125, 0
    v_mov_b32 v126, 0
    v_mov_b32 v127, 0
    v_mov_b32 v128, 0
    v_mov_b32 v129, 0
    v_mov_b32 v130, 0
    v_mov_b32 v131, 0
    v_mov_b32 v132, 0
    v_mov_b32 v133, 0
    v_mov_b32 v134, 0
    v_mov_b32 v135, 0
    v_mov_b32 v136, 0
    v_mov_b32 v137, 0
    v_mov_b32 v138, 0
    v_mov_b32 v139, 0
    v_mov_b32 v140, 0
    v_mov_b32 v141, 0
    v_mov_b32 v142, 0
    v_mov_b32 v143, 0
    v_mov_b32 v144, 0
    v_mov_b32 v145, 0
    v_mov_b32 v146, 0
    v_mov_b32 v147, 0
    v_mov_b32 v148, 0
    v_mov_b32 v149, 0
    v_mov_b32 v150, 0
    v_mov_b32 v151, 0
    v_mov_b32 v152, 0
    v_mov_b32 v153, 0
    v_mov_b32 v154, 0
    v_mov_b32 v155, 0
    v_mov_b32 v156, 0
    v_mov_b32 v157, 0
    v_mov_b32 v158, 0
    v_mov_b32 v159, 0
    v_bfe_u32 v160, v254, 1, 3
    v_lshrrev_b32 v232, 4, v254
    v_xor_b32 v160, v160, v232
    v_and_b32 v232, 15, v254
    v_lshlrev_b32 v232, 7, v232
    v_lshl_add_u32 v232, v160, 4, v232
    s_lshr_b32 s70, s65, 1
    s_mul_i32 s70, s70, 10240
    s_add_u32 s70, s70, 49152
    v_add_u32 v234, s70, v232
    v_xor_b32 v235, 64, v234
    s_and_b32 s70, s65, 1
    s_lshl_b32 s70, s70, 13
    v_add_u32 v232, s70, v232
    v_xor_b32 v233, 64, v232
    s_mov_b32 s80, 0
    s_mov_b32 s83, 0
    s_mov_b32 s81, 0
    s_mov_b32 m0, s86
    s_mov_b32 s85, 2
    ds_read_b32 v250, v248 offset:4
    s_waitcnt lgkmcnt(0)
    v_cmp_ne_u32 vcc, s3, v250
    s_cbranch_vccnz L_sw_103
L_bk_104:
    v_add_u32 v248, 4, v248
    ds_read_b128 v[192:195], v234 offset:0
    ds_read_b128 v[160:163], v232 offset:0
    ds_read_b128 v[164:167], v232 offset:2048
    ds_read_b128 v[196:199], v234 offset:2048
    ds_read_b128 v[168:171], v232 offset:4096
    ds_read_b128 v[172:175], v232 offset:6144
    ds_read_b128 v[200:203], v234 offset:4096
    ds_read_b128 v[204:207], v234 offset:6144
    ds_read_b128 v[208:211], v234 offset:8192
    s_mov_b32 s70, 20480
    s_mov_b32 s71, 4294885376
    s_mov_b32 s72, 16384
    s_mov_b32 s73, 4294934528
L_g1_ssm:
    s_waitcnt lgkmcnt(3)
    v_mfma_f32_16x16x32_bf16 v[0:3], v[160:163], v[192:195], v[0:3]
    ds_read_b128 v[212:215], v235 offset:0
    v_mfma_f32_16x16x32_bf16 v[4:7], v[164:167], v[192:195], v[4:7]
    ds_read_b128 v[176:179], v233 offset:0
    v_mfma_f32_16x16x32_bf16 v[8:11], v[168:171], v[192:195], v[8:11]
    ds_read_b128 v[180:183], v233 offset:2048
    v_mfma_f32_16x16x32_bf16 v[12:15], v[172:175], v[192:195], v[12:15]
    v_mfma_f32_16x16x32_bf16 v[32:35], v[160:163], v[196:199], v[32:35]
    ds_read_b128 v[216:219], v235 offset:2048
    v_mfma_f32_16x16x32_bf16 v[36:39], v[164:167], v[196:199], v[36:39]
    ds_read_b128 v[184:187], v233 offset:4096
    v_mfma_f32_16x16x32_bf16 v[40:43], v[168:171], v[196:199], v[40:43]
    ds_read_b128 v[188:191], v233 offset:6144
    v_mfma_f32_16x16x32_bf16 v[44:47], v[172:175], v[196:199], v[44:47]
    v_add_u32 v248, 4, v248
    s_waitcnt lgkmcnt(8)
    v_mfma_f32_16x16x32_bf16 v[64:67], v[160:163], v[200:203], v[64:67]
    ds_read_b128 v[220:223], v235 offset:4096
    v_mfma_f32_16x16x32_bf16 v[68:71], v[164:167], v[200:203], v[68:71]
    s_add_u32 s80, s80, 1
    s_cmp_eq_u32 s80, 5
    v_mfma_f32_16x16x32_bf16 v[72:75], v[168:171], v[200:203], v[72:75]
    s_cselect_b32 s84, s71, s70
    s_cselect_b32 s80, 0, s80
    v_mfma_f32_16x16x32_bf16 v[76:79], v[172:175], v[200:203], v[76:79]
    ds_read_b32 v250, v248
    s_waitcnt lgkmcnt(9)
    v_mfma_f32_16x16x32_bf16 v[96:99], v[160:163], v[204:207], v[96:99]
    ds_read_b128 v[224:227], v235 offset:6144
    v_mfma_f32_16x16x32_bf16 v[100:103], v[164:167], v[204:207], v[100:103]
    v_add_u32 v234, s84, v234
    v_mfma_f32_16x16x32_bf16 v[104:107], v[168:171], v[204:207], v[104:107]
    v_mfma_f32_16x16x32_bf16 v[108:111], v[172:175], v[204:207], v[108:111]
    s_waitcnt lgkmcnt(1)
    v_mfma_f32_16x16x32_bf16 v[128:131], v[160:163], v[208:211], v[128:131]
    ds_read_b128 v[228:231], v235 offset:8192
    v_mfma_f32_16x16x32_bf16 v[132:135], v[164:167], v[208:211], v[132:135]
    v_mfma_f32_16x16x32_bf16 v[136:139], v[168:171], v[208:211], v[136:139]
    v_cmp_ne_u32 vcc, s3, v250
    v_mfma_f32_16x16x32_bf16 v[140:143], v[172:175], v[208:211], v[140:143]
    v_mfma_f32_16x16x32_bf16 v[0:3], v[176:179], v[212:215], v[0:3]
    s_cbranch_vccnz L_sw_106
L_bk_107:
    v_mfma_f32_16x16x32_bf16 v[4:7], v[180:183], v[212:215], v[4:7]
    ds_read_b128 v[192:195], v234 offset:0
    v_mfma_f32_16x16x32_bf16 v[8:11], v[184:187], v[212:215], v[8:11]
    v_mfma_f32_16x16x32_bf16 v[12:15], v[188:191], v[212:215], v[12:15]
    v_mfma_f32_16x16x32_bf16 v[32:35], v[176:179], v[216:219], v[32:35]
    ds_read_b128 v[196:199], v234 offset:2048
    v_mfma_f32_16x16x32_bf16 v[36:39], v[180:183], v[216:219], v[36:39]
    v_mfma_f32_16x16x32_bf16 v[40:43], v[184:187], v[216:219], v[40:43]
    v_mfma_f32_16x16x32_bf16 v[44:47], v[188:191], v[216:219], v[44:47]
    v_mfma_f32_16x16x32_bf16 v[64:67], v[176:179], v[220:223], v[64:67]
    ds_read_b128 v[200:203], v234 offset:4096
    v_mfma_f32_16x16x32_bf16 v[68:71], v[180:183], v[220:223], v[68:71]
    v_add_u32 v235, s84, v235
    v_mfma_f32_16x16x32_bf16 v[72:75], v[184:187], v[220:223], v[72:75]
    v_mfma_f32_16x16x32_bf16 v[76:79], v[188:191], v[220:223], v[76:79]
    s_waitcnt lgkmcnt(4)
    v_mfma_f32_16x16x32_bf16 v[96:99], v[176:179], v[224:227], v[96:99]
    ds_read_b128 v[204:207], v234 offset:6144
    v_mfma_f32_16x16x32_bf16 v[100:103], v[180:183], v[224:227], v[100:103]
    s_add_u32 s81, s81, 1
    s_cmp_eq_u32 s81, 3
    v_mfma_f32_16x16x32_bf16 v[104:107], v[184:187], v[224:227], v[104:107]
    s_cselect_b32 s82, s73, s72
    s_cselect_b32 s81, 0, s81
    v_mfma_f32_16x16x32_bf16 v[108:111], v[188:191], v[224:227], v[108:111]
    s_add_u32 m0, m0, 4
    s_waitcnt lgkmcnt(4)
    v_mfma_f32_16x16x32_bf16 v[128:131], v[176:179], v[228:231], v[128:131]
    ds_read_b128 v[208:211], v234 offset:8192
    v_mfma_f32_16x16x32_bf16 v[132:135], v[180:183], v[228:231], v[132:135]
    v_mfma_f32_16x16x32_bf16 v[136:139], v[184:187], v[228:231], v[136:139]
    buffer_load_dword v252, s[52:55], 0 offen lds
    v_mfma_f32_16x16x32_bf16 v[140:143], v[188:191], v[228:231], v[140:143]
    s_waitcnt lgkmcnt(4)
    v_mfma_f32_16x16x32_bf16 v[16:19], v[160:163], v[192:195], v[16:19]
    ds_read_b128 v[212:215], v235 offset:0
    v_mfma_f32_16x16x32_bf16 v[20:23], v[164:167], v[192:195], v[20:23]
    v_mfma_f32_16x16x32_bf16 v[24:27], v[168:171], v[192:195], v[24:27]
    v_mfma_f32_16x16x32_bf16 v[28:31], v[172:175], v[192:195], v[28:31]
    s_waitcnt lgkmcnt(4)
    v_mfma_f32_16x16x32_bf16 v[48:51], v[160:163], v[196:199], v[48:51]
    ds_read_b128 v[216:219], v235 offset:2048
    v_mfma_f32_16x16x32_bf16 v[52:55], v[164:167], v[196:199], v[52:55]
    v_mfma_f32_16x16x32_bf16 v[56:59], v[168:171], v[196:199], v[56:59]
    v_mfma_f32_16x16x32_bf16 v[60:63], v[172:175], v[196:199], v[60:63]
    v_add_u32 v248, 4, v248
    s_waitcnt lgkmcnt(4)
    v_mfma_f32_16x16x32_bf16 v[80:83], v[160:163], v[200:203], v[80:83]
    ds_read_b128 v[220:223], v235 offset:4096
    v_mfma_f32_16x16x32_bf16 v[84:87], v[164:167], v[200:203], v[84:87]
    s_add_u32 s80, s80, 1
    s_cmp_eq_u32 s80, 5
    v_mfma_f32_16x16x32_bf16 v[88:91], v[168:171], v[200:203], v[88:91]
    s_cselect_b32 s84, s71, s70
    s_cselect_b32 s80, 0, s80
    v_mfma_f32_16x16x32_bf16 v[92:95], v[172:175], v[200:203], v[92:95]
    ds_read_b32 v250, v248
    s_waitcnt lgkmcnt(5)
    v_mfma_f32_16x16x32_bf16 v[112:115], v[160:163], v[204:207], v[112:115]
    ds_read_b128 v[224:227], v235 offset:6144
    v_mfma_f32_16x16x32_bf16 v[116:119], v[164:167], v[204:207], v[116:119]
    v_add_u32 v234, s84, v234
    v_mfma_f32_16x16x32_bf16 v[120:123], v[168:171], v[204:207], v[120:123]
    v_mfma_f32_16x16x32_bf16 v[124:127], v[172:175], v[204:207], v[124:127]
    s_waitcnt lgkmcnt(1)
    v_mfma_f32_16x16x32_bf16 v[144:147], v[160:163], v[208:211], v[144:147]
    ds_read_b128 v[228:231], v235 offset:8192
    v_mfma_f32_16x16x32_bf16 v[148:151], v[164:167], v[208:211], v[148:151]
    v_add_u32 v232, s82, v232
    v_add_u32 v233, s82, v233
    v_mfma_f32_16x16x32_bf16 v[152:155], v[168:171], v[208:211], v[152:155]
    v_cmp_ne_u32 vcc, s3, v250
    v_mfma_f32_16x16x32_bf16 v[156:159], v[172:175], v[208:211], v[156:159]
    v_mfma_f32_16x16x32_bf16 v[16:19], v[176:179], v[212:215], v[16:19]
    s_cbranch_vccnz L_sw_109
L_bk_110:
    v_mfma_f32_16x16x32_bf16 v[20:23], v[180:183], v[212:215], v[20:23]
    ds_read_b128 v[192:195], v234 offset:0
    v_mfma_f32_16x16x32_bf16 v[24:27], v[184:187], v[212:215], v[24:27]
    ds_read_b128 v[160:163], v232 offset:0
    v_mfma_f32_16x16x32_bf16 v[28:31], v[188:191], v[212:215], v[28:31]
    ds_read_b128 v[164:167], v232 offset:2048
    v_mfma_f32_16x16x32_bf16 v[48:51], v[176:179], v[216:219], v[48:51]
    ds_read_b128 v[196:199], v234 offset:2048
    v_mfma_f32_16x16x32_bf16 v[52:55], v[180:183], v[216:219], v[52:55]
    ds_read_b128 v[168:171], v232 offset:4096
    v_mfma_f32_16x16x32_bf16 v[56:59], v[184:187], v[216:219], v[56:59]
    ds_read_b128 v[172:175], v232 offset:6144
    v_mfma_f32_16x16x32_bf16 v[60:63], v[188:191], v[216:219], v[60:63]
    v_mfma_f32_16x16x32_bf16 v[80:83], v[176:179], v[220:223], v[80:83]
    ds_read_b128 v[200:203], v234 offset:4096
    v_mfma_f32_16x16x32_bf16 v[84:87], v[180:183], v[220:223], v[84:87]
    v_add_u32 v235, s84, v235
    v_mfma_f32_16x16x32_bf16 v[88:91], v[184:187], v[220:223], v[88:91]
    v_mfma_f32_16x16x32_bf16 v[92:95], v[188:191], v[220:223], v[92:95]
    s_waitcnt lgkmcnt(8)
    v_mfma_f32_16x16x32_bf16 v[112:115], v[176:179], v[224:227], v[112:115]
    ds_read_b128 v[204:207], v234 offset:6144
    v_mfma_f32_16x16x32_bf16 v[116:119], v[180:183], v[224:227], v[116:119]
    v_mfma_f32_16x16x32_bf16 v[120:123], v[184:187], v[224:227], v[120:123]
    v_mfma_f32_16x16x32_bf16 v[124:127], v[188:191], v[224:227], v[124:127]
    s_add_u32 m0, m0, 4
    s_waitcnt lgkmcnt(8)
    v_mfma_f32_16x16x32_bf16 v[144:147], v[176:179], v[228:231], v[144:147]
    ds_read_b128 v[208:211], v234 offset:8192
    v_mfma_f32_16x16x32_bf16 v[148:151], v[180:183], v[228:231], v[148:151]
    s_add_u32 s83, s83, 1
    s_cmp_lt_u32 s83, s85
    v_mfma_f32_16x16x32_bf16 v[152:155], v[184:187], v[228:231], v[152:155]
    buffer_load_dword v252, s[52:55], 0 offen lds
    v_mfma_f32_16x16x32_bf16 v[156:159], v[188:191], v[228:231], v[156:159]
    s_cbranch_scc1 L_g1_ssm
    s_cmp_eq_u32 s83, 10
    s_cbranch_scc1 L_g1e_112
    s_cmp_lg_u32 s83, 2
    s_cbranch_scc1 L_g1w_113
    s_mov_b32 s86, m0
    s_load_dword s66, s[34:35], 0
    s_mov_b64 s[88:89], s[70:71]
    s_mov_b64 s[90:91], s[72:73]
    s_lshr_b32 s70, s60, 1
    s_lshl_b32 s70, s70, 2
    s_add_u32 s70, s70, s63
    s_lshl_b32 s70, s70, 3
    s_lshl_b32 s71, s62, 7
    s_add_u32 s70, s70, s71
    v_lshrrev_b32 v246, 5, v254
    s_lshl_b32 s71, s65, 1
    s_add_u32 s70, s70, s71
    v_add_u32 v246, s70, v246
    v_and_b32 v247, 31, v254
    v_mul_u32_u24 v249, 1280, v246
    v_lshl_add_u32 v249, v247, 3, v249
    global_load_dwordx2 v[236:237], v249, s[4:5] offset:0
    global_load_dwordx2 v[238:239], v249, s[4:5] offset:256
    global_load_dwordx2 v[240:241], v249, s[4:5] offset:512
    global_load_dwordx2 v[242:243], v249, s[4:5] offset:768
    global_load_dwordx2 v[244:245], v249, s[4:5] offset:1024
    s_mov_b64 s[70:71], s[88:89]
    s_mov_b64 s[72:73], s[90:91]
    s_mov_b32 m0, s86
    s_mov_b32 s85, 5
    s_branch L_g1_ssm
L_g1w_113:
    s_waitcnt lgkmcnt(0)
    s_add_u32 s66, s66, 1
    s_waitcnt vmcnt(6)
    v_mov_b32 v249, 0
    v_mov_b32 v251, 0
    v_dot2c_f32_bf16 v249, s69, v236
    v_dot2c_f32_bf16 v251, v236, v236
    v_dot2c_f32_bf16 v249, s69, v237
    v_dot2c_f32_bf16 v251, v237, v237
    v_dot2c_f32_bf16 v249, s69, v238
    v_dot2c_f32_bf16 v251, v238, v238
    v_dot2c_f32_bf16 v249, s69, v239
    v_dot2c_f32_bf16 v251, v239, v239
    v_dot2c_f32_bf16 v249, s69, v240
    v_dot2c_f32_bf16 v251, v240, v240
    v_dot2c_f32_bf16 v249, s69, v241
    v_dot2c_f32_bf16 v251, v241, v241
    v_dot2c_f32_bf16 v249, s69, v242
    v_dot2c_f32_bf16 v251, v242, v242
    v_dot2c_f32_bf16 v249, s69, v243
    v_dot2c_f32_bf16 v251, v243, v243
    v_dot2c_f32_bf16 v249, s69, v244
    v_dot2c_f32_bf16 v251, v244, v244
    v_dot2c_f32_bf16 v249, s69, v245
    v_dot2c_f32_bf16 v251, v245, v245
    s_nop 2
    v_mov_b32 v236, v249
    s_nop 1
    v_add_f32_dpp v236, v236, v236 row_ror:8 row_mask:0xf bank_mask:0xf
    v_add_f32_dpp v251, v251, v251 row_ror:8 row_mask:0xf bank_mask:0xf
    s_nop 1
    v_add_f32_dpp v236, v236, v236 row_ror:4 row_mask:0xf bank_mask:0xf
    v_add_f32_dpp v251, v251, v251 row_ror:4 row_mask:0xf bank_mask:0xf
    s_nop 1
    v_add_f32_dpp v236, v236, v236 row_ror:2 row_mask:0xf bank_mask:0xf
    v_add_f32_dpp v251, v251, v251 row_ror:2 row_mask:0xf bank_mask:0xf
    s_nop 1
    v_add_f32_dpp v236, v236, v236 row_ror:1 row_mask:0xf bank_mask:0xf
    v_add_f32_dpp v251, v251, v251 row_ror:1 row_mask:0xf bank_mask:0xf
    s_nop 1
    v_add_f32_dpp v236, v236, v236 row_bcast:15 row_mask:0xa bank_mask:0xf
    v_add_f32_dpp v251, v251, v251 row_bcast:15 row_mask:0xa bank_mask:0xf
    v_mul_f32 v236, 0x3acccccd, v236
    v_mul_f32 v251, 0x3acccccd, v251
    v_fma_f32 v251, -v236, v236, v251
    v_max_f32 v251, 0, v251
    v_cvt_pk_bf16_f32 v251, v251, v251
    v_lshlrev_b32 v251, 16, v251
    v_add_f32 v251, 0x3727c5ac, v251
    v_cvt_pk_bf16_f32 v251, v251, v251
    v_lshlrev_b32 v251, 16, v251
    v_sqrt_f32 v251, v251
    v_lshlrev_b32 v246, 3, v246
    v_add_u32 v246, 16384, v246
    v_cvt_pk_bf16_f32 v236, v236, v251
    v_mov_b32 v237, s66
    v_cmp_eq_u32 vcc, 16, v247
    s_and_saveexec_b64 s[92:93], vcc
    global_store_dwordx2 v246, v[236:237], s[34:35] sc1
    s_mov_b64 exec, s[92:93]
    s_mov_b32 s85, 10
    s_branch L_g1_ssm
L_g1e_112:
    s_waitcnt lgkmcnt(0)
    s_setprio 3
    s_and_b32 s70, s65, 1
    s_lshl_b32 s70, s70, 8
    s_add_u32 s70, s70, 151552
    v_lshrrev_b32 v222, 4, v254
    v_lshlrev_b32 v222, 4, v222
    v_add_u32 v222, s70, v222
    s_lshr_b32 s71, s65, 1
    s_mul_i32 s71, s71, 80
    v_and_b32 v223, 15, v254
    v_add_u32 v223, s71, v223
    v_lshlrev_b32 v224, 2, v223
    v_add_u32 v225, 153600, v224
    v_lshlrev_b32 v226, 3, v223
    v_add_u32 v226, 155136, v226
    ds_read_b128 v[160:163], v222 offset:0
    ds_read_b128 v[176:179], v222 offset:512
    ds_read_b128 v[164:167], v222 offset:64
    ds_read_b128 v[180:183], v222 offset:576
    ds_read_b128 v[168:171], v222 offset:128
    ds_read_b128 v[184:187], v222 offset:640
    ds_read_b128 v[172:175], v222 offset:192
    ds_read_b128 v[188:191], v222 offset:704
    ds_read_b32 v192, v225 offset:0
    ds_read_b32 v193, v225 offset:640
    ds_read_b32 v194, v225 offset:64
    ds_read_b32 v195, v225 offset:704
    ds_read_b32 v196, v225 offset:128
    ds_read_b32 v197, v225 offset:768
    ds_read_b32 v198, v225 offset:192
    ds_read_b32 v199, v225 offset:832
    ds_read_b32 v200, v225 offset:256
    ds_read_b32 v201, v225 offset:896
    ds_read_b64 v[202:203], v226 offset:0
    ds_read_b64 v[212:213], v226 offset:1280
    ds_read_b64 v[204:205], v226 offset:128
    ds_read_b64 v[214:215], v226 offset:1408
    ds_read_b64 v[206:207], v226 offset:256
    ds_read_b64 v[216:217], v226 offset:1536
    ds_read_b64 v[208:209], v226 offset:384
    ds_read_b64 v[218:219], v226 offset:1664
    ds_read_b64 v[210:211], v226 offset:512
    ds_read_b64 v[220:221], v226 offset:1792
    s_and_b32 s70, s65, 1
    s_mul_i32 s70, s70, 10240
    s_add_u32 s70, s70, 81920
    v_lshrrev_b32 v227, 4, v254
    v_mul_u32_u24 v227, 2560, v227
    v_lshl_add_u32 v227, v224, 1, v227
    v_add_u32 v227, s70, v227
    v_add_u32 v229, 1280, v227
    s_waitcnt lgkmcnt(0)
    v_pk_fma_f32 v[0:1], v[160:161], v[192:193], v[0:1] op_sel:[0,0,0] op_sel_hi:[1,0,1] neg_lo:[0,1,0] neg_hi:[0,1,0]
    v_pk_fma_f32 v[16:17], v[160:161], v[192:193], v[16:17] op_sel:[0,1,0] op_sel_hi:[1,1,1] neg_lo:[0,1,0] neg_hi:[0,1,0]
    v_pk_fma_f32 v[32:33], v[160:161], v[194:195], v[32:33] op_sel:[0,0,0] op_sel_hi:[1,0,1] neg_lo:[0,1,0] neg_hi:[0,1,0]
    v_pk_fma_f32 v[48:49], v[160:161], v[194:195], v[48:49] op_sel:[0,1,0] op_sel_hi:[1,1,1] neg_lo:[0,1,0] neg_hi:[0,1,0]
    v_pk_fma_f32 v[64:65], v[160:161], v[196:197], v[64:65] op_sel:[0,0,0] op_sel_hi:[1,0,1] neg_lo:[0,1,0] neg_hi:[0,1,0]
    v_pk_fma_f32 v[80:81], v[160:161], v[196:197], v[80:81] op_sel:[0,1,0] op_sel_hi:[1,1,1] neg_lo:[0,1,0] neg_hi:[0,1,0]
    v_pk_fma_f32 v[96:97], v[160:161], v[198:199], v[96:97] op_sel:[0,0,0] op_sel_hi:[1,0,1] neg_lo:[0,1,0] neg_hi:[0,1,0]
    v_pk_fma_f32 v[112:113], v[160:161], v[198:199], v[112:113] op_sel:[0,1,0] op_sel_hi:[1,1,1] neg_lo:[0,1,0] neg_hi:[0,1,0]
    v_pk_fma_f32 v[128:129], v[160:161], v[200:201], v[128:129] op_sel:[0,0,0] op_sel_hi:[1,0,1] neg_lo:[0,1,0] neg_hi:[0,1,0]
    v_pk_fma_f32 v[144:145], v[160:161], v[200:201], v[144:145] op_sel:[0,1,0] op_sel_hi:[1,1,1] neg_lo:[0,1,0] neg_hi:[0,1,0]
    v_pk_mul_f32 v[0:1], v[0:1], v[176:177] op_sel:[0,0] op_sel_hi:[1,1]
    v_pk_mul_f32 v[16:17], v[16:17], v[176:177] op_sel:[0,0] op_sel_hi:[1,1]
    v_pk_mul_f32 v[32:33], v[32:33], v[176:177] op_sel:[0,0] op_sel_hi:[1,1]
    v_pk_mul_f32 v[48:49], v[48:49], v[176:177] op_sel:[0,0] op_sel_hi:[1,1]
    v_pk_mul_f32 v[64:65], v[64:65], v[176:177] op_sel:[0,0] op_sel_hi:[1,1]
    v_pk_mul_f32 v[80:81], v[80:81], v[176:177] op_sel:[0,0] op_sel_hi:[1,1]
    v_pk_mul_f32 v[96:97], v[96:97], v[176:177] op_sel:[0,0] op_sel_hi:[1,1]
    v_pk_mul_f32 v[112:113], v[112:113], v[176:177] op_sel:[0,0] op_sel_hi:[1,1]
    v_pk_mul_f32 v[128:129], v[128:129], v[176:177] op_sel:[0,0] op_sel_hi:[1,1]
    v_pk_mul_f32 v[144:145], v[144:145], v[176:177] op_sel:[0,0] op_sel_hi:[1,1]
    v_pk_fma_f32 v[2:3], v[162:163], v[192:193], v[2:3] op_sel:[0,0,0] op_sel_hi:[1,0,1] neg_lo:[0,1,0] neg_hi:[0,1,0]
    v_pk_fma_f32 v[18:19], v[162:163], v[192:193], v[18:19] op_sel:[0,1,0] op_sel_hi:[1,1,1] neg_lo:[0,1,0] neg_hi:[0,1,0]
    v_pk_fma_f32 v[34:35], v[162:163], v[194:195], v[34:35] op_sel:[0,0,0] op_sel_hi:[1,0,1] neg_lo:[0,1,0] neg_hi:[0,1,0]
    v_pk_fma_f32 v[50:51], v[162:163], v[194:195], v[50:51] op_sel:[0,1,0] op_sel_hi:[1,1,1] neg_lo:[0,1,0] neg_hi:[0,1,0]
    v_pk_fma_f32 v[66:67], v[162:163], v[196:197], v[66:67] op_sel:[0,0,0] op_sel_hi:[1,0,1] neg_lo:[0,1,0] neg_hi:[0,1,0]
    v_pk_fma_f32 v[82:83], v[162:163], v[196:197], v[82:83] op_sel:[0,1,0] op_sel_hi:[1,1,1] neg_lo:[0,1,0] neg_hi:[0,1,0]
    v_pk_fma_f32 v[98:99], v[162:163], v[198:199], v[98:99] op_sel:[0,0,0] op_sel_hi:[1,0,1] neg_lo:[0,1,0] neg_hi:[0,1,0]
    v_pk_fma_f32 v[114:115], v[162:163], v[198:199], v[114:115] op_sel:[0,1,0] op_sel_hi:[1,1,1] neg_lo:[0,1,0] neg_hi:[0,1,0]
    v_pk_fma_f32 v[130:131], v[162:163], v[200:201], v[130:131] op_sel:[0,0,0] op_sel_hi:[1,0,1] neg_lo:[0,1,0] neg_hi:[0,1,0]
    v_pk_fma_f32 v[146:147], v[162:163], v[200:201], v[146:147] op_sel:[0,1,0] op_sel_hi:[1,1,1] neg_lo:[0,1,0] neg_hi:[0,1,0]
    v_pk_mul_f32 v[2:3], v[2:3], v[178:179] op_sel:[0,0] op_sel_hi:[1,1]
    v_pk_mul_f32 v[18:19], v[18:19], v[178:179] op_sel:[0,0] op_sel_hi:[1,1]
    v_pk_mul_f32 v[34:35], v[34:35], v[178:179] op_sel:[0,0] op_sel_hi:[1,1]
    v_pk_mul_f32 v[50:51], v[50:51], v[178:179] op_sel:[0,0] op_sel_hi:[1,1]
    v_pk_mul_f32 v[66:67], v[66:67], v[178:179] op_sel:[0,0] op_sel_hi:[1,1]
    v_pk_mul_f32 v[82:83], v[82:83], v[178:179] op_sel:[0,0] op_sel_hi:[1,1]
    v_pk_mul_f32 v[98:99], v[98:99], v[178:179] op_sel:[0,0] op_sel_hi:[1,1]
    v_pk_mul_f32 v[114:115], v[114:115], v[178:179] op_sel:[0,0] op_sel_hi:[1,1]
    v_pk_mul_f32 v[130:131], v[130:131], v[178:179] op_sel:[0,0] op_sel_hi:[1,1]
    v_pk_mul_f32 v[146:147], v[146:147], v[178:179] op_sel:[0,0] op_sel_hi:[1,1]
    v_pk_fma_f32 v[4:5], v[164:165], v[192:193], v[4:5] op_sel:[0,0,0] op_sel_hi:[1,0,1] neg_lo:[0,1,0] neg_hi:[0,1,0]
    v_pk_fma_f32 v[20:21], v[164:165], v[192:193], v[20:21] op_sel:[0,1,0] op_sel_hi:[1,1,1] neg_lo:[0,1,0] neg_hi:[0,1,0]
    v_pk_fma_f32 v[36:37], v[164:165], v[194:195], v[36:37] op_sel:[0,0,0] op_sel_hi:[1,0,1] neg_lo:[0,1,0] neg_hi:[0,1,0]
    v_pk_fma_f32 v[52:53], v[164:165], v[194:195], v[52:53] op_sel:[0,1,0] op_sel_hi:[1,1,1] neg_lo:[0,1,0] neg_hi:[0,1,0]
    v_pk_fma_f32 v[68:69], v[164:165], v[196:197], v[68:69] op_sel:[0,0,0] op_sel_hi:[1,0,1] neg_lo:[0,1,0] neg_hi:[0,1,0]
    v_pk_fma_f32 v[84:85], v[164:165], v[196:197], v[84:85] op_sel:[0,1,0] op_sel_hi:[1,1,1] neg_lo:[0,1,0] neg_hi:[0,1,0]
    v_pk_fma_f32 v[100:101], v[164:165], v[198:199], v[100:101] op_sel:[0,0,0] op_sel_hi:[1,0,1] neg_lo:[0,1,0] neg_hi:[0,1,0]
    v_pk_fma_f32 v[116:117], v[164:165], v[198:199], v[116:117] op_sel:[0,1,0] op_sel_hi:[1,1,1] neg_lo:[0,1,0] neg_hi:[0,1,0]
    v_pk_fma_f32 v[132:133], v[164:165], v[200:201], v[132:133] op_sel:[0,0,0] op_sel_hi:[1,0,1] neg_lo:[0,1,0] neg_hi:[0,1,0]
    v_pk_fma_f32 v[148:149], v[164:165], v[200:201], v[148:149] op_sel:[0,1,0] op_sel_hi:[1,1,1] neg_lo:[0,1,0] neg_hi:[0,1,0]
    v_pk_mul_f32 v[4:5], v[4:5], v[180:181] op_sel:[0,0] op_sel_hi:[1,1]
    v_pk_mul_f32 v[20:21], v[20:21], v[180:181] op_sel:[0,0] op_sel_hi:[1,1]
    v_pk_mul_f32 v[36:37], v[36:37], v[180:181] op_sel:[0,0] op_sel_hi:[1,1]
    v_pk_mul_f32 v[52:53], v[52:53], v[180:181] op_sel:[0,0] op_sel_hi:[1,1]
    v_pk_mul_f32 v[68:69], v[68:69], v[180:181] op_sel:[0,0] op_sel_hi:[1,1]
    v_pk_mul_f32 v[84:85], v[84:85], v[180:181] op_sel:[0,0] op_sel_hi:[1,1]
    v_pk_mul_f32 v[100:101], v[100:101], v[180:181] op_sel:[0,0] op_sel_hi:[1,1]
    v_pk_mul_f32 v[116:117], v[116:117], v[180:181] op_sel:[0,0] op_sel_hi:[1,1]
    v_pk_mul_f32 v[132:133], v[132:133], v[180:181] op_sel:[0,0] op_sel_hi:[1,1]
    v_pk_mul_f32 v[148:149], v[148:149], v[180:181] op_sel:[0,0] op_sel_hi:[1,1]
    v_pk_fma_f32 v[6:7], v[166:167], v[192:193], v[6:7] op_sel:[0,0,0] op_sel_hi:[1,0,1] neg_lo:[0,1,0] neg_hi:[0,1,0]
    v_pk_fma_f32 v[22:23], v[166:167], v[192:193], v[22:23] op_sel:[0,1,0] op_sel_hi:[1,1,1] neg_lo:[0,1,0] neg_hi:[0,1,0]
    v_pk_fma_f32 v[38:39], v[166:167], v[194:195], v[38:39] op_sel:[0,0,0] op_sel_hi:[1,0,1] neg_lo:[0,1,0] neg_hi:[0,1,0]
    v_pk_fma_f32 v[54:55], v[166:167], v[194:195], v[54:55] op_sel:[0,1,0] op_sel_hi:[1,1,1] neg_lo:[0,1,0] neg_hi:[0,1,0]
    v_pk_fma_f32 v[70:71], v[166:167], v[196:197], v[70:71] op_sel:[0,0,0] op_sel_hi:[1,0,1] neg_lo:[0,1,0] neg_hi:[0,1,0]
    v_pk_fma_f32 v[86:87], v[166:167], v[196:197], v[86:87] op_sel:[0,1,0] op_sel_hi:[1,1,1] neg_lo:[0,1,0] neg_hi:[0,1,0]
    v_pk_fma_f32 v[102:103], v[166:167], v[198:199], v[102:103] op_sel:[0,0,0] op_sel_hi:[1,0,1] neg_lo:[0,1,0] neg_hi:[0,1,0]
    v_pk_fma_f32 v[118:119], v[166:167], v[198:199], v[118:119] op_sel:[0,1,0] op_sel_hi:[1,1,1] neg_lo:[0,1,0] neg_hi:[0,1,0]
    v_pk_fma_f32 v[134:135], v[166:167], v[200:201], v[134:135] op_sel:[0,0,0] op_sel_hi:[1,0,1] neg_lo:[0,1,0] neg_hi:[0,1,0]
    v_pk_fma_f32 v[150:151], v[166:167], v[200:201], v[150:151] op_sel:[0,1,0] op_sel_hi:[1,1,1] neg_lo:[0,1,0] neg_hi:[0,1,0]
    v_pk_mul_f32 v[6:7], v[6:7], v[182:183] op_sel:[0,0] op_sel_hi:[1,1]
    v_pk_mul_f32 v[22:23], v[22:23], v[182:183] op_sel:[0,0] op_sel_hi:[1,1]
    v_pk_mul_f32 v[38:39], v[38:39], v[182:183] op_sel:[0,0] op_sel_hi:[1,1]
    v_pk_mul_f32 v[54:55], v[54:55], v[182:183] op_sel:[0,0] op_sel_hi:[1,1]
    v_pk_mul_f32 v[70:71], v[70:71], v[182:183] op_sel:[0,0] op_sel_hi:[1,1]
    v_pk_mul_f32 v[86:87], v[86:87], v[182:183] op_sel:[0,0] op_sel_hi:[1,1]
    v_pk_mul_f32 v[102:103], v[102:103], v[182:183] op_sel:[0,0] op_sel_hi:[1,1]
    v_pk_mul_f32 v[118:119], v[118:119], v[182:183] op_sel:[0,0] op_sel_hi:[1,1]
    v_pk_mul_f32 v[134:135], v[134:135], v[182:183] op_sel:[0,0] op_sel_hi:[1,1]
    v_pk_mul_f32 v[150:151], v[150:151], v[182:183] op_sel:[0,0] op_sel_hi:[1,1]
    v_pk_fma_f32 v[8:9], v[168:169], v[192:193], v[8:9] op_sel:[0,0,0] op_sel_hi:[1,0,1] neg_lo:[0,1,0] neg_hi:[0,1,0]
    v_pk_fma_f32 v[24:25], v[168:169], v[192:193], v[24:25] op_sel:[0,1,0] op_sel_hi:[1,1,1] neg_lo:[0,1,0] neg_hi:[0,1,0]
    v_pk_fma_f32 v[40:41], v[168:169], v[194:195], v[40:41] op_sel:[0,0,0] op_sel_hi:[1,0,1] neg_lo:[0,1,0] neg_hi:[0,1,0]
    v_pk_fma_f32 v[56:57], v[168:169], v[194:195], v[56:57] op_sel:[0,1,0] op_sel_hi:[1,1,1] neg_lo:[0,1,0] neg_hi:[0,1,0]
    v_pk_fma_f32 v[72:73], v[168:169], v[196:197], v[72:73] op_sel:[0,0,0] op_sel_hi:[1,0,1] neg_lo:[0,1,0] neg_hi:[0,1,0]
    v_pk_fma_f32 v[88:89], v[168:169], v[196:197], v[88:89] op_sel:[0,1,0] op_sel_hi:[1,1,1] neg_lo:[0,1,0] neg_hi:[0,1,0]
    v_pk_fma_f32 v[104:105], v[168:169], v[198:199], v[104:105] op_sel:[0,0,0] op_sel_hi:[1,0,1] neg_lo:[0,1,0] neg_hi:[0,1,0]
    v_pk_fma_f32 v[120:121], v[168:169], v[198:199], v[120:121] op_sel:[0,1,0] op_sel_hi:[1,1,1] neg_lo:[0,1,0] neg_hi:[0,1,0]
    v_pk_fma_f32 v[136:137], v[168:169], v[200:201], v[136:137] op_sel:[0,0,0] op_sel_hi:[1,0,1] neg_lo:[0,1,0] neg_hi:[0,1,0]
    v_pk_fma_f32 v[152:153], v[168:169], v[200:201], v[152:153] op_sel:[0,1,0] op_sel_hi:[1,1,1] neg_lo:[0,1,0] neg_hi:[0,1,0]
    v_pk_mul_f32 v[8:9], v[8:9], v[184:185] op_sel:[0,0] op_sel_hi:[1,1]
    v_pk_mul_f32 v[24:25], v[24:25], v[184:185] op_sel:[0,0] op_sel_hi:[1,1]
    v_pk_mul_f32 v[40:41], v[40:41], v[184:185] op_sel:[0,0] op_sel_hi:[1,1]
    v_pk_mul_f32 v[56:57], v[56:57], v[184:185] op_sel:[0,0] op_sel_hi:[1,1]
    v_pk_mul_f32 v[72:73], v[72:73], v[184:185] op_sel:[0,0] op_sel_hi:[1,1]
    v_pk_mul_f32 v[88:89], v[88:89], v[184:185] op_sel:[0,0] op_sel_hi:[1,1]
    v_pk_mul_f32 v[104:105], v[104:105], v[184:185] op_sel:[0,0] op_sel_hi:[1,1]
    v_pk_mul_f32 v[120:121], v[120:121], v[184:185] op_sel:[0,0] op_sel_hi:[1,1]
    v_pk_mul_f32 v[136:137], v[136:137], v[184:185] op_sel:[0,0] op_sel_hi:[1,1]
    v_pk_mul_f32 v[152:153], v[152:153], v[184:185] op_sel:[0,0] op_sel_hi:[1,1]
    v_pk_fma_f32 v[10:11], v[170:171], v[192:193], v[10:11] op_sel:[0,0,0] op_sel_hi:[1,0,1] neg_lo:[0,1,0] neg_hi:[0,1,0]
    v_pk_fma_f32 v[26:27], v[170:171], v[192:193], v[26:27] op_sel:[0,1,0] op_sel_hi:[1,1,1] neg_lo:[0,1,0] neg_hi:[0,1,0]
    v_pk_fma_f32 v[42:43], v[170:171], v[194:195], v[42:43] op_sel:[0,0,0] op_sel_hi:[1,0,1] neg_lo:[0,1,0] neg_hi:[0,1,0]
    v_pk_fma_f32 v[58:59], v[170:171], v[194:195], v[58:59] op_sel:[0,1,0] op_sel_hi:[1,1,1] neg_lo:[0,1,0] neg_hi:[0,1,0]
    v_pk_fma_f32 v[74:75], v[170:171], v[196:197], v[74:75] op_sel:[0,0,0] op_sel_hi:[1,0,1] neg_lo:[0,1,0] neg_hi:[0,1,0]
    v_pk_fma_f32 v[90:91], v[170:171], v[196:197], v[90:91] op_sel:[0,1,0] op_sel_hi:[1,1,1] neg_lo:[0,1,0] neg_hi:[0,1,0]
    v_pk_fma_f32 v[106:107], v[170:171], v[198:199], v[106:107] op_sel:[0,0,0] op_sel_hi:[1,0,1] neg_lo:[0,1,0] neg_hi:[0,1,0]
    v_pk_fma_f32 v[122:123], v[170:171], v[198:199], v[122:123] op_sel:[0,1,0] op_sel_hi:[1,1,1] neg_lo:[0,1,0] neg_hi:[0,1,0]
    v_pk_fma_f32 v[138:139], v[170:171], v[200:201], v[138:139] op_sel:[0,0,0] op_sel_hi:[1,0,1] neg_lo:[0,1,0] neg_hi:[0,1,0]
    v_pk_fma_f32 v[154:155], v[170:171], v[200:201], v[154:155] op_sel:[0,1,0] op_sel_hi:[1,1,1] neg_lo:[0,1,0] neg_hi:[0,1,0]
    v_pk_mul_f32 v[10:11], v[10:11], v[186:187] op_sel:[0,0] op_sel_hi:[1,1]
    v_pk_mul_f32 v[26:27], v[26:27], v[186:187] op_sel:[0,0] op_sel_hi:[1,1]
    v_pk_mul_f32 v[42:43], v[42:43], v[186:187] op_sel:[0,0] op_sel_hi:[1,1]
    v_pk_mul_f32 v[58:59], v[58:59], v[186:187] op_sel:[0,0] op_sel_hi:[1,1]
    v_pk_mul_f32 v[74:75], v[74:75], v[186:187] op_sel:[0,0] op_sel_hi:[1,1]
    v_pk_mul_f32 v[90:91], v[90:91], v[186:187] op_sel:[0,0] op_sel_hi:[1,1]
    v_pk_mul_f32 v[106:107], v[106:107], v[186:187] op_sel:[0,0] op_sel_hi:[1,1]
    v_pk_mul_f32 v[122:123], v[122:123], v[186:187] op_sel:[0,0] op_sel_hi:[1,1]
    v_pk_mul_f32 v[138:139], v[138:139], v[186:187] op_sel:[0,0] op_sel_hi:[1,1]
    v_pk_mul_f32 v[154:155], v[154:155], v[186:187] op_sel:[0,0] op_sel_hi:[1,1]
    v_pk_fma_f32 v[12:13], v[172:173], v[192:193], v[12:13] op_sel:[0,0,0] op_sel_hi:[1,0,1] neg_lo:[0,1,0] neg_hi:[0,1,0]
    v_pk_fma_f32 v[28:29], v[172:173], v[192:193], v[28:29] op_sel:[0,1,0] op_sel_hi:[1,1,1] neg_lo:[0,1,0] neg_hi:[0,1,0]
    v_pk_fma_f32 v[44:45], v[172:173], v[194:195], v[44:45] op_sel:[0,0,0] op_sel_hi:[1,0,1] neg_lo:[0,1,0] neg_hi:[0,1,0]
    v_pk_fma_f32 v[60:61], v[172:173], v[194:195], v[60:61] op_sel:[0,1,0] op_sel_hi:[1,1,1] neg_lo:[0,1,0] neg_hi:[0,1,0]
    v_pk_fma_f32 v[76:77], v[172:173], v[196:197], v[76:77] op_sel:[0,0,0] op_sel_hi:[1,0,1] neg_lo:[0,1,0] neg_hi:[0,1,0]
    v_pk_fma_f32 v[92:93], v[172:173], v[196:197], v[92:93] op_sel:[0,1,0] op_sel_hi:[1,1,1] neg_lo:[0,1,0] neg_hi:[0,1,0]
    v_pk_fma_f32 v[108:109], v[172:173], v[198:199], v[108:109] op_sel:[0,0,0] op_sel_hi:[1,0,1] neg_lo:[0,1,0] neg_hi:[0,1,0]
    v_pk_fma_f32 v[124:125], v[172:173], v[198:199], v[124:125] op_sel:[0,1,0] op_sel_hi:[1,1,1] neg_lo:[0,1,0] neg_hi:[0,1,0]
    v_pk_fma_f32 v[140:141], v[172:173], v[200:201], v[140:141] op_sel:[0,0,0] op_sel_hi:[1,0,1] neg_lo:[0,1,0] neg_hi:[0,1,0]
    v_pk_fma_f32 v[156:157], v[172:173], v[200:201], v[156:157] op_sel:[0,1,0] op_sel_hi:[1,1,1] neg_lo:[0,1,0] neg_hi:[0,1,0]
    v_pk_mul_f32 v[12:13], v[12:13], v[188:189] op_sel:[0,0] op_sel_hi:[1,1]
    v_pk_mul_f32 v[28:29], v[28:29], v[188:189] op_sel:[0,0] op_sel_hi:[1,1]
    v_pk_mul_f32 v[44:45], v[44:45], v[188:189] op_sel:[0,0] op_sel_hi:[1,1]
    v_pk_mul_f32 v[60:61], v[60:61], v[188:189] op_sel:[0,0] op_sel_hi:[1,1]
    v_pk_mul_f32 v[76:77], v[76:77], v[188:189] op_sel:[0,0] op_sel_hi:[1,1]
    v_pk_mul_f32 v[92:93], v[92:93], v[188:189] op_sel:[0,0] op_sel_hi:[1,1]
    v_pk_mul_f32 v[108:109], v[108:109], v[188:189] op_sel:[0,0] op_sel_hi:[1,1]
    v_pk_mul_f32 v[124:125], v[124:125], v[188:189] op_sel:[0,0] op_sel_hi:[1,1]
    v_pk_mul_f32 v[140:141], v[140:141], v[188:189] op_sel:[0,0] op_sel_hi:[1,1]
    v_pk_mul_f32 v[156:157], v[156:157], v[188:189] op_sel:[0,0] op_sel_hi:[1,1]
    v_pk_fma_f32 v[14:15], v[174:175], v[192:193], v[14:15] op_sel:[0,0,0] op_sel_hi:[1,0,1] neg_lo:[0,1,0] neg_hi:[0,1,0]
    v_pk_fma_f32 v[30:31], v[174:175], v[192:193], v[30:31] op_sel:[0,1,0] op_sel_hi:[1,1,1] neg_lo:[0,1,0] neg_hi:[0,1,0]
    v_pk_fma_f32 v[46:47], v[174:175], v[194:195], v[46:47] op_sel:[0,0,0] op_sel_hi:[1,0,1] neg_lo:[0,1,0] neg_hi:[0,1,0]
    v_pk_fma_f32 v[62:63], v[174:175], v[194:195], v[62:63] op_sel:[0,1,0] op_sel_hi:[1,1,1] neg_lo:[0,1,0] neg_hi:[0,1,0]
    v_pk_fma_f32 v[78:79], v[174:175], v[196:197], v[78:79] op_sel:[0,0,0] op_sel_hi:[1,0,1] neg_lo:[0,1,0] neg_hi:[0,1,0]
    v_pk_fma_f32 v[94:95], v[174:175], v[196:197], v[94:95] op_sel:[0,1,0] op_sel_hi:[1,1,1] neg_lo:[0,1,0] neg_hi:[0,1,0]
    v_pk_fma_f32 v[110:111], v[174:175], v[198:199], v[110:111] op_sel:[0,0,0] op_sel_hi:[1,0,1] neg_lo:[0,1,0] neg_hi:[0,1,0]
    v_pk_fma_f32 v[126:127], v[174:175], v[198:199], v[126:127] op_sel:[0,1,0] op_sel_hi:[1,1,1] neg_lo:[0,1,0] neg_hi:[0,1,0]
    v_pk_fma_f32 v[142:143], v[174:175], v[200:201], v[142:143] op_sel:[0,0,0] op_sel_hi:[1,0,1] neg_lo:[0,1,0] neg_hi:[0,1,0]
    v_pk_fma_f32 v[158:159], v[174:175], v[200:201], v[158:159] op_sel:[0,1,0] op_sel_hi:[1,1,1] neg_lo:[0,1,0] neg_hi:[0,1,0]
    v_pk_mul_f32 v[14:15], v[14:15], v[190:191] op_sel:[0,0] op_sel_hi:[1,1]
    v_pk_mul_f32 v[30:31], v[30:31], v[190:191] op_sel:[0,0] op_sel_hi:[1,1]
    v_pk_mul_f32 v[46:47], v[46:47], v[190:191] op_sel:[0,0] op_sel_hi:[1,1]
    v_pk_mul_f32 v[62:63], v[62:63], v[190:191] op_sel:[0,0] op_sel_hi:[1,1]
    v_pk_mul_f32 v[78:79], v[78:79], v[190:191] op_sel:[0,0] op_sel_hi:[1,1]
    v_pk_mul_f32 v[94:95], v[94:95], v[190:191] op_sel:[0,0] op_sel_hi:[1,1]
    v_pk_mul_f32 v[110:111], v[110:111], v[190:191] op_sel:[0,0] op_sel_hi:[1,1]
    v_pk_mul_f32 v[126:127], v[126:127], v[190:191] op_sel:[0,0] op_sel_hi:[1,1]
    v_pk_mul_f32 v[142:143], v[142:143], v[190:191] op_sel:[0,0] op_sel_hi:[1,1]
    v_pk_mul_f32 v[158:159], v[158:159], v[190:191] op_sel:[0,0] op_sel_hi:[1,1]
    v_pk_fma_f32 v[2:3], v[0:1], v[202:203], v[2:3] op_sel:[0,0,0] op_sel_hi:[1,0,1]
    v_pk_fma_f32 v[18:19], v[16:17], v[202:203], v[18:19] op_sel:[0,0,0] op_sel_hi:[1,0,1]
    v_pk_fma_f32 v[34:35], v[32:33], v[204:205], v[34:35] op_sel:[0,0,0] op_sel_hi:[1,0,1]
    v_pk_fma_f32 v[50:51], v[48:49], v[204:205], v[50:51] op_sel:[0,0,0] op_sel_hi:[1,0,1]
    v_pk_fma_f32 v[66:67], v[64:65], v[206:207], v[66:67] op_sel:[0,0,0] op_sel_hi:[1,0,1]
    v_pk_fma_f32 v[82:83], v[80:81], v[206:207], v[82:83] op_sel:[0,0,0] op_sel_hi:[1,0,1]
    v_pk_fma_f32 v[98:99], v[96:97], v[208:209], v[98:99] op_sel:[0,0,0] op_sel_hi:[1,0,1]
    v_pk_fma_f32 v[114:115], v[112:113], v[208:209], v[114:115] op_sel:[0,0,0] op_sel_hi:[1,0,1]
    v_pk_fma_f32 v[130:131], v[128:129], v[210:211], v[130:131] op_sel:[0,0,0] op_sel_hi:[1,0,1]
    v_pk_fma_f32 v[146:147], v[144:145], v[210:211], v[146:147] op_sel:[0,0,0] op_sel_hi:[1,0,1]
    v_pk_fma_f32 v[2:3], v[16:17], v[202:203], v[2:3] op_sel:[0,1,0] op_sel_hi:[1,1,1] neg_lo:[0,1,0] neg_hi:[0,1,0]
    v_pk_fma_f32 v[18:19], v[0:1], v[202:203], v[18:19] op_sel:[0,1,0] op_sel_hi:[1,1,1]
    v_pk_fma_f32 v[34:35], v[48:49], v[204:205], v[34:35] op_sel:[0,1,0] op_sel_hi:[1,1,1] neg_lo:[0,1,0] neg_hi:[0,1,0]
    v_pk_fma_f32 v[50:51], v[32:33], v[204:205], v[50:51] op_sel:[0,1,0] op_sel_hi:[1,1,1]
    v_pk_fma_f32 v[66:67], v[80:81], v[206:207], v[66:67] op_sel:[0,1,0] op_sel_hi:[1,1,1] neg_lo:[0,1,0] neg_hi:[0,1,0]
    v_pk_fma_f32 v[82:83], v[64:65], v[206:207], v[82:83] op_sel:[0,1,0] op_sel_hi:[1,1,1]
    v_pk_fma_f32 v[98:99], v[112:113], v[208:209], v[98:99] op_sel:[0,1,0] op_sel_hi:[1,1,1] neg_lo:[0,1,0] neg_hi:[0,1,0]
    v_pk_fma_f32 v[114:115], v[96:97], v[208:209], v[114:115] op_sel:[0,1,0] op_sel_hi:[1,1,1]
    v_pk_fma_f32 v[130:131], v[144:145], v[210:211], v[130:131] op_sel:[0,1,0] op_sel_hi:[1,1,1] neg_lo:[0,1,0] neg_hi:[0,1,0]
    v_pk_fma_f32 v[146:147], v[128:129], v[210:211], v[146:147] op_sel:[0,1,0] op_sel_hi:[1,1,1]
    v_pk_fma_f32 v[4:5], v[2:3], v[202:203], v[4:5] op_sel:[0,0,0] op_sel_hi:[1,0,1]
    v_pk_fma_f32 v[20:21], v[18:19], v[202:203], v[20:21] op_sel:[0,0,0] op_sel_hi:[1,0,1]
    v_pk_fma_f32 v[36:37], v[34:35], v[204:205], v[36:37] op_sel:[0,0,0] op_sel_hi:[1,0,1]
    v_pk_fma_f32 v[52:53], v[50:51], v[204:205], v[52:53] op_sel:[0,0,0] op_sel_hi:[1,0,1]
    v_pk_fma_f32 v[68:69], v[66:67], v[206:207], v[68:69] op_sel:[0,0,0] op_sel_hi:[1,0,1]
    v_pk_fma_f32 v[84:85], v[82:83], v[206:207], v[84:85] op_sel:[0,0,0] op_sel_hi:[1,0,1]
    v_pk_fma_f32 v[100:101], v[98:99], v[208:209], v[100:101] op_sel:[0,0,0] op_sel_hi:[1,0,1]
    v_pk_fma_f32 v[116:117], v[114:115], v[208:209], v[116:117] op_sel:[0,0,0] op_sel_hi:[1,0,1]
    v_pk_fma_f32 v[132:133], v[130:131], v[210:211], v[132:133] op_sel:[0,0,0] op_sel_hi:[1,0,1]
    v_pk_fma_f32 v[148:149], v[146:147], v[210:211], v[148:149] op_sel:[0,0,0] op_sel_hi:[1,0,1]
    v_pk_fma_f32 v[4:5], v[18:19], v[202:203], v[4:5] op_sel:[0,1,0] op_sel_hi:[1,1,1] neg_lo:[0,1,0] neg_hi:[0,1,0]
    v_pk_fma_f32 v[20:21], v[2:3], v[202:203], v[20:21] op_sel:[0,1,0] op_sel_hi:[1,1,1]
    v_pk_fma_f32 v[36:37], v[50:51], v[204:205], v[36:37] op_sel:[0,1,0] op_sel_hi:[1,1,1] neg_lo:[0,1,0] neg_hi:[0,1,0]
    v_pk_fma_f32 v[52:53], v[34:35], v[204:205], v[52:53] op_sel:[0,1,0] op_sel_hi:[1,1,1]
    v_pk_fma_f32 v[68:69], v[82:83], v[206:207], v[68:69] op_sel:[0,1,0] op_sel_hi:[1,1,1] neg_lo:[0,1,0] neg_hi:[0,1,0]
    v_pk_fma_f32 v[84:85], v[66:67], v[206:207], v[84:85] op_sel:[0,1,0] op_sel_hi:[1,1,1]
    v_pk_fma_f32 v[100:101], v[114:115], v[208:209], v[100:101] op_sel:[0,1,0] op_sel_hi:[1,1,1] neg_lo:[0,1,0] neg_hi:[0,1,0]
    v_pk_fma_f32 v[116:117], v[98:99], v[208:209], v[116:117] op_sel:[0,1,0] op_sel_hi:[1,1,1]
    v_pk_fma_f32 v[132:133], v[146:147], v[210:211], v[132:133] op_sel:[0,1,0] op_sel_hi:[1,1,1] neg_lo:[0,1,0] neg_hi:[0,1,0]
    v_pk_fma_f32 v[148:149], v[130:131], v[210:211], v[148:149] op_sel:[0,1,0] op_sel_hi:[1,1,1]
    v_pk_fma_f32 v[6:7], v[4:5], v[202:203], v[6:7] op_sel:[0,0,0] op_sel_hi:[1,0,1]
    v_pk_fma_f32 v[22:23], v[20:21], v[202:203], v[22:23] op_sel:[0,0,0] op_sel_hi:[1,0,1]
    v_pk_fma_f32 v[38:39], v[36:37], v[204:205], v[38:39] op_sel:[0,0,0] op_sel_hi:[1,0,1]
    v_pk_fma_f32 v[54:55], v[52:53], v[204:205], v[54:55] op_sel:[0,0,0] op_sel_hi:[1,0,1]
    v_pk_fma_f32 v[70:71], v[68:69], v[206:207], v[70:71] op_sel:[0,0,0] op_sel_hi:[1,0,1]
    v_pk_fma_f32 v[86:87], v[84:85], v[206:207], v[86:87] op_sel:[0,0,0] op_sel_hi:[1,0,1]
    v_pk_fma_f32 v[102:103], v[100:101], v[208:209], v[102:103] op_sel:[0,0,0] op_sel_hi:[1,0,1]
    v_pk_fma_f32 v[118:119], v[116:117], v[208:209], v[118:119] op_sel:[0,0,0] op_sel_hi:[1,0,1]
    v_pk_fma_f32 v[134:135], v[132:133], v[210:211], v[134:135] op_sel:[0,0,0] op_sel_hi:[1,0,1]
    v_pk_fma_f32 v[150:151], v[148:149], v[210:211], v[150:151] op_sel:[0,0,0] op_sel_hi:[1,0,1]
    v_pk_fma_f32 v[6:7], v[20:21], v[202:203], v[6:7] op_sel:[0,1,0] op_sel_hi:[1,1,1] neg_lo:[0,1,0] neg_hi:[0,1,0]
    v_pk_fma_f32 v[22:23], v[4:5], v[202:203], v[22:23] op_sel:[0,1,0] op_sel_hi:[1,1,1]
    v_pk_fma_f32 v[38:39], v[52:53], v[204:205], v[38:39] op_sel:[0,1,0] op_sel_hi:[1,1,1] neg_lo:[0,1,0] neg_hi:[0,1,0]
    v_pk_fma_f32 v[54:55], v[36:37], v[204:205], v[54:55] op_sel:[0,1,0] op_sel_hi:[1,1,1]
    v_pk_fma_f32 v[70:71], v[84:85], v[206:207], v[70:71] op_sel:[0,1,0] op_sel_hi:[1,1,1] neg_lo:[0,1,0] neg_hi:[0,1,0]
    v_pk_fma_f32 v[86:87], v[68:69], v[206:207], v[86:87] op_sel:[0,1,0] op_sel_hi:[1,1,1]
    v_pk_fma_f32 v[102:103], v[116:117], v[208:209], v[102:103] op_sel:[0,1,0] op_sel_hi:[1,1,1] neg_lo:[0,1,0] neg_hi:[0,1,0]
    v_pk_fma_f32 v[118:119], v[100:101], v[208:209], v[118:119] op_sel:[0,1,0] op_sel_hi:[1,1,1]
    v_pk_fma_f32 v[134:135], v[148:149], v[210:211], v[134:135] op_sel:[0,1,0] op_sel_hi:[1,1,1] neg_lo:[0,1,0] neg_hi:[0,1,0]
    v_pk_fma_f32 v[150:151], v[132:133], v[210:211], v[150:151] op_sel:[0,1,0] op_sel_hi:[1,1,1]
    v_pk_fma_f32 v[8:9], v[6:7], v[202:203], v[8:9] op_sel:[0,0,0] op_sel_hi:[1,0,1]
    v_pk_fma_f32 v[24:25], v[22:23], v[202:203], v[24:25] op_sel:[0,0,0] op_sel_hi:[1,0,1]
    v_pk_fma_f32 v[40:41], v[38:39], v[204:205], v[40:41] op_sel:[0,0,0] op_sel_hi:[1,0,1]
    v_pk_fma_f32 v[56:57], v[54:55], v[204:205], v[56:57] op_sel:[0,0,0] op_sel_hi:[1,0,1]
    v_pk_fma_f32 v[72:73], v[70:71], v[206:207], v[72:73] op_sel:[0,0,0] op_sel_hi:[1,0,1]
    v_pk_fma_f32 v[88:89], v[86:87], v[206:207], v[88:89] op_sel:[0,0,0] op_sel_hi:[1,0,1]
    v_pk_fma_f32 v[104:105], v[102:103], v[208:209], v[104:105] op_sel:[0,0,0] op_sel_hi:[1,0,1]
    v_pk_fma_f32 v[120:121], v[118:119], v[208:209], v[120:121] op_sel:[0,0,0] op_sel_hi:[1,0,1]
    v_pk_fma_f32 v[136:137], v[134:135], v[210:211], v[136:137] op_sel:[0,0,0] op_sel_hi:[1,0,1]
    v_pk_fma_f32 v[152:153], v[150:151], v[210:211], v[152:153] op_sel:[0,0,0] op_sel_hi:[1,0,1]
    v_pk_fma_f32 v[8:9], v[22:23], v[202:203], v[8:9] op_sel:[0,1,0] op_sel_hi:[1,1,1] neg_lo:[0,1,0] neg_hi:[0,1,0]
    v_pk_fma_f32 v[24:25], v[6:7], v[202:203], v[24:25] op_sel:[0,1,0] op_sel_hi:[1,1,1]
    v_pk_fma_f32 v[40:41], v[54:55], v[204:205], v[40:41] op_sel:[0,1,0] op_sel_hi:[1,1,1] neg_lo:[0,1,0] neg_hi:[0,1,0]
    v_pk_fma_f32 v[56:57], v[38:39], v[204:205], v[56:57] op_sel:[0,1,0] op_sel_hi:[1,1,1]
    v_pk_fma_f32 v[72:73], v[86:87], v[206:207], v[72:73] op_sel:[0,1,0] op_sel_hi:[1,1,1] neg_lo:[0,1,0] neg_hi:[0,1,0]
    v_pk_fma_f32 v[88:89], v[70:71], v[206:207], v[88:89] op_sel:[0,1,0] op_sel_hi:[1,1,1]
    v_pk_fma_f32 v[104:105], v[118:119], v[208:209], v[104:105] op_sel:[0,1,0] op_sel_hi:[1,1,1] neg_lo:[0,1,0] neg_hi:[0,1,0]
    v_pk_fma_f32 v[120:121], v[102:103], v[208:209], v[120:121] op_sel:[0,1,0] op_sel_hi:[1,1,1]
    v_pk_fma_f32 v[136:137], v[150:151], v[210:211], v[136:137] op_sel:[0,1,0] op_sel_hi:[1,1,1] neg_lo:[0,1,0] neg_hi:[0,1,0]
    v_pk_fma_f32 v[152:153], v[134:135], v[210:211], v[152:153] op_sel:[0,1,0] op_sel_hi:[1,1,1]
    v_pk_fma_f32 v[10:11], v[8:9], v[202:203], v[10:11] op_sel:[0,0,0] op_sel_hi:[1,0,1]
    v_pk_fma_f32 v[26:27], v[24:25], v[202:203], v[26:27] op_sel:[0,0,0] op_sel_hi:[1,0,1]
    v_pk_fma_f32 v[42:43], v[40:41], v[204:205], v[42:43] op_sel:[0,0,0] op_sel_hi:[1,0,1]
    v_pk_fma_f32 v[58:59], v[56:57], v[204:205], v[58:59] op_sel:[0,0,0] op_sel_hi:[1,0,1]
    v_pk_fma_f32 v[74:75], v[72:73], v[206:207], v[74:75] op_sel:[0,0,0] op_sel_hi:[1,0,1]
    v_pk_fma_f32 v[90:91], v[88:89], v[206:207], v[90:91] op_sel:[0,0,0] op_sel_hi:[1,0,1]
    v_pk_fma_f32 v[106:107], v[104:105], v[208:209], v[106:107] op_sel:[0,0,0] op_sel_hi:[1,0,1]
    v_pk_fma_f32 v[122:123], v[120:121], v[208:209], v[122:123] op_sel:[0,0,0] op_sel_hi:[1,0,1]
    v_pk_fma_f32 v[138:139], v[136:137], v[210:211], v[138:139] op_sel:[0,0,0] op_sel_hi:[1,0,1]
    v_pk_fma_f32 v[154:155], v[152:153], v[210:211], v[154:155] op_sel:[0,0,0] op_sel_hi:[1,0,1]
    v_pk_fma_f32 v[10:11], v[24:25], v[202:203], v[10:11] op_sel:[0,1,0] op_sel_hi:[1,1,1] neg_lo:[0,1,0] neg_hi:[0,1,0]
    v_pk_fma_f32 v[26:27], v[8:9], v[202:203], v[26:27] op_sel:[0,1,0] op_sel_hi:[1,1,1]
    v_pk_fma_f32 v[42:43], v[56:57], v[204:205], v[42:43] op_sel:[0,1,0] op_sel_hi:[1,1,1] neg_lo:[0,1,0] neg_hi:[0,1,0]
    v_pk_fma_f32 v[58:59], v[40:41], v[204:205], v[58:59] op_sel:[0,1,0] op_sel_hi:[1,1,1]
    v_pk_fma_f32 v[74:75], v[88:89], v[206:207], v[74:75] op_sel:[0,1,0] op_sel_hi:[1,1,1] neg_lo:[0,1,0] neg_hi:[0,1,0]
    v_pk_fma_f32 v[90:91], v[72:73], v[206:207], v[90:91] op_sel:[0,1,0] op_sel_hi:[1,1,1]
    v_pk_fma_f32 v[106:107], v[120:121], v[208:209], v[106:107] op_sel:[0,1,0] op_sel_hi:[1,1,1] neg_lo:[0,1,0] neg_hi:[0,1,0]
    v_pk_fma_f32 v[122:123], v[104:105], v[208:209], v[122:123] op_sel:[0,1,0] op_sel_hi:[1,1,1]
    v_pk_fma_f32 v[138:139], v[152:153], v[210:211], v[138:139] op_sel:[0,1,0] op_sel_hi:[1,1,1] neg_lo:[0,1,0] neg_hi:[0,1,0]
    v_pk_fma_f32 v[154:155], v[136:137], v[210:211], v[154:155] op_sel:[0,1,0] op_sel_hi:[1,1,1]
    v_pk_fma_f32 v[12:13], v[10:11], v[202:203], v[12:13] op_sel:[0,0,0] op_sel_hi:[1,0,1]
    v_pk_fma_f32 v[28:29], v[26:27], v[202:203], v[28:29] op_sel:[0,0,0] op_sel_hi:[1,0,1]
    v_pk_fma_f32 v[44:45], v[42:43], v[204:205], v[44:45] op_sel:[0,0,0] op_sel_hi:[1,0,1]
    v_pk_fma_f32 v[60:61], v[58:59], v[204:205], v[60:61] op_sel:[0,0,0] op_sel_hi:[1,0,1]
    v_pk_fma_f32 v[76:77], v[74:75], v[206:207], v[76:77] op_sel:[0,0,0] op_sel_hi:[1,0,1]
    v_pk_fma_f32 v[92:93], v[90:91], v[206:207], v[92:93] op_sel:[0,0,0] op_sel_hi:[1,0,1]
    v_pk_fma_f32 v[108:109], v[106:107], v[208:209], v[108:109] op_sel:[0,0,0] op_sel_hi:[1,0,1]
    v_pk_fma_f32 v[124:125], v[122:123], v[208:209], v[124:125] op_sel:[0,0,0] op_sel_hi:[1,0,1]
    v_pk_fma_f32 v[140:141], v[138:139], v[210:211], v[140:141] op_sel:[0,0,0] op_sel_hi:[1,0,1]
    v_pk_fma_f32 v[156:157], v[154:155], v[210:211], v[156:157] op_sel:[0,0,0] op_sel_hi:[1,0,1]
    v_pk_fma_f32 v[12:13], v[26:27], v[202:203], v[12:13] op_sel:[0,1,0] op_sel_hi:[1,1,1] neg_lo:[0,1,0] neg_hi:[0,1,0]
    v_pk_fma_f32 v[28:29], v[10:11], v[202:203], v[28:29] op_sel:[0,1,0] op_sel_hi:[1,1,1]
    v_pk_fma_f32 v[44:45], v[58:59], v[204:205], v[44:45] op_sel:[0,1,0] op_sel_hi:[1,1,1] neg_lo:[0,1,0] neg_hi:[0,1,0]
    v_pk_fma_f32 v[60:61], v[42:43], v[204:205], v[60:61] op_sel:[0,1,0] op_sel_hi:[1,1,1]
    v_pk_fma_f32 v[76:77], v[90:91], v[206:207], v[76:77] op_sel:[0,1,0] op_sel_hi:[1,1,1] neg_lo:[0,1,0] neg_hi:[0,1,0]
    v_pk_fma_f32 v[92:93], v[74:75], v[206:207], v[92:93] op_sel:[0,1,0] op_sel_hi:[1,1,1]
    v_pk_fma_f32 v[108:109], v[122:123], v[208:209], v[108:109] op_sel:[0,1,0] op_sel_hi:[1,1,1] neg_lo:[0,1,0] neg_hi:[0,1,0]
    v_pk_fma_f32 v[124:125], v[106:107], v[208:209], v[124:125] op_sel:[0,1,0] op_sel_hi:[1,1,1]
    v_pk_fma_f32 v[140:141], v[154:155], v[210:211], v[140:141] op_sel:[0,1,0] op_sel_hi:[1,1,1] neg_lo:[0,1,0] neg_hi:[0,1,0]
    v_pk_fma_f32 v[156:157], v[138:139], v[210:211], v[156:157] op_sel:[0,1,0] op_sel_hi:[1,1,1]
    v_pk_fma_f32 v[14:15], v[12:13], v[202:203], v[14:15] op_sel:[0,0,0] op_sel_hi:[1,0,1]
    v_pk_fma_f32 v[30:31], v[28:29], v[202:203], v[30:31] op_sel:[0,0,0] op_sel_hi:[1,0,1]
    v_pk_fma_f32 v[46:47], v[44:45], v[204:205], v[46:47] op_sel:[0,0,0] op_sel_hi:[1,0,1]
    v_pk_fma_f32 v[62:63], v[60:61], v[204:205], v[62:63] op_sel:[0,0,0] op_sel_hi:[1,0,1]
    v_pk_fma_f32 v[78:79], v[76:77], v[206:207], v[78:79] op_sel:[0,0,0] op_sel_hi:[1,0,1]
    v_pk_fma_f32 v[94:95], v[92:93], v[206:207], v[94:95] op_sel:[0,0,0] op_sel_hi:[1,0,1]
    v_pk_fma_f32 v[110:111], v[108:109], v[208:209], v[110:111] op_sel:[0,0,0] op_sel_hi:[1,0,1]
    v_pk_fma_f32 v[126:127], v[124:125], v[208:209], v[126:127] op_sel:[0,0,0] op_sel_hi:[1,0,1]
    v_pk_fma_f32 v[142:143], v[140:141], v[210:211], v[142:143] op_sel:[0,0,0] op_sel_hi:[1,0,1]
    v_pk_fma_f32 v[158:159], v[156:157], v[210:211], v[158:159] op_sel:[0,0,0] op_sel_hi:[1,0,1]
    v_pk_fma_f32 v[14:15], v[28:29], v[202:203], v[14:15] op_sel:[0,1,0] op_sel_hi:[1,1,1] neg_lo:[0,1,0] neg_hi:[0,1,0]
    v_pk_fma_f32 v[30:31], v[12:13], v[202:203], v[30:31] op_sel:[0,1,0] op_sel_hi:[1,1,1]
    v_pk_fma_f32 v[46:47], v[60:61], v[204:205], v[46:47] op_sel:[0,1,0] op_sel_hi:[1,1,1] neg_lo:[0,1,0] neg_hi:[0,1,0]
    v_pk_fma_f32 v[62:63], v[44:45], v[204:205], v[62:63] op_sel:[0,1,0] op_sel_hi:[1,1,1]
    v_pk_fma_f32 v[78:79], v[92:93], v[206:207], v[78:79] op_sel:[0,1,0] op_sel_hi:[1,1,1] neg_lo:[0,1,0] neg_hi:[0,1,0]
    v_pk_fma_f32 v[94:95], v[76:77], v[206:207], v[94:95] op_sel:[0,1,0] op_sel_hi:[1,1,1]
    v_pk_fma_f32 v[110:111], v[124:125], v[208:209], v[110:111] op_sel:[0,1,0] op_sel_hi:[1,1,1] neg_lo:[0,1,0] neg_hi:[0,1,0]
    v_pk_fma_f32 v[126:127], v[108:109], v[208:209], v[126:127] op_sel:[0,1,0] op_sel_hi:[1,1,1]
    v_pk_fma_f32 v[142:143], v[156:157], v[210:211], v[142:143] op_sel:[0,1,0] op_sel_hi:[1,1,1] neg_lo:[0,1,0] neg_hi:[0,1,0]
    v_pk_fma_f32 v[158:159], v[140:141], v[210:211], v[158:159] op_sel:[0,1,0] op_sel_hi:[1,1,1]
    v_and_b32 v248, 3, v254
    v_lshlrev_b32 v248, 9, v248
    v_add_u32 v248, 159996, v248
    ds_read_b32 v250, v248 offset:72
    s_waitcnt lgkmcnt(0)
    v_cmp_ne_u32 vcc, s3, v250
    s_cbranch_vccnz L_sw_114
L_bk_115:
    ds_write2_b32 v227, v14, v30 offset0:0 offset1:1
    ds_write2_b32 v229, v15, v31 offset0:0 offset1:1
    ds_write2_b32 v227, v46, v62 offset0:32 offset1:33
    ds_write2_b32 v229, v47, v63 offset0:32 offset1:33
    ds_write2_b32 v227, v78, v94 offset0:64 offset1:65
    ds_write2_b32 v229, v79, v95 offset0:64 offset1:65
    ds_write2_b32 v227, v110, v126 offset0:96 offset1:97
    ds_write2_b32 v229, v111, v127 offset0:96 offset1:97
    ds_write2_b32 v227, v142, v158 offset0:128 offset1:129
    ds_write2_b32 v229, v143, v159 offset0:128 offset1:129
    s_waitcnt lgkmcnt(0)
    s_setprio 0
    s_barrier
    v_pk_mul_f32 v[160:161], v[0:1], v[212:213] op_sel:[0,1] op_sel_hi:[1,1]
    v_pk_mul_f32 v[162:163], v[32:33], v[214:215] op_sel:[0,1] op_sel_hi:[1,1]
    v_pk_mul_f32 v[164:165], v[64:65], v[216:217] op_sel:[0,1] op_sel_hi:[1,1]
    v_pk_mul_f32 v[166:167], v[96:97], v[218:219] op_sel:[0,1] op_sel_hi:[1,1]
    v_pk_mul_f32 v[168:169], v[128:129], v[220:221] op_sel:[0,1] op_sel_hi:[1,1]
    v_pk_mul_f32 v[0:1], v[0:1], v[212:213] op_sel:[0,0] op_sel_hi:[1,0]
    v_pk_mul_f32 v[32:33], v[32:33], v[214:215] op_sel:[0,0] op_sel_hi:[1,0]
    v_pk_mul_f32 v[64:65], v[64:65], v[216:217] op_sel:[0,0] op_sel_hi:[1,0]
    v_pk_mul_f32 v[96:97], v[96:97], v[218:219] op_sel:[0,0] op_sel_hi:[1,0]
    v_pk_mul_f32 v[128:129], v[128:129], v[220:221] op_sel:[0,0] op_sel_hi:[1,0]
    v_pk_fma_f32 v[0:1], v[16:17], v[212:213], v[0:1] op_sel:[0,1,0] op_sel_hi:[1,1,1]
    v_pk_fma_f32 v[32:33], v[48:49], v[214:215], v[32:33] op_sel:[0,1,0] op_sel_hi:[1,1,1]
    v_pk_fma_f32 v[64:65], v[80:81], v[216:217], v[64:65] op_sel:[0,1,0] op_sel_hi:[1,1,1]
    v_pk_fma_f32 v[96:97], v[112:113], v[218:219], v[96:97] op_sel:[0,1,0] op_sel_hi:[1,1,1]
    v_pk_fma_f32 v[128:129], v[144:145], v[220:221], v[128:129] op_sel:[0,1,0] op_sel_hi:[1,1,1]
    v_pk_fma_f32 v[16:17], v[16:17], v[212:213], v[160:161] op_sel:[0,0,0] op_sel_hi:[1,0,1] neg_lo:[0,1,0] neg_hi:[0,1,0]
    v_pk_fma_f32 v[48:49], v[48:49], v[214:215], v[162:163] op_sel:[0,0,0] op_sel_hi:[1,0,1] neg_lo:[0,1,0] neg_hi:[0,1,0]
    v_pk_fma_f32 v[80:81], v[80:81], v[216:217], v[164:165] op_sel:[0,0,0] op_sel_hi:[1,0,1] neg_lo:[0,1,0] neg_hi:[0,1,0]
    v_pk_fma_f32 v[112:113], v[112:113], v[218:219], v[166:167] op_sel:[0,0,0] op_sel_hi:[1,0,1] neg_lo:[0,1,0] neg_hi:[0,1,0]
    v_pk_fma_f32 v[144:145], v[144:145], v[220:221], v[168:169] op_sel:[0,0,0] op_sel_hi:[1,0,1] neg_lo:[0,1,0] neg_hi:[0,1,0]
    v_pk_mul_f32 v[160:161], v[2:3], v[212:213] op_sel:[0,1] op_sel_hi:[1,1]
    v_pk_mul_f32 v[162:163], v[34:35], v[214:215] op_sel:[0,1] op_sel_hi:[1,1]
    v_pk_mul_f32 v[164:165], v[66:67], v[216:217] op_sel:[0,1] op_sel_hi:[1,1]
    v_pk_mul_f32 v[166:167], v[98:99], v[218:219] op_sel:[0,1] op_sel_hi:[1,1]
    v_pk_mul_f32 v[168:169], v[130:131], v[220:221] op_sel:[0,1] op_sel_hi:[1,1]
    v_pk_mul_f32 v[2:3], v[2:3], v[212:213] op_sel:[0,0] op_sel_hi:[1,0]
    v_pk_mul_f32 v[34:35], v[34:35], v[214:215] op_sel:[0,0] op_sel_hi:[1,0]
    v_pk_mul_f32 v[66:67], v[66:67], v[216:217] op_sel:[0,0] op_sel_hi:[1,0]
    v_pk_mul_f32 v[98:99], v[98:99], v[218:219] op_sel:[0,0] op_sel_hi:[1,0]
    v_pk_mul_f32 v[130:131], v[130:131], v[220:221] op_sel:[0,0] op_sel_hi:[1,0]
    v_pk_fma_f32 v[2:3], v[18:19], v[212:213], v[2:3] op_sel:[0,1,0] op_sel_hi:[1,1,1]
    v_pk_fma_f32 v[34:35], v[50:51], v[214:215], v[34:35] op_sel:[0,1,0] op_sel_hi:[1,1,1]
    v_pk_fma_f32 v[66:67], v[82:83], v[216:217], v[66:67] op_sel:[0,1,0] op_sel_hi:[1,1,1]
    v_pk_fma_f32 v[98:99], v[114:115], v[218:219], v[98:99] op_sel:[0,1,0] op_sel_hi:[1,1,1]
    v_pk_fma_f32 v[130:131], v[146:147], v[220:221], v[130:131] op_sel:[0,1,0] op_sel_hi:[1,1,1]
    v_pk_fma_f32 v[18:19], v[18:19], v[212:213], v[160:161] op_sel:[0,0,0] op_sel_hi:[1,0,1] neg_lo:[0,1,0] neg_hi:[0,1,0]
    v_pk_fma_f32 v[50:51], v[50:51], v[214:215], v[162:163] op_sel:[0,0,0] op_sel_hi:[1,0,1] neg_lo:[0,1,0] neg_hi:[0,1,0]
    v_pk_fma_f32 v[82:83], v[82:83], v[216:217], v[164:165] op_sel:[0,0,0] op_sel_hi:[1,0,1] neg_lo:[0,1,0] neg_hi:[0,1,0]
    v_pk_fma_f32 v[114:115], v[114:115], v[218:219], v[166:167] op_sel:[0,0,0] op_sel_hi:[1,0,1] neg_lo:[0,1,0] neg_hi:[0,1,0]
    v_pk_fma_f32 v[146:147], v[146:147], v[220:221], v[168:169] op_sel:[0,0,0] op_sel_hi:[1,0,1] neg_lo:[0,1,0] neg_hi:[0,1,0]
    v_pk_mul_f32 v[160:161], v[4:5], v[212:213] op_sel:[0,1] op_sel_hi:[1,1]
    v_pk_mul_f32 v[162:163], v[36:37], v[214:215] op_sel:[0,1] op_sel_hi:[1,1]
    v_pk_mul_f32 v[164:165], v[68:69], v[216:217] op_sel:[0,1] op_sel_hi:[1,1]
    v_pk_mul_f32 v[166:167], v[100:101], v[218:219] op_sel:[0,1] op_sel_hi:[1,1]
    v_pk_mul_f32 v[168:169], v[132:133], v[220:221] op_sel:[0,1] op_sel_hi:[1,1]
    v_pk_mul_f32 v[4:5], v[4:5], v[212:213] op_sel:[0,0] op_sel_hi:[1,0]
    v_pk_mul_f32 v[36:37], v[36:37], v[214:215] op_sel:[0,0] op_sel_hi:[1,0]
    v_pk_mul_f32 v[68:69], v[68:69], v[216:217] op_sel:[0,0] op_sel_hi:[1,0]
    v_pk_mul_f32 v[100:101], v[100:101], v[218:219] op_sel:[0,0] op_sel_hi:[1,0]
    v_pk_mul_f32 v[132:133], v[132:133], v[220:221] op_sel:[0,0] op_sel_hi:[1,0]
    v_pk_fma_f32 v[4:5], v[20:21], v[212:213], v[4:5] op_sel:[0,1,0] op_sel_hi:[1,1,1]
    v_pk_fma_f32 v[36:37], v[52:53], v[214:215], v[36:37] op_sel:[0,1,0] op_sel_hi:[1,1,1]
    v_pk_fma_f32 v[68:69], v[84:85], v[216:217], v[68:69] op_sel:[0,1,0] op_sel_hi:[1,1,1]
    v_pk_fma_f32 v[100:101], v[116:117], v[218:219], v[100:101] op_sel:[0,1,0] op_sel_hi:[1,1,1]
    v_pk_fma_f32 v[132:133], v[148:149], v[220:221], v[132:133] op_sel:[0,1,0] op_sel_hi:[1,1,1]
    v_pk_fma_f32 v[20:21], v[20:21], v[212:213], v[160:161] op_sel:[0,0,0] op_sel_hi:[1,0,1] neg_lo:[0,1,0] neg_hi:[0,1,0]
    v_pk_fma_f32 v[52:53], v[52:53], v[214:215], v[162:163] op_sel:[0,0,0] op_sel_hi:[1,0,1] neg_lo:[0,1,0] neg_hi:[0,1,0]
    v_pk_fma_f32 v[84:85], v[84:85], v[216:217], v[164:165] op_sel:[0,0,0] op_sel_hi:[1,0,1] neg_lo:[0,1,0] neg_hi:[0,1,0]
    v_pk_fma_f32 v[116:117], v[116:117], v[218:219], v[166:167] op_sel:[0,0,0] op_sel_hi:[1,0,1] neg_lo:[0,1,0] neg_hi:[0,1,0]
    v_pk_fma_f32 v[148:149], v[148:149], v[220:221], v[168:169] op_sel:[0,0,0] op_sel_hi:[1,0,1] neg_lo:[0,1,0] neg_hi:[0,1,0]
    v_pk_mul_f32 v[160:161], v[6:7], v[212:213] op_sel:[0,1] op_sel_hi:[1,1]
    v_pk_mul_f32 v[162:163], v[38:39], v[214:215] op_sel:[0,1] op_sel_hi:[1,1]
    v_pk_mul_f32 v[164:165], v[70:71], v[216:217] op_sel:[0,1] op_sel_hi:[1,1]
    v_pk_mul_f32 v[166:167], v[102:103], v[218:219] op_sel:[0,1] op_sel_hi:[1,1]
    v_pk_mul_f32 v[168:169], v[134:135], v[220:221] op_sel:[0,1] op_sel_hi:[1,1]
    v_pk_mul_f32 v[6:7], v[6:7], v[212:213] op_sel:[0,0] op_sel_hi:[1,0]
    v_pk_mul_f32 v[38:39], v[38:39], v[214:215] op_sel:[0,0] op_sel_hi:[1,0]
    v_pk_mul_f32 v[70:71], v[70:71], v[216:217] op_sel:[0,0] op_sel_hi:[1,0]
    v_pk_mul_f32 v[102:103], v[102:103], v[218:219] op_sel:[0,0] op_sel_hi:[1,0]
    v_pk_mul_f32 v[134:135], v[134:135], v[220:221] op_sel:[0,0] op_sel_hi:[1,0]
    v_pk_fma_f32 v[6:7], v[22:23], v[212:213], v[6:7] op_sel:[0,1,0] op_sel_hi:[1,1,1]
    v_pk_fma_f32 v[38:39], v[54:55], v[214:215], v[38:39] op_sel:[0,1,0] op_sel_hi:[1,1,1]
    v_pk_fma_f32 v[70:71], v[86:87], v[216:217], v[70:71] op_sel:[0,1,0] op_sel_hi:[1,1,1]
    v_pk_fma_f32 v[102:103], v[118:119], v[218:219], v[102:103] op_sel:[0,1,0] op_sel_hi:[1,1,1]
    v_pk_fma_f32 v[134:135], v[150:151], v[220:221], v[134:135] op_sel:[0,1,0] op_sel_hi:[1,1,1]
    v_pk_fma_f32 v[22:23], v[22:23], v[212:213], v[160:161] op_sel:[0,0,0] op_sel_hi:[1,0,1] neg_lo:[0,1,0] neg_hi:[0,1,0]
    v_pk_fma_f32 v[54:55], v[54:55], v[214:215], v[162:163] op_sel:[0,0,0] op_sel_hi:[1,0,1] neg_lo:[0,1,0] neg_hi:[0,1,0]
    v_pk_fma_f32 v[86:87], v[86:87], v[216:217], v[164:165] op_sel:[0,0,0] op_sel_hi:[1,0,1] neg_lo:[0,1,0] neg_hi:[0,1,0]
    v_pk_fma_f32 v[118:119], v[118:119], v[218:219], v[166:167] op_sel:[0,0,0] op_sel_hi:[1,0,1] neg_lo:[0,1,0] neg_hi:[0,1,0]
    v_pk_fma_f32 v[150:151], v[150:151], v[220:221], v[168:169] op_sel:[0,0,0] op_sel_hi:[1,0,1] neg_lo:[0,1,0] neg_hi:[0,1,0]
    v_pk_mul_f32 v[160:161], v[8:9], v[212:213] op_sel:[0,1] op_sel_hi:[1,1]
    v_pk_mul_f32 v[162:163], v[40:41], v[214:215] op_sel:[0,1] op_sel_hi:[1,1]
    v_pk_mul_f32 v[164:165], v[72:73], v[216:217] op_sel:[0,1] op_sel_hi:[1,1]
    v_pk_mul_f32 v[166:167], v[104:105], v[218:219] op_sel:[0,1] op_sel_hi:[1,1]
    v_pk_mul_f32 v[168:169], v[136:137], v[220:221] op_sel:[0,1] op_sel_hi:[1,1]
    v_pk_mul_f32 v[8:9], v[8:9], v[212:213] op_sel:[0,0] op_sel_hi:[1,0]
    v_pk_mul_f32 v[40:41], v[40:41], v[214:215] op_sel:[0,0] op_sel_hi:[1,0]
    v_pk_mul_f32 v[72:73], v[72:73], v[216:217] op_sel:[0,0] op_sel_hi:[1,0]
    v_pk_mul_f32 v[104:105], v[104:105], v[218:219] op_sel:[0,0] op_sel_hi:[1,0]
    v_pk_mul_f32 v[136:137], v[136:137], v[220:221] op_sel:[0,0] op_sel_hi:[1,0]
    v_pk_fma_f32 v[8:9], v[24:25], v[212:213], v[8:9] op_sel:[0,1,0] op_sel_hi:[1,1,1]
    v_pk_fma_f32 v[40:41], v[56:57], v[214:215], v[40:41] op_sel:[0,1,0] op_sel_hi:[1,1,1]
    v_pk_fma_f32 v[72:73], v[88:89], v[216:217], v[72:73] op_sel:[0,1,0] op_sel_hi:[1,1,1]
    v_pk_fma_f32 v[104:105], v[120:121], v[218:219], v[104:105] op_sel:[0,1,0] op_sel_hi:[1,1,1]
    v_pk_fma_f32 v[136:137], v[152:153], v[220:221], v[136:137] op_sel:[0,1,0] op_sel_hi:[1,1,1]
    v_pk_fma_f32 v[24:25], v[24:25], v[212:213], v[160:161] op_sel:[0,0,0] op_sel_hi:[1,0,1] neg_lo:[0,1,0] neg_hi:[0,1,0]
    v_pk_fma_f32 v[56:57], v[56:57], v[214:215], v[162:163] op_sel:[0,0,0] op_sel_hi:[1,0,1] neg_lo:[0,1,0] neg_hi:[0,1,0]
    v_pk_fma_f32 v[88:89], v[88:89], v[216:217], v[164:165] op_sel:[0,0,0] op_sel_hi:[1,0,1] neg_lo:[0,1,0] neg_hi:[0,1,0]
    v_pk_fma_f32 v[120:121], v[120:121], v[218:219], v[166:167] op_sel:[0,0,0] op_sel_hi:[1,0,1] neg_lo:[0,1,0] neg_hi:[0,1,0]
    v_pk_fma_f32 v[152:153], v[152:153], v[220:221], v[168:169] op_sel:[0,0,0] op_sel_hi:[1,0,1] neg_lo:[0,1,0] neg_hi:[0,1,0]
    v_pk_mul_f32 v[160:161], v[10:11], v[212:213] op_sel:[0,1] op_sel_hi:[1,1]
    v_pk_mul_f32 v[162:163], v[42:43], v[214:215] op_sel:[0,1] op_sel_hi:[1,1]
    v_pk_mul_f32 v[164:165], v[74:75], v[216:217] op_sel:[0,1] op_sel_hi:[1,1]
    v_pk_mul_f32 v[166:167], v[106:107], v[218:219] op_sel:[0,1] op_sel_hi:[1,1]
    v_pk_mul_f32 v[168:169], v[138:139], v[220:221] op_sel:[0,1] op_sel_hi:[1,1]
    v_pk_mul_f32 v[10:11], v[10:11], v[212:213] op_sel:[0,0] op_sel_hi:[1,0]
    v_pk_mul_f32 v[42:43], v[42:43], v[214:215] op_sel:[0,0] op_sel_hi:[1,0]
    v_pk_mul_f32 v[74:75], v[74:75], v[216:217] op_sel:[0,0] op_sel_hi:[1,0]
    v_pk_mul_f32 v[106:107], v[106:107], v[218:219] op_sel:[0,0] op_sel_hi:[1,0]
    v_pk_mul_f32 v[138:139], v[138:139], v[220:221] op_sel:[0,0] op_sel_hi:[1,0]
    v_pk_fma_f32 v[10:11], v[26:27], v[212:213], v[10:11] op_sel:[0,1,0] op_sel_hi:[1,1,1]
    v_pk_fma_f32 v[42:43], v[58:59], v[214:215], v[42:43] op_sel:[0,1,0] op_sel_hi:[1,1,1]
    v_pk_fma_f32 v[74:75], v[90:91], v[216:217], v[74:75] op_sel:[0,1,0] op_sel_hi:[1,1,1]
    v_pk_fma_f32 v[106:107], v[122:123], v[218:219], v[106:107] op_sel:[0,1,0] op_sel_hi:[1,1,1]
    v_pk_fma_f32 v[138:139], v[154:155], v[220:221], v[138:139] op_sel:[0,1,0] op_sel_hi:[1,1,1]
    v_pk_fma_f32 v[26:27], v[26:27], v[212:213], v[160:161] op_sel:[0,0,0] op_sel_hi:[1,0,1] neg_lo:[0,1,0] neg_hi:[0,1,0]
    v_pk_fma_f32 v[58:59], v[58:59], v[214:215], v[162:163] op_sel:[0,0,0] op_sel_hi:[1,0,1] neg_lo:[0,1,0] neg_hi:[0,1,0]
    v_pk_fma_f32 v[90:91], v[90:91], v[216:217], v[164:165] op_sel:[0,0,0] op_sel_hi:[1,0,1] neg_lo:[0,1,0] neg_hi:[0,1,0]
    v_pk_fma_f32 v[122:123], v[122:123], v[218:219], v[166:167] op_sel:[0,0,0] op_sel_hi:[1,0,1] neg_lo:[0,1,0] neg_hi:[0,1,0]
    v_pk_fma_f32 v[154:155], v[154:155], v[220:221], v[168:169] op_sel:[0,0,0] op_sel_hi:[1,0,1] neg_lo:[0,1,0] neg_hi:[0,1,0]
    v_pk_mul_f32 v[160:161], v[12:13], v[212:213] op_sel:[0,1] op_sel_hi:[1,1]
    v_pk_mul_f32 v[162:163], v[44:45], v[214:215] op_sel:[0,1] op_sel_hi:[1,1]
    v_pk_mul_f32 v[164:165], v[76:77], v[216:217] op_sel:[0,1] op_sel_hi:[1,1]
    v_pk_mul_f32 v[166:167], v[108:109], v[218:219] op_sel:[0,1] op_sel_hi:[1,1]
    v_pk_mul_f32 v[168:169], v[140:141], v[220:221] op_sel:[0,1] op_sel_hi:[1,1]
    v_pk_mul_f32 v[12:13], v[12:13], v[212:213] op_sel:[0,0] op_sel_hi:[1,0]
    v_pk_mul_f32 v[44:45], v[44:45], v[214:215] op_sel:[0,0] op_sel_hi:[1,0]
    v_pk_mul_f32 v[76:77], v[76:77], v[216:217] op_sel:[0,0] op_sel_hi:[1,0]
    v_pk_mul_f32 v[108:109], v[108:109], v[218:219] op_sel:[0,0] op_sel_hi:[1,0]
    v_pk_mul_f32 v[140:141], v[140:141], v[220:221] op_sel:[0,0] op_sel_hi:[1,0]
    v_pk_fma_f32 v[12:13], v[28:29], v[212:213], v[12:13] op_sel:[0,1,0] op_sel_hi:[1,1,1]
    v_pk_fma_f32 v[44:45], v[60:61], v[214:215], v[44:45] op_sel:[0,1,0] op_sel_hi:[1,1,1]
    v_pk_fma_f32 v[76:77], v[92:93], v[216:217], v[76:77] op_sel:[0,1,0] op_sel_hi:[1,1,1]
    v_pk_fma_f32 v[108:109], v[124:125], v[218:219], v[108:109] op_sel:[0,1,0] op_sel_hi:[1,1,1]
    v_pk_fma_f32 v[140:141], v[156:157], v[220:221], v[140:141] op_sel:[0,1,0] op_sel_hi:[1,1,1]
    v_pk_fma_f32 v[28:29], v[28:29], v[212:213], v[160:161] op_sel:[0,0,0] op_sel_hi:[1,0,1] neg_lo:[0,1,0] neg_hi:[0,1,0]
    v_pk_fma_f32 v[60:61], v[60:61], v[214:215], v[162:163] op_sel:[0,0,0] op_sel_hi:[1,0,1] neg_lo:[0,1,0] neg_hi:[0,1,0]
    v_pk_fma_f32 v[92:93], v[92:93], v[216:217], v[164:165] op_sel:[0,0,0] op_sel_hi:[1,0,1] neg_lo:[0,1,0] neg_hi:[0,1,0]
    v_pk_fma_f32 v[124:125], v[124:125], v[218:219], v[166:167] op_sel:[0,0,0] op_sel_hi:[1,0,1] neg_lo:[0,1,0] neg_hi:[0,1,0]
    v_pk_fma_f32 v[156:157], v[156:157], v[220:221], v[168:169] op_sel:[0,0,0] op_sel_hi:[1,0,1] neg_lo:[0,1,0] neg_hi:[0,1,0]
    v_pk_mul_f32 v[160:161], v[14:15], v[212:213] op_sel:[0,1] op_sel_hi:[1,1]
    v_pk_mul_f32 v[162:163], v[46:47], v[214:215] op_sel:[0,1] op_sel_hi:[1,1]
    v_pk_mul_f32 v[164:165], v[78:79], v[216:217] op_sel:[0,1] op_sel_hi:[1,1]
    v_pk_mul_f32 v[166:167], v[110:111], v[218:219] op_sel:[0,1] op_sel_hi:[1,1]
    v_pk_mul_f32 v[168:169], v[142:143], v[220:221] op_sel:[0,1] op_sel_hi:[1,1]
    v_pk_mul_f32 v[14:15], v[14:15], v[212:213] op_sel:[0,0] op_sel_hi:[1,0]
    v_pk_mul_f32 v[46:47], v[46:47], v[214:215] op_sel:[0,0] op_sel_hi:[1,0]
    v_pk_mul_f32 v[78:79], v[78:79], v[216:217] op_sel:[0,0] op_sel_hi:[1,0]
    v_pk_mul_f32 v[110:111], v[110:111], v[218:219] op_sel:[0,0] op_sel_hi:[1,0]
    v_pk_mul_f32 v[142:143], v[142:143], v[220:221] op_sel:[0,0] op_sel_hi:[1,0]
    v_pk_fma_f32 v[14:15], v[30:31], v[212:213], v[14:15] op_sel:[0,1,0] op_sel_hi:[1,1,1]
    v_pk_fma_f32 v[46:47], v[62:63], v[214:215], v[46:47] op_sel:[0,1,0] op_sel_hi:[1,1,1]
    v_pk_fma_f32 v[78:79], v[94:95], v[216:217], v[78:79] op_sel:[0,1,0] op_sel_hi:[1,1,1]
    v_pk_fma_f32 v[110:111], v[126:127], v[218:219], v[110:111] op_sel:[0,1,0] op_sel_hi:[1,1,1]
    v_pk_fma_f32 v[142:143], v[158:159], v[220:221], v[142:143] op_sel:[0,1,0] op_sel_hi:[1,1,1]
    v_pk_fma_f32 v[30:31], v[30:31], v[212:213], v[160:161] op_sel:[0,0,0] op_sel_hi:[1,0,1] neg_lo:[0,1,0] neg_hi:[0,1,0]
    v_pk_fma_f32 v[62:63], v[62:63], v[214:215], v[162:163] op_sel:[0,0,0] op_sel_hi:[1,0,1] neg_lo:[0,1,0] neg_hi:[0,1,0]
    v_pk_fma_f32 v[94:95], v[94:95], v[216:217], v[164:165] op_sel:[0,0,0] op_sel_hi:[1,0,1] neg_lo:[0,1,0] neg_hi:[0,1,0]
    v_pk_fma_f32 v[126:127], v[126:127], v[218:219], v[166:167] op_sel:[0,0,0] op_sel_hi:[1,0,1] neg_lo:[0,1,0] neg_hi:[0,1,0]
    v_pk_fma_f32 v[158:159], v[158:159], v[220:221], v[168:169] op_sel:[0,0,0] op_sel_hi:[1,0,1] neg_lo:[0,1,0] neg_hi:[0,1,0]
    s_mul_i32 s70, s65, 12288
    s_add_u32 s70, s70, 102400
    v_and_b32 v222, 7, v254
    v_bfe_u32 v223, v254, 3, 1
    v_lshlrev_b32 v223, 2, v223
    v_xor_b32 v222, v222, v223
    v_lshrrev_b32 v223, 4, v254
    v_lshlrev_b32 v223, 1, v223
    v_xor_b32 v222, v222, v223
    v_and_b32 v223, 15, v254
    v_lshlrev_b32 v223, 7, v223
    v_lshl_add_u32 v222, v222, 4, v223
    v_add_u32 v222, s70, v222
    v_xor_b32 v223, 16, v222
    v_lshrrev_b32 v224, 4, v254
    v_bfe_u32 v225, v254, 2, 2
    v_and_b32 v226, 1, v224
    v_lshl_add_u32 v226, v226, 2, v225
    v_bfe_u32 v228, v254, 1, 1
    v_xor_b32 v226, v226, v228
    v_lshl_add_u32 v224, v224, 3, v225
    v_lshlrev_b32 v224, 7, v224
    v_lshl_add_u32 v224, v226, 4, v224
    v_and_b32 v225, 1, v254
    v_lshl_add_u32 v224, v225, 3, v224
    v_add_u32 v224, s70, v224
    v_xor_b32 v176, 0, v224
    v_xor_b32 v177, 64, v224
    v_xor_b32 v178, 32, v224
    v_xor_b32 v179, 96, v224
    v_xor_b32 v180, 64, v224
    v_xor_b32 v181, 0, v224
    v_xor_b32 v182, 96, v224
    v_xor_b32 v183, 32, v224
    s_lshl_b32 s70, s62, 1
    s_and_b32 s71, s65, 1
    s_add_u32 s70, s70, s71
    s_mul_i32 s70, s70, 88
    s_mul_i32 s71, s64, 10
    s_add_u32 s70, s70, s71
    s_lshr_b32 s71, s65, 1
    s_mul_i32 s71, s71, 5
    s_add_u32 s70, s70, s71
    s_add_u32 s70, s70, 48
    s_lshl_b32 s70, s70, 12
    s_add_u32 s70, s70, 1048576
    v_lshlrev_b32 v225, 4, v254
    v_add_u32 v225, s70, v225
    s_setprio 3
    s_barrier
    ds_read_b32 v160, v227 offset:0
    ds_read_b32 v161, v227 offset:1280
    ds_read_b32 v162, v227 offset:4
    ds_read_b32 v163, v227 offset:1284
    ds_read_b32 v164, v227 offset:128
    ds_read_b32 v165, v227 offset:1408
    ds_read_b32 v166, v227 offset:132
    ds_read_b32 v167, v227 offset:1412
    ds_read_b32 v168, v227 offset:256
    ds_read_b32 v169, v227 offset:1536
    ds_read_b32 v170, v227 offset:260
    ds_read_b32 v171, v227 offset:1540
    ds_read_b32 v172, v227 offset:384
    ds_read_b32 v173, v227 offset:1664
    ds_read_b32 v174, v227 offset:388
    ds_read_b32 v175, v227 offset:1668
    ds_read_b32 v192, v227 offset:512
    ds_read_b32 v193, v227 offset:1792
    ds_read_b32 v194, v227 offset:516
    ds_read_b32 v195, v227 offset:1796
    s_waitcnt lgkmcnt(0)
    v_pk_add_f32 v[0:1], v[0:1], v[160:161] op_sel:[0,0] op_sel_hi:[1,1]
    v_pk_add_f32 v[16:17], v[16:17], v[162:163] op_sel:[0,0] op_sel_hi:[1,1]
    v_pk_mul_f32 v[196:197], v[160:161], v[202:203] op_sel:[0,1] op_sel_hi:[1,1]
    v_pk_mul_f32 v[160:161], v[160:161], v[202:203] op_sel:[0,0] op_sel_hi:[1,0]
    v_pk_fma_f32 v[160:161], v[162:163], v[202:203], v[160:161] op_sel:[0,1,0] op_sel_hi:[1,1,1]
    v_pk_fma_f32 v[162:163], v[162:163], v[202:203], v[196:197] op_sel:[0,0,0] op_sel_hi:[1,0,1] neg_lo:[0,0,1] neg_hi:[0,0,1]
    v_pk_add_f32 v[2:3], v[2:3], v[160:161] op_sel:[0,0] op_sel_hi:[1,1]
    v_pk_add_f32 v[18:19], v[18:19], v[162:163] op_sel:[0,0] op_sel_hi:[1,1]
    v_pk_mul_f32 v[196:197], v[160:161], v[202:203] op_sel:[0,1] op_sel_hi:[1,1]
    v_pk_mul_f32 v[160:161], v[160:161], v[202:203] op_sel:[0,0] op_sel_hi:[1,0]
    v_pk_fma_f32 v[160:161], v[162:163], v[202:203], v[160:161] op_sel:[0,1,0] op_sel_hi:[1,1,1]
    v_pk_fma_f32 v[162:163], v[162:163], v[202:203], v[196:197] op_sel:[0,0,0] op_sel_hi:[1,0,1] neg_lo:[0,0,1] neg_hi:[0,0,1]
    v_pk_add_f32 v[4:5], v[4:5], v[160:161] op_sel:[0,0] op_sel_hi:[1,1]
    v_pk_add_f32 v[20:21], v[20:21], v[162:163] op_sel:[0,0] op_sel_hi:[1,1]
    v_pk_mul_f32 v[196:197], v[160:161], v[202:203] op_sel:[0,1] op_sel_hi:[1,1]
    v_pk_mul_f32 v[160:161], v[160:161], v[202:203] op_sel:[0,0] op_sel_hi:[1,0]
    v_pk_fma_f32 v[160:161], v[162:163], v[202:203], v[160:161] op_sel:[0,1,0] op_sel_hi:[1,1,1]
    v_pk_fma_f32 v[162:163], v[162:163], v[202:203], v[196:197] op_sel:[0,0,0] op_sel_hi:[1,0,1] neg_lo:[0,0,1] neg_hi:[0,0,1]
    v_pk_add_f32 v[6:7], v[6:7], v[160:161] op_sel:[0,0] op_sel_hi:[1,1]
    v_pk_add_f32 v[22:23], v[22:23], v[162:163] op_sel:[0,0] op_sel_hi:[1,1]
    v_pk_mul_f32 v[196:197], v[160:161], v[202:203] op_sel:[0,1] op_sel_hi:[1,1]
    v_pk_mul_f32 v[160:161], v[160:161], v[202:203] op_sel:[0,0] op_sel_hi:[1,0]
    v_pk_fma_f32 v[160:161], v[162:163], v[202:203], v[160:161] op_sel:[0,1,0] op_sel_hi:[1,1,1]
    v_pk_fma_f32 v[162:163], v[162:163], v[202:203], v[196:197] op_sel:[0,0,0] op_sel_hi:[1,0,1] neg_lo:[0,0,1] neg_hi:[0,0,1]
    v_pk_add_f32 v[8:9], v[8:9], v[160:161] op_sel:[0,0] op_sel_hi:[1,1]
    v_pk_add_f32 v[24:25], v[24:25], v[162:163] op_sel:[0,0] op_sel_hi:[1,1]
    v_pk_mul_f32 v[196:197], v[160:161], v[202:203] op_sel:[0,1] op_sel_hi:[1,1]
    v_pk_mul_f32 v[160:161], v[160:161], v[202:203] op_sel:[0,0] op_sel_hi:[1,0]
    v_pk_fma_f32 v[160:161], v[162:163], v[202:203], v[160:161] op_sel:[0,1,0] op_sel_hi:[1,1,1]
    v_pk_fma_f32 v[162:163], v[162:163], v[202:203], v[196:197] op_sel:[0,0,0] op_sel_hi:[1,0,1] neg_lo:[0,0,1] neg_hi:[0,0,1]
    v_pk_add_f32 v[10:11], v[10:11], v[160:161] op_sel:[0,0] op_sel_hi:[1,1]
    v_pk_add_f32 v[26:27], v[26:27], v[162:163] op_sel:[0,0] op_sel_hi:[1,1]
    v_pk_mul_f32 v[196:197], v[160:161], v[202:203] op_sel:[0,1] op_sel_hi:[1,1]
    v_pk_mul_f32 v[160:161], v[160:161], v[202:203] op_sel:[0,0] op_sel_hi:[1,0]
    v_pk_fma_f32 v[160:161], v[162:163], v[202:203], v[160:161] op_sel:[0,1,0] op_sel_hi:[1,1,1]
    v_pk_fma_f32 v[162:163], v[162:163], v[202:203], v[196:197] op_sel:[0,0,0] op_sel_hi:[1,0,1] neg_lo:[0,0,1] neg_hi:[0,0,1]
    v_pk_add_f32 v[12:13], v[12:13], v[160:161] op_sel:[0,0] op_sel_hi:[1,1]
    v_pk_add_f32 v[28:29], v[28:29], v[162:163] op_sel:[0,0] op_sel_hi:[1,1]
    v_pk_mul_f32 v[196:197], v[160:161], v[202:203] op_sel:[0,1] op_sel_hi:[1,1]
    v_pk_mul_f32 v[160:161], v[160:161], v[202:203] op_sel:[0,0] op_sel_hi:[1,0]
    v_pk_fma_f32 v[160:161], v[162:163], v[202:203], v[160:161] op_sel:[0,1,0] op_sel_hi:[1,1,1]
    v_pk_fma_f32 v[162:163], v[162:163], v[202:203], v[196:197] op_sel:[0,0,0] op_sel_hi:[1,0,1] neg_lo:[0,0,1] neg_hi:[0,0,1]
    v_pk_add_f32 v[14:15], v[14:15], v[160:161] op_sel:[0,0] op_sel_hi:[1,1]
    v_pk_add_f32 v[30:31], v[30:31], v[162:163] op_sel:[0,0] op_sel_hi:[1,1]
    v_pk_add_f32 v[32:33], v[32:33], v[164:165] op_sel:[0,0] op_sel_hi:[1,1]
    v_cvt_pk_bf16_f32 v232, v0, v2
    v_pk_add_f32 v[48:49], v[48:49], v[166:167] op_sel:[0,0] op_sel_hi:[1,1]
    v_cvt_pk_bf16_f32 v233, v4, v6
    v_pk_mul_f32 v[196:197], v[164:165], v[204:205] op_sel:[0,1] op_sel_hi:[1,1]
    v_pk_mul_f32 v[164:165], v[164:165], v[204:205] op_sel:[0,0] op_sel_hi:[1,0]
    v_cvt_pk_bf16_f32 v234, v8, v10
    v_pk_fma_f32 v[164:165], v[166:167], v[204:205], v[164:165] op_sel:[0,1,0] op_sel_hi:[1,1,1]
    v_pk_fma_f32 v[166:167], v[166:167], v[204:205], v[196:197] op_sel:[0,0,0] op_sel_hi:[1,0,1] neg_lo:[0,0,1] neg_hi:[0,0,1]
    v_cvt_pk_bf16_f32 v235, v12, v14
    v_pk_add_f32 v[34:35], v[34:35], v[164:165] op_sel:[0,0] op_sel_hi:[1,1]
    v_pk_add_f32 v[50:51], v[50:51], v[166:167] op_sel:[0,0] op_sel_hi:[1,1]
    ds_write_b128 v222, v[232:235] offset:0
    v_pk_mul_f32 v[196:197], v[164:165], v[204:205] op_sel:[0,1] op_sel_hi:[1,1]
    v_pk_mul_f32 v[164:165], v[164:165], v[204:205] op_sel:[0,0] op_sel_hi:[1,0]
    v_cvt_pk_bf16_f32 v236, v1, v3
    v_pk_fma_f32 v[164:165], v[166:167], v[204:205], v[164:165] op_sel:[0,1,0] op_sel_hi:[1,1,1]
    v_pk_fma_f32 v[166:167], v[166:167], v[204:205], v[196:197] op_sel:[0,0,0] op_sel_hi:[1,0,1] neg_lo:[0,0,1] neg_hi:[0,0,1]
    v_cvt_pk_bf16_f32 v237, v5, v7
    v_pk_add_f32 v[36:37], v[36:37], v[164:165] op_sel:[0,0] op_sel_hi:[1,1]
    v_cvt_pk_bf16_f32 v238, v9, v11
    v_pk_add_f32 v[52:53], v[52:53], v[166:167] op_sel:[0,0] op_sel_hi:[1,1]
    v_pk_mul_f32 v[196:197], v[164:165], v[204:205] op_sel:[0,1] op_sel_hi:[1,1]
    v_cvt_pk_bf16_f32 v239, v13, v15
    v_pk_mul_f32 v[164:165], v[164:165], v[204:205] op_sel:[0,0] op_sel_hi:[1,0]
    v_pk_fma_f32 v[164:165], v[166:167], v[204:205], v[164:165] op_sel:[0,1,0] op_sel_hi:[1,1,1]
    ds_write_b128 v223, v[236:239] offset:0
    v_pk_fma_f32 v[166:167], v[166:167], v[204:205], v[196:197] op_sel:[0,0,0] op_sel_hi:[1,0,1] neg_lo:[0,0,1] neg_hi:[0,0,1]
    v_pk_add_f32 v[38:39], v[38:39], v[164:165] op_sel:[0,0] op_sel_hi:[1,1]
    v_cvt_pk_bf16_f32 v0, v16, v18
    v_pk_add_f32 v[54:55], v[54:55], v[166:167] op_sel:[0,0] op_sel_hi:[1,1]
    v_pk_mul_f32 v[196:197], v[164:165], v[204:205] op_sel:[0,1] op_sel_hi:[1,1]
    v_cvt_pk_bf16_f32 v1, v20, v22
    v_pk_mul_f32 v[164:165], v[164:165], v[204:205] op_sel:[0,0] op_sel_hi:[1,0]
    v_pk_fma_f32 v[164:165], v[166:167], v[204:205], v[164:165] op_sel:[0,1,0] op_sel_hi:[1,1,1]
    v_cvt_pk_bf16_f32 v2, v24, v26
    v_pk_fma_f32 v[166:167], v[166:167], v[204:205], v[196:197] op_sel:[0,0,0] op_sel_hi:[1,0,1] neg_lo:[0,0,1] neg_hi:[0,0,1]
    v_cvt_pk_bf16_f32 v3, v28, v30
    v_pk_add_f32 v[40:41], v[40:41], v[164:165] op_sel:[0,0] op_sel_hi:[1,1]
    v_pk_add_f32 v[56:57], v[56:57], v[166:167] op_sel:[0,0] op_sel_hi:[1,1]
    ds_write_b128 v222, v[0:3] offset:2048
    v_pk_mul_f32 v[196:197], v[164:165], v[204:205] op_sel:[0,1] op_sel_hi:[1,1]
    v_pk_mul_f32 v[164:165], v[164:165], v[204:205] op_sel:[0,0] op_sel_hi:[1,0]
    v_cvt_pk_bf16_f32 v4, v17, v19
    v_pk_fma_f32 v[164:165], v[166:167], v[204:205], v[164:165] op_sel:[0,1,0] op_sel_hi:[1,1,1]
    v_pk_fma_f32 v[166:167], v[166:167], v[204:205], v[196:197] op_sel:[0,0,0] op_sel_hi:[1,0,1] neg_lo:[0,0,1] neg_hi:[0,0,1]
    v_cvt_pk_bf16_f32 v5, v21, v23
    v_pk_add_f32 v[42:43], v[42:43], v[164:165] op_sel:[0,0] op_sel_hi:[1,1]
    v_pk_add_f32 v[58:59], v[58:59], v[166:167] op_sel:[0,0] op_sel_hi:[1,1]
    v_cvt_pk_bf16_f32 v6, v25, v27
    v_pk_mul_f32 v[196:197], v[164:165], v[204:205] op_sel:[0,1] op_sel_hi:[1,1]
    v_pk_mul_f32 v[164:165], v[164:165], v[204:205] op_sel:[0,0] op_sel_hi:[1,0]
    v_cvt_pk_bf16_f32 v7, v29, v31
    v_pk_fma_f32 v[164:165], v[166:167], v[204:205], v[164:165] op_sel:[0,1,0] op_sel_hi:[1,1,1]
    ds_write_b128 v223, v[4:7] offset:2048
    v_pk_fma_f32 v[166:167], v[166:167], v[204:205], v[196:197] op_sel:[0,0,0] op_sel_hi:[1,0,1] neg_lo:[0,0,1] neg_hi:[0,0,1]
    v_pk_add_f32 v[44:45], v[44:45], v[164:165] op_sel:[0,0] op_sel_hi:[1,1]
    ds_read_b64_tr_b16 v[16:17], v176 offset:0
    ds_read_b64_tr_b16 v[18:19], v177 offset:512
    v_pk_add_f32 v[60:61], v[60:61], v[166:167] op_sel:[0,0] op_sel_hi:[1,1]
    v_pk_mul_f32 v[196:197], v[164:165], v[204:205] op_sel:[0,1] op_sel_hi:[1,1]
    ds_read_b64_tr_b16 v[20:21], v178 offset:0
    ds_read_b64_tr_b16 v[22:23], v179 offset:512
    v_pk_mul_f32 v[164:165], v[164:165], v[204:205] op_sel:[0,0] op_sel_hi:[1,0]
    v_pk_fma_f32 v[164:165], v[166:167], v[204:205], v[164:165] op_sel:[0,1,0] op_sel_hi:[1,1,1]
    ds_read_b64_tr_b16 v[24:25], v180 offset:0
    ds_read_b64_tr_b16 v[26:27], v181 offset:512
    v_pk_fma_f32 v[166:167], v[166:167], v[204:205], v[196:197] op_sel:[0,0,0] op_sel_hi:[1,0,1] neg_lo:[0,0,1] neg_hi:[0,0,1]
    v_pk_add_f32 v[46:47], v[46:47], v[164:165] op_sel:[0,0] op_sel_hi:[1,1]
    ds_read_b64_tr_b16 v[28:29], v182 offset:0
    ds_read_b64_tr_b16 v[30:31], v183 offset:512
    v_pk_add_f32 v[62:63], v[62:63], v[166:167] op_sel:[0,0] op_sel_hi:[1,1]
    v_pk_add_f32 v[64:65], v[64:65], v[168:169] op_sel:[0,0] op_sel_hi:[1,1]
    v_cvt_pk_bf16_f32 v184, v32, v34
    v_pk_add_f32 v[80:81], v[80:81], v[170:171] op_sel:[0,0] op_sel_hi:[1,1]
    v_cvt_pk_bf16_f32 v185, v36, v38
    v_pk_mul_f32 v[196:197], v[168:169], v[206:207] op_sel:[0,1] op_sel_hi:[1,1]
    v_pk_mul_f32 v[168:169], v[168:169], v[206:207] op_sel:[0,0] op_sel_hi:[1,0]
    s_waitcnt lgkmcnt(6)
    global_store_dwordx4 v225, v[16:19], s[34:35] offset:0 sc1
    v_pk_fma_f32 v[168:169], v[170:171], v[206:207], v[168:169] op_sel:[0,1,0] op_sel_hi:[1,1,1]
    v_cvt_pk_bf16_f32 v186, v40, v42
    v_pk_fma_f32 v[170:171], v[170:171], v[206:207], v[196:197] op_sel:[0,0,0] op_sel_hi:[1,0,1] neg_lo:[0,0,1] neg_hi:[0,0,1]
    v_pk_add_f32 v[66:67], v[66:67], v[168:169] op_sel:[0,0] op_sel_hi:[1,1]
    v_cvt_pk_bf16_f32 v187, v44, v46
    v_pk_add_f32 v[82:83], v[82:83], v[170:171] op_sel:[0,0] op_sel_hi:[1,1]
    ds_write_b128 v222, v[184:187] offset:4096
    v_pk_mul_f32 v[196:197], v[168:169], v[206:207] op_sel:[0,1] op_sel_hi:[1,1]
    v_pk_mul_f32 v[168:169], v[168:169], v[206:207] op_sel:[0,0] op_sel_hi:[1,0]
    v_cvt_pk_bf16_f32 v188, v33, v35
    v_pk_fma_f32 v[168:169], v[170:171], v[206:207], v[168:169] op_sel:[0,1,0] op_sel_hi:[1,1,1]
    v_pk_fma_f32 v[170:171], v[170:171], v[206:207], v[196:197] op_sel:[0,0,0] op_sel_hi:[1,0,1] neg_lo:[0,0,1] neg_hi:[0,0,1]
    s_waitcnt lgkmcnt(5)
    global_store_dwordx4 v225, v[20:23], s[34:35] offset:1024 sc1
    v_pk_add_f32 v[68:69], v[68:69], v[168:169] op_sel:[0,0] op_sel_hi:[1,1]
    v_cvt_pk_bf16_f32 v189, v37, v39
    v_pk_add_f32 v[84:85], v[84:85], v[170:171] op_sel:[0,0] op_sel_hi:[1,1]
    v_pk_mul_f32 v[196:197], v[168:169], v[206:207] op_sel:[0,1] op_sel_hi:[1,1]
    v_cvt_pk_bf16_f32 v190, v41, v43
    v_pk_mul_f32 v[168:169], v[168:169], v[206:207] op_sel:[0,0] op_sel_hi:[1,0]
    v_cvt_pk_bf16_f32 v191, v45, v47
    v_pk_fma_f32 v[168:169], v[170:171], v[206:207], v[168:169] op_sel:[0,1,0] op_sel_hi:[1,1,1]
    v_pk_fma_f32 v[170:171], v[170:171], v[206:207], v[196:197] op_sel:[0,0,0] op_sel_hi:[1,0,1] neg_lo:[0,0,1] neg_hi:[0,0,1]
    ds_write_b128 v223, v[188:191] offset:4096
    v_pk_add_f32 v[70:71], v[70:71], v[168:169] op_sel:[0,0] op_sel_hi:[1,1]
    s_waitcnt lgkmcnt(4)
    global_store_dwordx4 v225, v[24:27], s[34:35] offset:2048 sc1
    v_pk_add_f32 v[86:87], v[86:87], v[170:171] op_sel:[0,0] op_sel_hi:[1,1]
    v_pk_mul_f32 v[196:197], v[168:169], v[206:207] op_sel:[0,1] op_sel_hi:[1,1]
    v_cvt_pk_bf16_f32 v32, v48, v50
    v_pk_mul_f32 v[168:169], v[168:169], v[206:207] op_sel:[0,0] op_sel_hi:[1,0]
    v_pk_fma_f32 v[168:169], v[170:171], v[206:207], v[168:169] op_sel:[0,1,0] op_sel_hi:[1,1,1]
    v_cvt_pk_bf16_f32 v33, v52, v54
    v_pk_fma_f32 v[170:171], v[170:171], v[206:207], v[196:197] op_sel:[0,0,0] op_sel_hi:[1,0,1] neg_lo:[0,0,1] neg_hi:[0,0,1]
    v_cvt_pk_bf16_f32 v34, v56, v58
    v_pk_add_f32 v[72:73], v[72:73], v[168:169] op_sel:[0,0] op_sel_hi:[1,1]
    v_pk_add_f32 v[88:89], v[88:89], v[170:171] op_sel:[0,0] op_sel_hi:[1,1]
    v_cvt_pk_bf16_f32 v35, v60, v62
    v_pk_mul_f32 v[196:197], v[168:169], v[206:207] op_sel:[0,1] op_sel_hi:[1,1]
    s_waitcnt lgkmcnt(2)
    global_store_dwordx4 v225, v[28:31], s[34:35] offset:3072 sc1
    v_add_u32 v225, 4096, v225
    v_pk_mul_f32 v[168:169], v[168:169], v[206:207] op_sel:[0,0] op_sel_hi:[1,0]
    v_pk_fma_f32 v[168:169], v[170:171], v[206:207], v[168:169] op_sel:[0,1,0] op_sel_hi:[1,1,1]
    ds_write_b128 v222, v[32:35] offset:6144
    v_pk_fma_f32 v[170:171], v[170:171], v[206:207], v[196:197] op_sel:[0,0,0] op_sel_hi:[1,0,1] neg_lo:[0,0,1] neg_hi:[0,0,1]
    v_cvt_pk_bf16_f32 v36, v49, v51
    v_pk_add_f32 v[74:75], v[74:75], v[168:169] op_sel:[0,0] op_sel_hi:[1,1]
    v_pk_add_f32 v[90:91], v[90:91], v[170:171] op_sel:[0,0] op_sel_hi:[1,1]
    v_cvt_pk_bf16_f32 v37, v53, v55
    v_pk_mul_f32 v[196:197], v[168:169], v[206:207] op_sel:[0,1] op_sel_hi:[1,1]
    v_pk_mul_f32 v[168:169], v[168:169], v[206:207] op_sel:[0,0] op_sel_hi:[1,0]
    v_cvt_pk_bf16_f32 v38, v57, v59
    v_pk_fma_f32 v[168:169], v[170:171], v[206:207], v[168:169] op_sel:[0,1,0] op_sel_hi:[1,1,1]
    v_cvt_pk_bf16_f32 v39, v61, v63
    v_pk_fma_f32 v[170:171], v[170:171], v[206:207], v[196:197] op_sel:[0,0,0] op_sel_hi:[1,0,1] neg_lo:[0,0,1] neg_hi:[0,0,1]
    v_pk_add_f32 v[76:77], v[76:77], v[168:169] op_sel:[0,0] op_sel_hi:[1,1]
    ds_write_b128 v223, v[36:39] offset:6144
    v_pk_add_f32 v[92:93], v[92:93], v[170:171] op_sel:[0,0] op_sel_hi:[1,1]
    ds_read_b64_tr_b16 v[48:49], v176 offset:4096
    ds_read_b64_tr_b16 v[50:51], v177 offset:4608
    v_pk_mul_f32 v[196:197], v[168:169], v[206:207] op_sel:[0,1] op_sel_hi:[1,1]
    v_pk_mul_f32 v[168:169], v[168:169], v[206:207] op_sel:[0,0] op_sel_hi:[1,0]
    ds_read_b64_tr_b16 v[52:53], v178 offset:4096
    ds_read_b64_tr_b16 v[54:55], v179 offset:4608
    v_pk_fma_f32 v[168:169], v[170:171], v[206:207], v[168:169] op_sel:[0,1,0] op_sel_hi:[1,1,1]
    ds_read_b64_tr_b16 v[56:57], v180 offset:4096
    ds_read_b64_tr_b16 v[58:59], v181 offset:4608
    v_pk_fma_f32 v[170:171], v[170:171], v[206:207], v[196:197] op_sel:[0,0,0] op_sel_hi:[1,0,1] neg_lo:[0,0,1] neg_hi:[0,0,1]
    v_pk_add_f32 v[78:79], v[78:79], v[168:169] op_sel:[0,0] op_sel_hi:[1,1]
    ds_read_b64_tr_b16 v[60:61], v182 offset:4096
    ds_read_b64_tr_b16 v[62:63], v183 offset:4608
    v_pk_add_f32 v[94:95], v[94:95], v[170:171] op_sel:[0,0] op_sel_hi:[1,1]
    v_pk_add_f32 v[96:97], v[96:97], v[172:173] op_sel:[0,0] op_sel_hi:[1,1]
    v_cvt_pk_bf16_f32 v232, v64, v66
    v_pk_add_f32 v[112:113], v[112:113], v[174:175] op_sel:[0,0] op_sel_hi:[1,1]
    v_cvt_pk_bf16_f32 v233, v68, v70
    v_pk_mul_f32 v[196:197], v[172:173], v[208:209] op_sel:[0,1] op_sel_hi:[1,1]
    v_pk_mul_f32 v[172:173], v[172:173], v[208:209] op_sel:[0,0] op_sel_hi:[1,0]
    s_waitcnt lgkmcnt(6)
    global_store_dwordx4 v225, v[48:51], s[34:35] offset:0 sc1
    v_pk_fma_f32 v[172:173], v[174:175], v[208:209], v[172:173] op_sel:[0,1,0] op_sel_hi:[1,1,1]
    v_cvt_pk_bf16_f32 v234, v72, v74
    v_pk_fma_f32 v[174:175], v[174:175], v[208:209], v[196:197] op_sel:[0,0,0] op_sel_hi:[1,0,1] neg_lo:[0,0,1] neg_hi:[0,0,1]
    v_pk_add_f32 v[98:99], v[98:99], v[172:173] op_sel:[0,0] op_sel_hi:[1,1]
    v_cvt_pk_bf16_f32 v235, v76, v78
    v_pk_add_f32 v[114:115], v[114:115], v[174:175] op_sel:[0,0] op_sel_hi:[1,1]
    ds_write_b128 v222, v[232:235] offset:8192
    v_pk_mul_f32 v[196:197], v[172:173], v[208:209] op_sel:[0,1] op_sel_hi:[1,1]
    v_pk_mul_f32 v[172:173], v[172:173], v[208:209] op_sel:[0,0] op_sel_hi:[1,0]
    v_cvt_pk_bf16_f32 v236, v65, v67
    v_pk_fma_f32 v[172:173], v[174:175], v[208:209], v[172:173] op_sel:[0,1,0] op_sel_hi:[1,1,1]
    v_pk_fma_f32 v[174:175], v[174:175], v[208:209], v[196:197] op_sel:[0,0,0] op_sel_hi:[1,0,1] neg_lo:[0,0,1] neg_hi:[0,0,1]
    s_waitcnt lgkmcnt(5)
    global_store_dwordx4 v225, v[52:55], s[34:35] offset:1024 sc1
    v_pk_add_f32 v[100:101], v[100:101], v[172:173] op_sel:[0,0] op_sel_hi:[1,1]
    v_cvt_pk_bf16_f32 v237, v69, v71
    v_pk_add_f32 v[116:117], v[116:117], v[174:175] op_sel:[0,0] op_sel_hi:[1,1]
    v_pk_mul_f32 v[196:197], v[172:173], v[208:209] op_sel:[0,1] op_sel_hi:[1,1]
    v_cvt_pk_bf16_f32 v238, v73, v75
    v_pk_mul_f32 v[172:173], v[172:173], v[208:209] op_sel:[0,0] op_sel_hi:[1,0]
    v_cvt_pk_bf16_f32 v239, v77, v79
    v_pk_fma_f32 v[172:173], v[174:175], v[208:209], v[172:173] op_sel:[0,1,0] op_sel_hi:[1,1,1]
    v_pk_fma_f32 v[174:175], v[174:175], v[208:209], v[196:197] op_sel:[0,0,0] op_sel_hi:[1,0,1] neg_lo:[0,0,1] neg_hi:[0,0,1]
    ds_write_b128 v223, v[236:239] offset:8192
    v_pk_add_f32 v[102:103], v[102:103], v[172:173] op_sel:[0,0] op_sel_hi:[1,1]
    s_waitcnt lgkmcnt(4)
    global_store_dwordx4 v225, v[56:59], s[34:35] offset:2048 sc1
    v_pk_add_f32 v[118:119], v[118:119], v[174:175] op_sel:[0,0] op_sel_hi:[1,1]
    v_pk_mul_f32 v[196:197], v[172:173], v[208:209] op_sel:[0,1] op_sel_hi:[1,1]
    v_cvt_pk_bf16_f32 v64, v80, v82
    v_pk_mul_f32 v[172:173], v[172:173], v[208:209] op_sel:[0,0] op_sel_hi:[1,0]
    v_pk_fma_f32 v[172:173], v[174:175], v[208:209], v[172:173] op_sel:[0,1,0] op_sel_hi:[1,1,1]
    v_cvt_pk_bf16_f32 v65, v84, v86
    v_pk_fma_f32 v[174:175], v[174:175], v[208:209], v[196:197] op_sel:[0,0,0] op_sel_hi:[1,0,1] neg_lo:[0,0,1] neg_hi:[0,0,1]
    v_cvt_pk_bf16_f32 v66, v88, v90
    v_pk_add_f32 v[104:105], v[104:105], v[172:173] op_sel:[0,0] op_sel_hi:[1,1]
    v_pk_add_f32 v[120:121], v[120:121], v[174:175] op_sel:[0,0] op_sel_hi:[1,1]
    v_cvt_pk_bf16_f32 v67, v92, v94
    v_pk_mul_f32 v[196:197], v[172:173], v[208:209] op_sel:[0,1] op_sel_hi:[1,1]
    s_waitcnt lgkmcnt(2)
    global_store_dwordx4 v225, v[60:63], s[34:35] offset:3072 sc1
    v_add_u32 v225, 4096, v225
    v_pk_mul_f32 v[172:173], v[172:173], v[208:209] op_sel:[0,0] op_sel_hi:[1,0]
    v_pk_fma_f32 v[172:173], v[174:175], v[208:209], v[172:173] op_sel:[0,1,0] op_sel_hi:[1,1,1]
    ds_write_b128 v222, v[64:67] offset:10240
    v_pk_fma_f32 v[174:175], v[174:175], v[208:209], v[196:197] op_sel:[0,0,0] op_sel_hi:[1,0,1] neg_lo:[0,0,1] neg_hi:[0,0,1]
    v_cvt_pk_bf16_f32 v68, v81, v83
    v_pk_add_f32 v[106:107], v[106:107], v[172:173] op_sel:[0,0] op_sel_hi:[1,1]
    v_pk_add_f32 v[122:123], v[122:123], v[174:175] op_sel:[0,0] op_sel_hi:[1,1]
    v_cvt_pk_bf16_f32 v69, v85, v87
    v_pk_mul_f32 v[196:197], v[172:173], v[208:209] op_sel:[0,1] op_sel_hi:[1,1]
    v_pk_mul_f32 v[172:173], v[172:173], v[208:209] op_sel:[0,0] op_sel_hi:[1,0]
    v_cvt_pk_bf16_f32 v70, v89, v91
    v_pk_fma_f32 v[172:173], v[174:175], v[208:209], v[172:173] op_sel:[0,1,0] op_sel_hi:[1,1,1]
    v_cvt_pk_bf16_f32 v71, v93, v95
    v_pk_fma_f32 v[174:175], v[174:175], v[208:209], v[196:197] op_sel:[0,0,0] op_sel_hi:[1,0,1] neg_lo:[0,0,1] neg_hi:[0,0,1]
    v_pk_add_f32 v[108:109], v[108:109], v[172:173] op_sel:[0,0] op_sel_hi:[1,1]
    ds_write_b128 v223, v[68:71] offset:10240
    v_pk_add_f32 v[124:125], v[124:125], v[174:175] op_sel:[0,0] op_sel_hi:[1,1]
    ds_read_b64_tr_b16 v[80:81], v176 offset:8192
    ds_read_b64_tr_b16 v[82:83], v177 offset:8704
    v_pk_mul_f32 v[196:197], v[172:173], v[208:209] op_sel:[0,1] op_sel_hi:[1,1]
    v_pk_mul_f32 v[172:173], v[172:173], v[208:209] op_sel:[0,0] op_sel_hi:[1,0]
    ds_read_b64_tr_b16 v[84:85], v178 offset:8192
    ds_read_b64_tr_b16 v[86:87], v179 offset:8704
    v_pk_fma_f32 v[172:173], v[174:175], v[208:209], v[172:173] op_sel:[0,1,0] op_sel_hi:[1,1,1]
    ds_read_b64_tr_b16 v[88:89], v180 offset:8192
    ds_read_b64_tr_b16 v[90:91], v181 offset:8704
    v_pk_fma_f32 v[174:175], v[174:175], v[208:209], v[196:197] op_sel:[0,0,0] op_sel_hi:[1,0,1] neg_lo:[0,0,1] neg_hi:[0,0,1]
    v_pk_add_f32 v[110:111], v[110:111], v[172:173] op_sel:[0,0] op_sel_hi:[1,1]
    ds_read_b64_tr_b16 v[92:93], v182 offset:8192
    ds_read_b64_tr_b16 v[94:95], v183 offset:8704
    v_pk_add_f32 v[126:127], v[126:127], v[174:175] op_sel:[0,0] op_sel_hi:[1,1]
    v_pk_add_f32 v[128:129], v[128:129], v[192:193] op_sel:[0,0] op_sel_hi:[1,1]
    v_cvt_pk_bf16_f32 v184, v96, v98
    v_pk_add_f32 v[144:145], v[144:145], v[194:195] op_sel:[0,0] op_sel_hi:[1,1]
    v_cvt_pk_bf16_f32 v185, v100, v102
    v_pk_mul_f32 v[196:197], v[192:193], v[210:211] op_sel:[0,1] op_sel_hi:[1,1]
    v_pk_mul_f32 v[192:193], v[192:193], v[210:211] op_sel:[0,0] op_sel_hi:[1,0]
    s_waitcnt lgkmcnt(6)
    global_store_dwordx4 v225, v[80:83], s[34:35] offset:0 sc1
    v_pk_fma_f32 v[192:193], v[194:195], v[210:211], v[192:193] op_sel:[0,1,0] op_sel_hi:[1,1,1]
    v_cvt_pk_bf16_f32 v186, v104, v106
    v_pk_fma_f32 v[194:195], v[194:195], v[210:211], v[196:197] op_sel:[0,0,0] op_sel_hi:[1,0,1] neg_lo:[0,0,1] neg_hi:[0,0,1]
    v_pk_add_f32 v[130:131], v[130:131], v[192:193] op_sel:[0,0] op_sel_hi:[1,1]
    v_cvt_pk_bf16_f32 v187, v108, v110
    v_pk_add_f32 v[146:147], v[146:147], v[194:195] op_sel:[0,0] op_sel_hi:[1,1]
    ds_write_b128 v222, v[184:187] offset:0
    v_pk_mul_f32 v[196:197], v[192:193], v[210:211] op_sel:[0,1] op_sel_hi:[1,1]
    v_pk_mul_f32 v[192:193], v[192:193], v[210:211] op_sel:[0,0] op_sel_hi:[1,0]
    v_cvt_pk_bf16_f32 v188, v97, v99
    v_pk_fma_f32 v[192:193], v[194:195], v[210:211], v[192:193] op_sel:[0,1,0] op_sel_hi:[1,1,1]
    v_pk_fma_f32 v[194:195], v[194:195], v[210:211], v[196:197] op_sel:[0,0,0] op_sel_hi:[1,0,1] neg_lo:[0,0,1] neg_hi:[0,0,1]
    s_waitcnt lgkmcnt(5)
    global_store_dwordx4 v225, v[84:87], s[34:35] offset:1024 sc1
    v_pk_add_f32 v[132:133], v[132:133], v[192:193] op_sel:[0,0] op_sel_hi:[1,1]
    v_cvt_pk_bf16_f32 v189, v101, v103
    v_pk_add_f32 v[148:149], v[148:149], v[194:195] op_sel:[0,0] op_sel_hi:[1,1]
    v_pk_mul_f32 v[196:197], v[192:193], v[210:211] op_sel:[0,1] op_sel_hi:[1,1]
    v_cvt_pk_bf16_f32 v190, v105, v107
    v_pk_mul_f32 v[192:193], v[192:193], v[210:211] op_sel:[0,0] op_sel_hi:[1,0]
    v_cvt_pk_bf16_f32 v191, v109, v111
    v_pk_fma_f32 v[192:193], v[194:195], v[210:211], v[192:193] op_sel:[0,1,0] op_sel_hi:[1,1,1]
    v_pk_fma_f32 v[194:195], v[194:195], v[210:211], v[196:197] op_sel:[0,0,0] op_sel_hi:[1,0,1] neg_lo:[0,0,1] neg_hi:[0,0,1]
    ds_write_b128 v223, v[188:191] offset:0
    v_pk_add_f32 v[134:135], v[134:135], v[192:193] op_sel:[0,0] op_sel_hi:[1,1]
    s_waitcnt lgkmcnt(4)
    global_store_dwordx4 v225, v[88:91], s[34:35] offset:2048 sc1
    v_pk_add_f32 v[150:151], v[150:151], v[194:195] op_sel:[0,0] op_sel_hi:[1,1]
    v_pk_mul_f32 v[196:197], v[192:193], v[210:211] op_sel:[0,1] op_sel_hi:[1,1]
    v_cvt_pk_bf16_f32 v96, v112, v114
    v_pk_mul_f32 v[192:193], v[192:193], v[210:211] op_sel:[0,0] op_sel_hi:[1,0]
    v_pk_fma_f32 v[192:193], v[194:195], v[210:211], v[192:193] op_sel:[0,1,0] op_sel_hi:[1,1,1]
    v_cvt_pk_bf16_f32 v97, v116, v118
    v_pk_fma_f32 v[194:195], v[194:195], v[210:211], v[196:197] op_sel:[0,0,0] op_sel_hi:[1,0,1] neg_lo:[0,0,1] neg_hi:[0,0,1]
    v_cvt_pk_bf16_f32 v98, v120, v122
    v_pk_add_f32 v[136:137], v[136:137], v[192:193] op_sel:[0,0] op_sel_hi:[1,1]
    v_pk_add_f32 v[152:153], v[152:153], v[194:195] op_sel:[0,0] op_sel_hi:[1,1]
    v_cvt_pk_bf16_f32 v99, v124, v126
    v_pk_mul_f32 v[196:197], v[192:193], v[210:211] op_sel:[0,1] op_sel_hi:[1,1]
    s_waitcnt lgkmcnt(2)
    global_store_dwordx4 v225, v[92:95], s[34:35] offset:3072 sc1
    v_add_u32 v225, 4096, v225
    v_pk_mul_f32 v[192:193], v[192:193], v[210:211] op_sel:[0,0] op_sel_hi:[1,0]
    v_pk_fma_f32 v[192:193], v[194:195], v[210:211], v[192:193] op_sel:[0,1,0] op_sel_hi:[1,1,1]
    ds_write_b128 v222, v[96:99] offset:2048
    v_pk_fma_f32 v[194:195], v[194:195], v[210:211], v[196:197] op_sel:[0,0,0] op_sel_hi:[1,0,1] neg_lo:[0,0,1] neg_hi:[0,0,1]
    v_cvt_pk_bf16_f32 v100, v113, v115
    v_pk_add_f32 v[138:139], v[138:139], v[192:193] op_sel:[0,0] op_sel_hi:[1,1]
    v_pk_add_f32 v[154:155], v[154:155], v[194:195] op_sel:[0,0] op_sel_hi:[1,1]
    v_cvt_pk_bf16_f32 v101, v117, v119
    v_pk_mul_f32 v[196:197], v[192:193], v[210:211] op_sel:[0,1] op_sel_hi:[1,1]
    v_pk_mul_f32 v[192:193], v[192:193], v[210:211] op_sel:[0,0] op_sel_hi:[1,0]
    v_cvt_pk_bf16_f32 v102, v121, v123
    v_pk_fma_f32 v[192:193], v[194:195], v[210:211], v[192:193] op_sel:[0,1,0] op_sel_hi:[1,1,1]
    v_cvt_pk_bf16_f32 v103, v125, v127
    v_pk_fma_f32 v[194:195], v[194:195], v[210:211], v[196:197] op_sel:[0,0,0] op_sel_hi:[1,0,1] neg_lo:[0,0,1] neg_hi:[0,0,1]
    v_pk_add_f32 v[140:141], v[140:141], v[192:193] op_sel:[0,0] op_sel_hi:[1,1]
    ds_write_b128 v223, v[100:103] offset:2048
    v_pk_add_f32 v[156:157], v[156:157], v[194:195] op_sel:[0,0] op_sel_hi:[1,1]
    ds_read_b64_tr_b16 v[112:113], v176 offset:0
    ds_read_b64_tr_b16 v[114:115], v177 offset:512
    v_pk_mul_f32 v[196:197], v[192:193], v[210:211] op_sel:[0,1] op_sel_hi:[1,1]
    v_pk_mul_f32 v[192:193], v[192:193], v[210:211] op_sel:[0,0] op_sel_hi:[1,0]
    ds_read_b64_tr_b16 v[116:117], v178 offset:0
    ds_read_b64_tr_b16 v[118:119], v179 offset:512
    v_pk_fma_f32 v[192:193], v[194:195], v[210:211], v[192:193] op_sel:[0,1,0] op_sel_hi:[1,1,1]
    ds_read_b64_tr_b16 v[120:121], v180 offset:0
    ds_read_b64_tr_b16 v[122:123], v181 offset:512
    v_pk_fma_f32 v[194:195], v[194:195], v[210:211], v[196:197] op_sel:[0,0,0] op_sel_hi:[1,0,1] neg_lo:[0,0,1] neg_hi:[0,0,1]
    v_pk_add_f32 v[142:143], v[142:143], v[192:193] op_sel:[0,0] op_sel_hi:[1,1]
    ds_read_b64_tr_b16 v[124:125], v182 offset:0
    ds_read_b64_tr_b16 v[126:127], v183 offset:512
    v_pk_add_f32 v[158:159], v[158:159], v[194:195] op_sel:[0,0] op_sel_hi:[1,1]
    v_cvt_pk_bf16_f32 v232, v128, v130
    v_cvt_pk_bf16_f32 v233, v132, v134
    s_waitcnt lgkmcnt(6)
    global_store_dwordx4 v225, v[112:115], s[34:35] offset:0 sc1
    v_cvt_pk_bf16_f32 v234, v136, v138
    v_cvt_pk_bf16_f32 v235, v140, v142
    ds_write_b128 v222, v[232:235] offset:4096
    v_cvt_pk_bf16_f32 v236, v129, v131
    s_waitcnt lgkmcnt(5)
    global_store_dwordx4 v225, v[116:119], s[34:35] offset:1024 sc1
    v_cvt_pk_bf16_f32 v237, v133, v135
    v_cvt_pk_bf16_f32 v238, v137, v139
    v_cvt_pk_bf16_f32 v239, v141, v143
    ds_write_b128 v223, v[236:239] offset:4096
    s_waitcnt lgkmcnt(4)
    global_store_dwordx4 v225, v[120:123], s[34:35] offset:2048 sc1
    v_cvt_pk_bf16_f32 v128, v144, v146
    v_cvt_pk_bf16_f32 v129, v148, v150
    v_cvt_pk_bf16_f32 v130, v152, v154
    v_cvt_pk_bf16_f32 v131, v156, v158
    s_waitcnt lgkmcnt(2)
    global_store_dwordx4 v225, v[124:127], s[34:35] offset:3072 sc1
    v_add_u32 v225, 4096, v225
    ds_write_b128 v222, v[128:131] offset:6144
    v_cvt_pk_bf16_f32 v132, v145, v147
    v_cvt_pk_bf16_f32 v133, v149, v151
    v_cvt_pk_bf16_f32 v134, v153, v155
    v_cvt_pk_bf16_f32 v135, v157, v159
    ds_write_b128 v223, v[132:135] offset:6144
    ds_read_b64_tr_b16 v[144:145], v176 offset:4096
    ds_read_b64_tr_b16 v[146:147], v177 offset:4608
    ds_read_b64_tr_b16 v[148:149], v178 offset:4096
    ds_read_b64_tr_b16 v[150:151], v179 offset:4608
    ds_read_b64_tr_b16 v[152:153], v180 offset:4096
    ds_read_b64_tr_b16 v[154:155], v181 offset:4608
    ds_read_b64_tr_b16 v[156:157], v182 offset:4096
    ds_read_b64_tr_b16 v[158:159], v183 offset:4608
    s_waitcnt lgkmcnt(6)
    global_store_dwordx4 v225, v[144:147], s[34:35] offset:0 sc1
    s_waitcnt lgkmcnt(4)
    global_store_dwordx4 v225, v[148:151], s[34:35] offset:1024 sc1
    s_waitcnt lgkmcnt(2)
    global_store_dwordx4 v225, v[152:155], s[34:35] offset:2048 sc1
    s_waitcnt lgkmcnt(0)
    global_store_dwordx4 v225, v[156:159], s[34:35] offset:3072 sc1
    v_mov_b32 v196, s3
    ds_write_b32 v253, v196 offset:84
    s_lshl_b32 s70, s62, 1
    s_and_b32 s71, s65, 1
    s_add_u32 s70, s70, s71
    s_lshl_b32 s71, s64, 1
    s_lshr_b32 s72, s65, 1
    s_add_u32 s71, s71, s72
    s_add_u32 s71, s71, 24
    s_lshl_b32 s70, s70, 5
    s_add_u32 s70, s70, s71
    s_lshl_b32 s70, s70, 7
    s_add_u32 s73, s70, 12582912
    s_lshl_b32 s70, s23, 4
    v_and_b32 v224, 15, v254
    v_add_u32 v224, s70, v224
    v_lshrrev_b32 v225, 4, v254
    s_lshl_b32 s71, s65, 4
    s_add_u32 s71, s71, s68
    v_lshl_add_u32 v225, v225, 2, s71
    v_mul_u32_u24 v226, 640, v224
    v_add_u32 v226, v226, v225
    v_lshlrev_b32 v227, 2, v226
    v_lshlrev_b32 v226, 1, v226
    v_lshlrev_b32 v225, 1, v225
    v_lshlrev_b32 v228, 3, v224
    v_add_u32 v228, 16384, v228
    global_load_dwordx2 v[180:181], v226, s[4:5]
    v_add_u32 v226, 20480, v226
    global_load_dwordx2 v[182:183], v226, s[4:5]
    global_load_dwordx2 v[188:189], v225, s[20:21]
    global_load_dwordx2 v[184:185], v228, s[34:35] offset:0 sc1
    global_load_dwordx2 v[186:187], v228, s[34:35] offset:128 sc1
    v_lshrrev_b32 v224, 4, v254
    v_bfe_u32 v225, v254, 2, 2
    v_lshl_add_u32 v225, v224, 2, v225
    v_bfe_u32 v229, v225, 1, 2
    s_lshl_b32 s70, s65, 5
    v_add_u32 v225, s70, v225
    v_lshlrev_b32 v225, 7, v225
    v_and_b32 v226, 3, v254
    v_lshl_add_u32 v225, v226, 3, v225
    v_and_b32 v226, 1, v224
    s_lshl_b32 s70, s65, 1
    v_add_u32 v226, s70, v226
    v_bfe_u32 v230, v254, 1, 3
    v_xor_b32 v226, v226, v230
    v_lshrrev_b32 v224, 1, v224
    v_lshlrev_b32 v224, 13, v224
    v_lshl_add_u32 v224, v226, 4, v224
    v_and_b32 v230, 15, v254
    v_lshl_add_u32 v224, v230, 7, v224
    s_add_u32 s70, s65, 0
    s_and_b32 s70, s70, 3
    v_xor_b32 v226, s70, v229
    v_lshl_add_u32 v204, v226, 5, v225
    s_lshl_b32 s70, s70, 11
    v_add_u32 v208, s70, v224
    s_add_u32 s70, s65, 1
    s_and_b32 s70, s70, 3
    v_xor_b32 v226, s70, v229
    v_lshl_add_u32 v205, v226, 5, v225
    s_lshl_b32 s70, s70, 11
    v_add_u32 v209, s70, v224
    s_add_u32 s70, s65, 2
    s_and_b32 s70, s70, 3
    v_xor_b32 v226, s70, v229
    v_lshl_add_u32 v206, v226, 5, v225
    s_lshl_b32 s70, s70, 11
    v_add_u32 v210, s70, v224
    s_add_u32 s70, s65, 3
    s_and_b32 s70, s70, 3
    v_xor_b32 v226, s70, v229
    v_lshl_add_u32 v207, v226, 5, v225
    s_lshl_b32 s70, s70, 11
    v_add_u32 v211, s70, v224
    v_lshlrev_b32 v224, 4, v254
    s_and_b32 s71, s23, 3
    s_add_u32 s70, s71, 0
    s_lshr_b32 s72, s70, 2
    s_mul_i32 s72, s72, 348
    s_add_u32 s70, s70, s72
    s_lshl_b32 s70, s70, 10
    v_add_u32 v216, s70, v224
    s_add_u32 s70, s71, 1
    s_lshr_b32 s72, s70, 2
    s_mul_i32 s72, s72, 348
    s_add_u32 s70, s70, s72
    s_lshl_b32 s70, s70, 10
    v_add_u32 v217, s70, v224
    s_mul_i32 s70, s67, 360448
    s_lshl_b32 s71, s65, 12
    s_add_u32 s70, s70, s71
    s_add_u32 s70, s70, 1048576
    s_add_u32 s56, s34, s70
    s_addc_u32 s57, s35, 0
    s_mov_b32 s58, 708608
    s_mov_b32 s59, 0x20000
    s_lshl_b32 s100, s98, 14
    s_lshl_b32 s70, s67, 12
    s_add_u32 s70, s70, 12582912
    v_and_b32 v232, 31, v254
    v_lshlrev_b32 v232, 7, v232
    v_add_u32 v232, s70, v232
    s_lshr_b32 s71, s65, 1
    s_lshl_b32 s71, 0x555555, s71
    v_lshlrev_b32 v224, 17, v254
    v_add_u32 v224, s73, v224
    v_mov_b32 v225, s66
    s_mov_b32 exec_lo, s71
    s_mov_b32 exec_hi, 0
    global_load_dword v236, v232, s[34:35] sc1
    s_waitcnt vmcnt(6)
    s_mov_b64 exec, 1
    global_store_dword v224, v225, s[34:35] sc1
    s_mov_b64 exec, -1
    s_mov_b32 exec_lo, s71
    s_mov_b32 exec_hi, 0
    s_waitcnt vmcnt(1)
    s_branch L_fl_117b
L_fl_117:
    global_load_dword v236, v232, s[34:35] sc1
    s_waitcnt vmcnt(0)
L_fl_117b:
    v_cmp_ne_u32 vcc, s66, v236
    s_cbranch_vccz L_fl_118
    s_sleep 1
    s_sub_u32 s94, s94, 1
    s_cmp_lg_u32 s94, 0
    s_cbranch_scc1 L_fl_117
    s_mov_b32 s94, 1
L_fl_118:
    s_mov_b64 exec, -1
    v_and_b32 v233, 3, v254
    v_lshlrev_b32 v233, 9, v233
    v_add_u32 v233, 157948, v233
    buffer_load_dwordx4 v[128:131], v216, s[56:59], s100 offen sc1
    buffer_load_dwordx4 v[132:135], v217, s[56:59], s100 offen sc1
    s_add_u32 s100, s100, 16384
    s_cmp_eq_u32 s100, 196608
    s_cselect_b32 s100, 0, s100
    buffer_load_dwordx4 v[136:139], v216, s[56:59], s100 offen sc1
    buffer_load_dwordx4 v[140:143], v217, s[56:59], s100 offen sc1
    s_add_u32 s100, s100, 16384
    s_cmp_eq_u32 s100, 196608
    s_cselect_b32 s100, 0, s100
    buffer_load_dwordx4 v[144:147], v216, s[56:59], s100 offen sc1
    buffer_load_dwordx4 v[148:151], v217, s[56:59], s100 offen sc1
    s_add_u32 s100, s100, 16384
    s_cmp_eq_u32 s100, 196608
    s_cselect_b32 s100, 0, s100
    buffer_load_dwordx4 v[152:155], v216, s[56:59], s100 offen sc1
    buffer_load_dwordx4 v[156:159], v217, s[56:59], s100 offen sc1
    s_add_u32 s100, s100, 16384
    s_cmp_eq_u32 s100, 196608
    s_cselect_b32 s100, 0, s100
    buffer_load_dwordx4 v[160:163], v216, s[56:59], s100 offen sc1
    buffer_load_dwordx4 v[164:167], v217, s[56:59], s100 offen sc1
    s_add_u32 s100, s100, 16384
    s_cmp_eq_u32 s100, 196608
    s_cselect_b32 s100, 0, s100
L_st_119:
    s_mov_b64 s[88:89], 0
    v_cmp_ne_u32 vcc, s66, v185
    s_nop 1
    s_or_b64 s[88:89], s[88:89], vcc
    v_cmp_ne_u32 vcc, s66, v187
    s_nop 1
    s_or_b64 s[88:89], s[88:89], vcc
    s_cmp_eq_u64 s[88:89], 0
    s_cbranch_scc1 L_st_120
    global_load_dwordx2 v[184:185], v228, s[34:35] offset:0 sc1
    global_load_dwordx2 v[186:187], v228, s[34:35] offset:128 sc1
    s_waitcnt vmcnt(0)
    s_sleep 1
    s_sub_u32 s94, s94, 1
    s_cmp_lg_u32 s94, 0
    s_cbranch_scc1 L_st_119
    s_mov_b32 s94, 1
L_st_120:
    v_and_b32 v191, 0xffff0000, v189
    v_lshlrev_b32 v190, 16, v189
    v_and_b32 v189, 0xffff0000, v188
    v_lshlrev_b32 v188, 16, v188
    v_and_b32 v185, 0xffff0000, v184
    v_lshlrev_b32 v184, 16, v184
    v_rcp_f32 v185, v185
    v_and_b32 v3, 0xffff0000, v181
    v_lshlrev_b32 v2, 16, v181
    v_and_b32 v1, 0xffff0000, v180
    v_lshlrev_b32 v0, 16, v180
    v_pk_add_f32 v[192:193], v[0:1], v[184:185] op_sel_hi:[1,0] neg_lo:[0,1] neg_hi:[0,1]
    v_pk_add_f32 v[194:195], v[2:3], v[184:185] op_sel_hi:[1,0] neg_lo:[0,1] neg_hi:[0,1]
    v_cvt_pk_bf16_f32 v196, v192, v193
    v_cvt_pk_bf16_f32 v197, v194, v195
    v_and_b32 v195, 0xffff0000, v197
    v_lshlrev_b32 v194, 16, v197
    v_and_b32 v193, 0xffff0000, v196
    v_lshlrev_b32 v192, 16, v196
    v_pk_mul_f32 v[192:193], v[192:193], v[184:185] op_sel:[0,1] op_sel_hi:[1,1]
    v_pk_mul_f32 v[194:195], v[194:195], v[184:185] op_sel:[0,1] op_sel_hi:[1,1]
    v_cvt_pk_bf16_f32 v196, v192, v193
    v_cvt_pk_bf16_f32 v197, v194, v195
    v_and_b32 v195, 0xffff0000, v197
    v_lshlrev_b32 v194, 16, v197
    v_and_b32 v193, 0xffff0000, v196
    v_lshlrev_b32 v192, 16, v196
    v_pk_mul_f32 v[192:193], v[192:193], v[188:189]
    v_pk_mul_f32 v[194:195], v[194:195], v[190:191]
    v_cvt_pk_bf16_f32 v196, v192, v193
    v_cvt_pk_bf16_f32 v197, v194, v195
    v_and_b32 v195, 0xffff0000, v197
    v_lshlrev_b32 v194, 16, v197
    v_and_b32 v193, 0xffff0000, v196
    v_lshlrev_b32 v192, 16, v196
    v_pk_add_f32 v[0:1], v[0:1], v[192:193]
    v_pk_add_f32 v[2:3], v[2:3], v[194:195]
    v_and_b32 v187, 0xffff0000, v186
    v_lshlrev_b32 v186, 16, v186
    v_rcp_f32 v187, v187
    v_and_b32 v7, 0xffff0000, v183
    v_lshlrev_b32 v6, 16, v183
    v_and_b32 v5, 0xffff0000, v182
    v_lshlrev_b32 v4, 16, v182
    v_pk_add_f32 v[192:193], v[4:5], v[186:187] op_sel_hi:[1,0] neg_lo:[0,1] neg_hi:[0,1]
    v_pk_add_f32 v[194:195], v[6:7], v[186:187] op_sel_hi:[1,0] neg_lo:[0,1] neg_hi:[0,1]
    v_cvt_pk_bf16_f32 v196, v192, v193
    v_cvt_pk_bf16_f32 v197, v194, v195
    v_and_b32 v195, 0xffff0000, v197
    v_lshlrev_b32 v194, 16, v197
    v_and_b32 v193, 0xffff0000, v196
    v_lshlrev_b32 v192, 16, v196
    v_pk_mul_f32 v[192:193], v[192:193], v[186:187] op_sel:[0,1] op_sel_hi:[1,1]
    v_pk_mul_f32 v[194:195], v[194:195], v[186:187] op_sel:[0,1] op_sel_hi:[1,1]
    v_cvt_pk_bf16_f32 v196, v192, v193
    v_cvt_pk_bf16_f32 v197, v194, v195
    v_and_b32 v195, 0xffff0000, v197
    v_lshlrev_b32 v194, 16, v197
    v_and_b32 v193, 0xffff0000, v196
    v_lshlrev_b32 v192, 16, v196
    v_pk_mul_f32 v[192:193], v[192:193], v[188:189]
    v_pk_mul_f32 v[194:195], v[194:195], v[190:191]
    v_cvt_pk_bf16_f32 v196, v192, v193
    v_cvt_pk_bf16_f32 v197, v194, v195
    v_and_b32 v195, 0xffff0000, v197
    v_lshlrev_b32 v194, 16, v197
    v_and_b32 v193, 0xffff0000, v196
    v_lshlrev_b32 v192, 16, v196
    v_pk_add_f32 v[4:5], v[4:5], v[192:193]
    v_pk_add_f32 v[6:7], v[6:7], v[194:195]
    v_mov_b32 v234, s3
    ds_read_b32 v235, v233 offset:92
    s_waitcnt lgkmcnt(0)
    v_cmp_ne_u32 vcc, s3, v235
    s_cbranch_vccnz L_sw_121
L_bk_122:
    v_lshlrev_b32 v232, 4, v254
    v_add_u32 v232, 161792, v232
    ds_read_b32 v235, v233 offset:96
    v_add_u32 v212, 0, v204
    v_add_u32 v213, 0, v205
    v_add_u32 v214, 0, v206
    v_add_u32 v215, 0, v207
    ds_read_b64_tr_b16 v[32:33], v212
    ds_read_b64_tr_b16 v[34:35], v212 offset:2048
    ds_read_b64_tr_b16 v[36:37], v213
    ds_read_b64_tr_b16 v[38:39], v213 offset:2048
    ds_read_b64_tr_b16 v[40:41], v214
    ds_read_b64_tr_b16 v[42:43], v214 offset:2048
    ds_read_b64_tr_b16 v[44:45], v215
    ds_read_b64_tr_b16 v[46:47], v215 offset:2048
    v_add_u32 v212, 16384, v204
    v_add_u32 v213, 16384, v205
    v_add_u32 v214, 16384, v206
    v_add_u32 v215, 16384, v207
    ds_read_b64_tr_b16 v[48:49], v212
    ds_read_b64_tr_b16 v[50:51], v212 offset:2048
    ds_read_b64_tr_b16 v[52:53], v213
    ds_read_b64_tr_b16 v[54:55], v213 offset:2048
    ds_read_b64_tr_b16 v[56:57], v214
    ds_read_b64_tr_b16 v[58:59], v214 offset:2048
    ds_read_b64_tr_b16 v[60:61], v215
    ds_read_b64_tr_b16 v[62:63], v215 offset:2048
    s_waitcnt lgkmcnt(8)
    s_waitcnt vmcnt(8)
    v_mfma_f32_16x16x32_bf16 v[0:3], v[32:35], v[128:131], v[0:3]
    ds_write_b32 v253, v234 offset:88
    buffer_load_dwordx4 v[168:171], v216, s[56:59], s100 offen sc1
    v_mfma_f32_16x16x32_bf16 v[4:7], v[32:35], v[132:135], v[4:7]
    v_add_u32 v212, 32768, v204
    v_add_u32 v213, 32768, v205
    v_add_u32 v214, 32768, v206
    v_add_u32 v215, 32768, v207
    v_cmp_ne_u32 vcc, s3, v235
    s_cbranch_vccnz L_sw_126
L_bk_127:
    v_mfma_f32_16x16x32_bf16 v[8:11], v[36:39], v[128:131], 0
    ds_read_b32 v235, v233 offset:100
    v_mfma_f32_16x16x32_bf16 v[12:15], v[36:39], v[132:135], 0
    ds_read_b64_tr_b16 v[64:65], v212
    ds_read_b64_tr_b16 v[66:67], v212 offset:2048
    ds_read_b64_tr_b16 v[68:69], v213
    ds_read_b64_tr_b16 v[70:71], v213 offset:2048
    v_mfma_f32_16x16x32_bf16 v[16:19], v[40:43], v[128:131], 0
    ds_read_b64_tr_b16 v[72:73], v214
    ds_read_b64_tr_b16 v[74:75], v214 offset:2048
    ds_read_b64_tr_b16 v[76:77], v215
    ds_read_b64_tr_b16 v[78:79], v215 offset:2048
    buffer_load_dwordx4 v[172:175], v217, s[56:59], s100 offen sc1
    s_add_u32 s100, s100, 16384
    s_cmp_eq_u32 s100, 196608
    s_cselect_b32 s100, 0, s100
    v_mfma_f32_16x16x32_bf16 v[20:23], v[40:43], v[132:135], 0
    v_mfma_f32_16x16x32_bf16 v[24:27], v[44:47], v[128:131], 0
    v_mfma_f32_16x16x32_bf16 v[28:31], v[44:47], v[132:135], 0
    s_waitcnt lgkmcnt(10)
    s_waitcnt vmcnt(8)
    v_mfma_f32_16x16x32_bf16 v[0:3], v[48:51], v[136:139], v[0:3]
    ds_write_b32 v253, v234 offset:92
    buffer_load_dwordx4 v[128:131], v216, s[56:59], s100 offen sc1
    v_mfma_f32_16x16x32_bf16 v[4:7], v[48:51], v[140:143], v[4:7]
    v_add_u32 v212, 49152, v204
    v_add_u32 v213, 49152, v205
    v_add_u32 v214, 49152, v206
    v_add_u32 v215, 49152, v207
    s_waitcnt lgkmcnt(9)
    v_cmp_ne_u32 vcc, s3, v235
    s_cbranch_vccnz L_sw_129
L_bk_130:
    v_mfma_f32_16x16x32_bf16 v[8:11], v[52:55], v[136:139], v[8:11]
    ds_read_b32 v235, v233 offset:104
    v_mfma_f32_16x16x32_bf16 v[12:15], v[52:55], v[140:143], v[12:15]
    ds_read_b64_tr_b16 v[32:33], v212
    ds_read_b64_tr_b16 v[34:35], v212 offset:2048
    ds_read_b64_tr_b16 v[36:37], v213
    ds_read_b64_tr_b16 v[38:39], v213 offset:2048
    v_mfma_f32_16x16x32_bf16 v[16:19], v[56:59], v[136:139], v[16:19]
    ds_read_b64_tr_b16 v[40:41], v214
    ds_read_b64_tr_b16 v[42:43], v214 offset:2048
    ds_read_b64_tr_b16 v[44:45], v215
    ds_read_b64_tr_b16 v[46:47], v215 offset:2048
    buffer_load_dwordx4 v[132:135], v217, s[56:59], s100 offen sc1
    s_add_u32 s100, s100, 16384
    s_cmp_eq_u32 s100, 196608
    s_cselect_b32 s100, 0, s100
    v_mfma_f32_16x16x32_bf16 v[20:23], v[56:59], v[140:143], v[20:23]
    v_mfma_f32_16x16x32_bf16 v[24:27], v[60:63], v[136:139], v[24:27]
    v_mfma_f32_16x16x32_bf16 v[28:31], v[60:63], v[140:143], v[28:31]
    s_waitcnt lgkmcnt(10)
    s_waitcnt vmcnt(8)
    v_mfma_f32_16x16x32_bf16 v[0:3], v[64:67], v[144:147], v[0:3]
    ds_write_b32 v253, v234 offset:96
    buffer_load_dwordx4 v[136:139], v216, s[56:59], s100 offen sc1
    v_mfma_f32_16x16x32_bf16 v[4:7], v[64:67], v[148:151], v[4:7]
    v_add_u32 v212, 65536, v204
    v_add_u32 v213, 65536, v205
    v_add_u32 v214, 65536, v206
    v_add_u32 v215, 65536, v207
    s_waitcnt lgkmcnt(9)
    v_cmp_ne_u32 vcc, s3, v235
    s_cbranch_vccnz L_sw_132
L_bk_133:
    v_mfma_f32_16x16x32_bf16 v[8:11], v[68:71], v[144:147], v[8:11]
    ds_read_b32 v235, v233 offset:108
    v_mfma_f32_16x16x32_bf16 v[12:15], v[68:71], v[148:151], v[12:15]
    ds_read_b64_tr_b16 v[48:49], v212
    ds_read_b64_tr_b16 v[50:51], v212 offset:2048
    ds_read_b64_tr_b16 v[52:53], v213
    ds_read_b64_tr_b16 v[54:55], v213 offset:2048
    v_mfma_f32_16x16x32_bf16 v[16:19], v[72:75], v[144:147], v[16:19]
    ds_read_b64_tr_b16 v[56:57], v214
    ds_read_b64_tr_b16 v[58:59], v214 offset:2048
    ds_read_b64_tr_b16 v[60:61], v215
    ds_read_b64_tr_b16 v[62:63], v215 offset:2048
    buffer_load_dwordx4 v[140:143], v217, s[56:59], s100 offen sc1
    s_add_u32 s100, s100, 16384
    s_cmp_eq_u32 s100, 196608
    s_cselect_b32 s100, 0, s100
    v_mfma_f32_16x16x32_bf16 v[20:23], v[72:75], v[148:151], v[20:23]
    v_mfma_f32_16x16x32_bf16 v[24:27], v[76:79], v[144:147], v[24:27]
    v_mfma_f32_16x16x32_bf16 v[28:31], v[76:79], v[148:151], v[28:31]
    s_waitcnt lgkmcnt(10)
    s_waitcnt vmcnt(8)
    v_mfma_f32_16x16x32_bf16 v[0:3], v[32:35], v[152:155], v[0:3]
    ds_write_b32 v253, v234 offset:100
    buffer_load_dwordx4 v[144:147], v216, s[56:59], s100 offen sc1
    v_mfma_f32_16x16x32_bf16 v[4:7], v[32:35], v[156:159], v[4:7]
    v_add_u32 v212, 81920, v204
    v_add_u32 v213, 81920, v205
    v_add_u32 v214, 81920, v206
    v_add_u32 v215, 81920, v207
    s_waitcnt lgkmcnt(9)
    v_cmp_ne_u32 vcc, s3, v235
    s_cbranch_vccnz L_sw_135
L_bk_136:
    v_mfma_f32_16x16x32_bf16 v[8:11], v[36:39], v[152:155], v[8:11]
    ds_read_b32 v235, v233 offset:112
    v_mfma_f32_16x16x32_bf16 v[12:15], v[36:39], v[156:159], v[12:15]
    ds_read_b64_tr_b16 v[64:65], v212
    ds_read_b64_tr_b16 v[66:67], v212 offset:2048
    ds_read_b64_tr_b16 v[68:69], v213
    ds_read_b64_tr_b16 v[70:71], v213 offset:2048
    v_mfma_f32_16x16x32_bf16 v[16:19], v[40:43], v[152:155], v[16:19]
    ds_read_b64_tr_b16 v[72:73], v214
    ds_read_b64_tr_b16 v[74:75], v214 offset:2048
    ds_read_b64_tr_b16 v[76:77], v215
    ds_read_b64_tr_b16 v[78:79], v215 offset:2048
    buffer_load_dwordx4 v[148:151], v217, s[56:59], s100 offen sc1
    s_add_u32 s100, s100, 16384
    s_cmp_eq_u32 s100, 196608
    s_cselect_b32 s100, 0, s100
    v_mfma_f32_16x16x32_bf16 v[20:23], v[40:43], v[156:159], v[20:23]
    v_mfma_f32_16x16x32_bf16 v[24:27], v[44:47], v[152:155], v[24:27]
    v_mfma_f32_16x16x32_bf16 v[28:31], v[44:47], v[156:159], v[28:31]
    s_waitcnt lgkmcnt(10)
    s_waitcnt vmcnt(8)
    v_mfma_f32_16x16x32_bf16 v[0:3], v[48:51], v[160:163], v[0:3]
    ds_write_b32 v253, v234 offset:104
    buffer_load_dwordx4 v[152:155], v216, s[56:59], s100 offen sc1
    v_mfma_f32_16x16x32_bf16 v[4:7], v[48:51], v[164:167], v[4:7]
    v_add_u32 v212, 98304, v204
    v_add_u32 v213, 98304, v205
    v_add_u32 v214, 98304, v206
    v_add_u32 v215, 98304, v207
    s_waitcnt lgkmcnt(9)
    v_cmp_ne_u32 vcc, s3, v235
    s_cbranch_vccnz L_sw_138
L_bk_139:
    v_mfma_f32_16x16x32_bf16 v[8:11], v[52:55], v[160:163], v[8:11]
    ds_read_b32 v235, v233 offset:116
    v_mfma_f32_16x16x32_bf16 v[12:15], v[52:55], v[164:167], v[12:15]
    ds_read_b64_tr_b16 v[32:33], v212
    ds_read_b64_tr_b16 v[34:35], v212 offset:2048
    ds_read_b64_tr_b16 v[36:37], v213
    ds_read_b64_tr_b16 v[38:39], v213 offset:2048
    v_mfma_f32_16x16x32_bf16 v[16:19], v[56:59], v[160:163], v[16:19]
    ds_read_b64_tr_b16 v[40:41], v214
    ds_read_b64_tr_b16 v[42:43], v214 offset:2048
    ds_read_b64_tr_b16 v[44:45], v215
    ds_read_b64_tr_b16 v[46:47], v215 offset:2048
    buffer_load_dwordx4 v[156:159], v217, s[56:59], s100 offen sc1
    s_add_u32 s100, s100, 16384
    s_cmp_eq_u32 s100, 196608
    s_cselect_b32 s100, 0, s100
    v_mfma_f32_16x16x32_bf16 v[20:23], v[56:59], v[164:167], v[20:23]
    v_mfma_f32_16x16x32_bf16 v[24:27], v[60:63], v[160:163], v[24:27]
    v_mfma_f32_16x16x32_bf16 v[28:31], v[60:63], v[164:167], v[28:31]
    s_waitcnt lgkmcnt(10)
    s_waitcnt vmcnt(8)
    v_mfma_f32_16x16x32_bf16 v[0:3], v[64:67], v[168:171], v[0:3]
    ds_write_b32 v253, v234 offset:108
    buffer_load_dwordx4 v[160:163], v216, s[56:59], s100 offen sc1
    v_mfma_f32_16x16x32_bf16 v[4:7], v[64:67], v[172:175], v[4:7]
    v_add_u32 v212, 114688, v204
    v_add_u32 v213, 114688, v205
    v_add_u32 v214, 114688, v206
    v_add_u32 v215, 114688, v207
    s_waitcnt lgkmcnt(9)
    v_cmp_ne_u32 vcc, s3, v235
    s_cbranch_vccnz L_sw_141
L_bk_142:
    v_mfma_f32_16x16x32_bf16 v[8:11], v[68:71], v[168:171], v[8:11]
    ds_read_b32 v235, v233 offset:120
    v_mfma_f32_16x16x32_bf16 v[12:15], v[68:71], v[172:175], v[12:15]
    ds_read_b64_tr_b16 v[48:49], v212
    ds_read_b64_tr_b16 v[50:51], v212 offset:2048
    ds_read_b64_tr_b16 v[52:53], v213
    ds_read_b64_tr_b16 v[54:55], v213 offset:2048
    v_mfma_f32_16x16x32_bf16 v[16:19], v[72:75], v[168:171], v[16:19]
    ds_read_b64_tr_b16 v[56:57], v214
    ds_read_b64_tr_b16 v[58:59], v214 offset:2048
    ds_read_b64_tr_b16 v[60:61], v215
    ds_read_b64_tr_b16 v[62:63], v215 offset:2048
    buffer_load_dwordx4 v[164:167], v217, s[56:59], s100 offen sc1
    s_add_u32 s100, s100, 16384
    s_cmp_eq_u32 s100, 196608
    s_cselect_b32 s100, 0, s100
    v_mfma_f32_16x16x32_bf16 v[20:23], v[72:75], v[172:175], v[20:23]
    v_mfma_f32_16x16x32_bf16 v[24:27], v[76:79], v[168:171], v[24:27]
    v_mfma_f32_16x16x32_bf16 v[28:31], v[76:79], v[172:175], v[28:31]
    s_waitcnt lgkmcnt(10)
    s_waitcnt vmcnt(8)
    v_mfma_f32_16x16x32_bf16 v[0:3], v[32:35], v[128:131], v[0:3]
    ds_write_b32 v253, v234 offset:112
    buffer_load_dwordx4 v[168:171], v216, s[56:59], s100 offen sc1
    v_mfma_f32_16x16x32_bf16 v[4:7], v[32:35], v[132:135], v[4:7]
    v_add_u32 v212, 131072, v204
    v_add_u32 v213, 131072, v205
    v_add_u32 v214, 131072, v206
    v_add_u32 v215, 131072, v207
    s_waitcnt lgkmcnt(9)
    v_cmp_ne_u32 vcc, s3, v235
    s_cbranch_vccnz L_sw_144
L_bk_145:
    v_mfma_f32_16x16x32_bf16 v[8:11], v[36:39], v[128:131], v[8:11]
    ds_read_b32 v235, v233 offset:124
    v_mfma_f32_16x16x32_bf16 v[12:15], v[36:39], v[132:135], v[12:15]
    ds_read_b64_tr_b16 v[64:65], v212
    ds_read_b64_tr_b16 v[66:67], v212 offset:2048
    ds_read_b64_tr_b16 v[68:69], v213
    ds_read_b64_tr_b16 v[70:71], v213 offset:2048
    v_mfma_f32_16x16x32_bf16 v[16:19], v[40:43], v[128:131], v[16:19]
    ds_read_b64_tr_b16 v[72:73], v214
    ds_read_b64_tr_b16 v[74:75], v214 offset:2048
    ds_read_b64_tr_b16 v[76:77], v215
    ds_read_b64_tr_b16 v[78:79], v215 offset:2048
    buffer_load_dwordx4 v[172:175], v217, s[56:59], s100 offen sc1
    s_mul_i32 s100, s99, 16384
    s_add_u32 s100, s100, 196608
    v_mfma_f32_16x16x32_bf16 v[20:23], v[40:43], v[132:135], v[20:23]
    ds_read_b32 v236, v232
    v_mfma_f32_16x16x32_bf16 v[24:27], v[44:47], v[128:131], v[24:27]
    v_mfma_f32_16x16x32_bf16 v[28:31], v[44:47], v[132:135], v[28:31]
    s_waitcnt lgkmcnt(0)
    v_cmp_le_u32 vcc, 3, v236
    s_cbranch_vccz L_late_124
    s_waitcnt vmcnt(8)
    v_mfma_f32_16x16x32_bf16 v[0:3], v[48:51], v[136:139], v[0:3]
    ds_write_b32 v253, v234 offset:116
    buffer_load_dwordx4 v[128:131], v216, s[56:59], s100 offen sc1
    v_mfma_f32_16x16x32_bf16 v[4:7], v[48:51], v[140:143], v[4:7]
    v_add_u32 v212, 0, v204
    v_add_u32 v213, 0, v205
    v_add_u32 v214, 0, v206
    v_add_u32 v215, 0, v207
    v_cmp_ne_u32 vcc, s3, v235
    s_cbranch_vccnz L_sw_164
L_bk_165:
    v_mfma_f32_16x16x32_bf16 v[8:11], v[52:55], v[136:139], v[8:11]
    ds_read_b32 v235, v233 offset:128
    v_mfma_f32_16x16x32_bf16 v[12:15], v[52:55], v[140:143], v[12:15]
    ds_read_b64_tr_b16 v[32:33], v212
    ds_read_b64_tr_b16 v[34:35], v212 offset:2048
    ds_read_b64_tr_b16 v[36:37], v213
    ds_read_b64_tr_b16 v[38:39], v213 offset:2048
    v_mfma_f32_16x16x32_bf16 v[16:19], v[56:59], v[136:139], v[16:19]
    ds_read_b64_tr_b16 v[40:41], v214
    ds_read_b64_tr_b16 v[42:43], v214 offset:2048
    ds_read_b64_tr_b16 v[44:45], v215
    ds_read_b64_tr_b16 v[46:47], v215 offset:2048
    buffer_load_dwordx4 v[132:135], v217, s[56:59], s100 offen sc1
    s_add_u32 s100, s100, 16384
    s_cmp_eq_u32 s100, 360448
    s_cselect_b32 s100, 196608, s100
    v_mfma_f32_16x16x32_bf16 v[20:23], v[56:59], v[140:143], v[20:23]
    v_mfma_f32_16x16x32_bf16 v[24:27], v[60:63], v[136:139], v[24:27]
    v_mfma_f32_16x16x32_bf16 v[28:31], v[60:63], v[140:143], v[28:31]
    s_waitcnt vmcnt(8)
    v_mfma_f32_16x16x32_bf16 v[0:3], v[64:67], v[144:147], v[0:3]
    ds_write_b32 v253, v234 offset:120
    buffer_load_dwordx4 v[136:139], v216, s[56:59], s100 offen sc1
    v_mfma_f32_16x16x32_bf16 v[4:7], v[64:67], v[148:151], v[4:7]
    v_add_u32 v212, 16384, v204
    v_add_u32 v213, 16384, v205
    v_add_u32 v214, 16384, v206
    v_add_u32 v215, 16384, v207
    s_waitcnt lgkmcnt(9)
    v_cmp_ne_u32 vcc, s3, v235
    s_cbranch_vccnz L_sw_167
L_bk_168:
    v_mfma_f32_16x16x32_bf16 v[8:11], v[68:71], v[144:147], v[8:11]
    ds_read_b32 v235, v233 offset:132
    v_mfma_f32_16x16x32_bf16 v[12:15], v[68:71], v[148:151], v[12:15]
    ds_read_b64_tr_b16 v[48:49], v212
    ds_read_b64_tr_b16 v[50:51], v212 offset:2048
    ds_read_b64_tr_b16 v[52:53], v213
    ds_read_b64_tr_b16 v[54:55], v213 offset:2048
    v_mfma_f32_16x16x32_bf16 v[16:19], v[72:75], v[144:147], v[16:19]
    ds_read_b64_tr_b16 v[56:57], v214
    ds_read_b64_tr_b16 v[58:59], v214 offset:2048
    ds_read_b64_tr_b16 v[60:61], v215
    ds_read_b64_tr_b16 v[62:63], v215 offset:2048
    buffer_load_dwordx4 v[140:143], v217, s[56:59], s100 offen sc1
    s_add_u32 s100, s100, 16384
    s_cmp_eq_u32 s100, 360448
    s_cselect_b32 s100, 196608, s100
    v_mfma_f32_16x16x32_bf16 v[20:23], v[72:75], v[148:151], v[20:23]
    v_mfma_f32_16x16x32_bf16 v[24:27], v[76:79], v[144:147], v[24:27]
    v_mfma_f32_16x16x32_bf16 v[28:31], v[76:79], v[148:151], v[28:31]
    s_waitcnt lgkmcnt(10)
    s_waitcnt vmcnt(8)
    v_mfma_f32_16x16x32_bf16 v[0:3], v[32:35], v[152:155], v[0:3]
    ds_write_b32 v253, v234 offset:124
    buffer_load_dwordx4 v[144:147], v216, s[56:59], s100 offen sc1
    v_mfma_f32_16x16x32_bf16 v[4:7], v[32:35], v[156:159], v[4:7]
    v_add_u32 v212, 32768, v204
    v_add_u32 v213, 32768, v205
    v_add_u32 v214, 32768, v206
    v_add_u32 v215, 32768, v207
    s_waitcnt lgkmcnt(9)
    v_cmp_ne_u32 vcc, s3, v235
    s_cbranch_vccnz L_sw_170
L_bk_171:
    v_mfma_f32_16x16x32_bf16 v[8:11], v[36:39], v[152:155], v[8:11]
    ds_read_b32 v235, v233 offset:136
    v_mfma_f32_16x16x32_bf16 v[12:15], v[36:39], v[156:159], v[12:15]
    ds_read_b64_tr_b16 v[64:65], v212
    ds_read_b64_tr_b16 v[66:67], v212 offset:2048
    ds_read_b64_tr_b16 v[68:69], v213
    ds_read_b64_tr_b16 v[70:71], v213 offset:2048
    v_mfma_f32_16x16x32_bf16 v[16:19], v[40:43], v[152:155], v[16:19]
    ds_read_b64_tr_b16 v[72:73], v214
    ds_read_b64_tr_b16 v[74:75], v214 offset:2048
    ds_read_b64_tr_b16 v[76:77], v215
    ds_read_b64_tr_b16 v[78:79], v215 offset:2048
    buffer_load_dwordx4 v[148:151], v217, s[56:59], s100 offen sc1
    s_add_u32 s100, s100, 16384
    s_cmp_eq_u32 s100, 360448
    s_cselect_b32 s100, 196608, s100
    v_mfma_f32_16x16x32_bf16 v[20:23], v[40:43], v[156:159], v[20:23]
    v_mfma_f32_16x16x32_bf16 v[24:27], v[44:47], v[152:155], v[24:27]
    v_mfma_f32_16x16x32_bf16 v[28:31], v[44:47], v[156:159], v[28:31]
    s_waitcnt lgkmcnt(10)
    s_waitcnt vmcnt(8)
    v_mfma_f32_16x16x32_bf16 v[0:3], v[48:51], v[160:163], v[0:3]
    ds_write_b32 v253, v234 offset:128
    buffer_load_dwordx4 v[152:155], v216, s[56:59], s100 offen sc1
    v_mfma_f32_16x16x32_bf16 v[4:7], v[48:51], v[164:167], v[4:7]
    v_add_u32 v212, 49152, v208
    v_add_u32 v213, 49152, v209
    v_add_u32 v214, 49152, v210
    v_add_u32 v215, 49152, v211
    s_waitcnt lgkmcnt(9)
    v_cmp_ne_u32 vcc, s3, v235
    s_cbranch_vccnz L_sw_173
L_bk_174:
    v_mfma_f32_16x16x32_bf16 v[8:11], v[52:55], v[160:163], v[8:11]
    ds_read_b32 v235, v233 offset:140
    v_mfma_f32_16x16x32_bf16 v[12:15], v[52:55], v[164:167], v[12:15]
    ds_read_b128 v[32:35], v212
    ds_read_b128 v[36:39], v213
    v_mfma_f32_16x16x32_bf16 v[16:19], v[56:59], v[160:163], v[16:19]
    ds_read_b128 v[40:43], v214
    ds_read_b128 v[44:47], v215
    buffer_load_dwordx4 v[156:159], v217, s[56:59], s100 offen sc1
    s_add_u32 s100, s100, 16384
    s_cmp_eq_u32 s100, 360448
    s_cselect_b32 s100, 196608, s100
    v_mfma_f32_16x16x32_bf16 v[20:23], v[56:59], v[164:167], v[20:23]
    v_mfma_f32_16x16x32_bf16 v[24:27], v[60:63], v[160:163], v[24:27]
    v_mfma_f32_16x16x32_bf16 v[28:31], v[60:63], v[164:167], v[28:31]
    s_waitcnt lgkmcnt(6)
    s_waitcnt vmcnt(8)
    v_mfma_f32_16x16x32_bf16 v[0:3], v[64:67], v[168:171], v[0:3]
    ds_write_b32 v253, v234 offset:132
    buffer_load_dwordx4 v[160:163], v216, s[56:59], s100 offen sc1
    v_mfma_f32_16x16x32_bf16 v[4:7], v[64:67], v[172:175], v[4:7]
    v_add_u32 v212, 65536, v208
    v_add_u32 v213, 65536, v209
    v_add_u32 v214, 65536, v210
    v_add_u32 v215, 65536, v211
    s_waitcnt lgkmcnt(5)
    v_cmp_ne_u32 vcc, s3, v235
    s_cbranch_vccnz L_sw_176
L_bk_177:
    v_mfma_f32_16x16x32_bf16 v[8:11], v[68:71], v[168:171], v[8:11]
    ds_read_b32 v235, v233 offset:144
    v_mfma_f32_16x16x32_bf16 v[12:15], v[68:71], v[172:175], v[12:15]
    ds_read_b128 v[48:51], v212
    ds_read_b128 v[52:55], v213
    v_mfma_f32_16x16x32_bf16 v[16:19], v[72:75], v[168:171], v[16:19]
    ds_read_b128 v[56:59], v214
    ds_read_b128 v[60:63], v215
    buffer_load_dwordx4 v[164:167], v217, s[56:59], s100 offen sc1
    s_add_u32 s100, s100, 16384
    s_cmp_eq_u32 s100, 360448
    s_cselect_b32 s100, 196608, s100
    v_mfma_f32_16x16x32_bf16 v[20:23], v[72:75], v[172:175], v[20:23]
    v_mfma_f32_16x16x32_bf16 v[24:27], v[76:79], v[168:171], v[24:27]
    v_mfma_f32_16x16x32_bf16 v[28:31], v[76:79], v[172:175], v[28:31]
L_join_125:
    s_waitcnt lgkmcnt(6)
    s_waitcnt vmcnt(8)
    v_mfma_f32_16x16x32_bf16 v[0:3], v[32:35], v[128:131], v[0:3]
    ds_write_b32 v253, v234 offset:136
    buffer_load_dwordx4 v[168:171], v216, s[56:59], s100 offen sc1
    v_mfma_f32_16x16x32_bf16 v[4:7], v[32:35], v[132:135], v[4:7]
    v_add_u32 v212, 81920, v208
    v_add_u32 v213, 81920, v209
    v_add_u32 v214, 81920, v210
    v_add_u32 v215, 81920, v211
    s_waitcnt lgkmcnt(5)
    v_cmp_ne_u32 vcc, s3, v235
    s_cbranch_vccnz L_sw_179
L_bk_180:
    v_mfma_f32_16x16x32_bf16 v[8:11], v[36:39], v[128:131], v[8:11]
    ds_read_b32 v235, v233 offset:148
    v_mfma_f32_16x16x32_bf16 v[12:15], v[36:39], v[132:135], v[12:15]
    ds_read_b128 v[64:67], v212
    ds_read_b128 v[68:71], v213
    v_mfma_f32_16x16x32_bf16 v[16:19], v[40:43], v[128:131], v[16:19]
    ds_read_b128 v[72:75], v214
    ds_read_b128 v[76:79], v215
    buffer_load_dwordx4 v[172:175], v217, s[56:59], s100 offen sc1
    s_add_u32 s100, s100, 16384
    s_cmp_eq_u32 s100, 360448
    s_cselect_b32 s100, 196608, s100
    v_mfma_f32_16x16x32_bf16 v[20:23], v[40:43], v[132:135], v[20:23]
    v_mfma_f32_16x16x32_bf16 v[24:27], v[44:47], v[128:131], v[24:27]
    v_mfma_f32_16x16x32_bf16 v[28:31], v[44:47], v[132:135], v[28:31]
    s_waitcnt lgkmcnt(6)
    s_waitcnt vmcnt(8)
    v_mfma_f32_16x16x32_bf16 v[0:3], v[48:51], v[136:139], v[0:3]
    ds_write_b32 v253, v234 offset:140
    buffer_load_dwordx4 v[128:131], v216, s[56:59], s100 offen sc1
    v_mfma_f32_16x16x32_bf16 v[4:7], v[48:51], v[140:143], v[4:7]
    v_add_u32 v212, 98304, v208
    v_add_u32 v213, 98304, v209
    v_add_u32 v214, 98304, v210
    v_add_u32 v215, 98304, v211
    s_waitcnt lgkmcnt(5)
    v_cmp_ne_u32 vcc, s3, v235
    s_cbranch_vccnz L_sw_182
L_bk_183:
    v_mfma_f32_16x16x32_bf16 v[8:11], v[52:55], v[136:139], v[8:11]
    ds_read_b32 v235, v233 offset:152
    v_mfma_f32_16x16x32_bf16 v[12:15], v[52:55], v[140:143], v[12:15]
    ds_read_b128 v[32:35], v212
    ds_read_b128 v[36:39], v213
    v_mfma_f32_16x16x32_bf16 v[16:19], v[56:59], v[136:139], v[16:19]
    ds_read_b128 v[40:43], v214
    ds_read_b128 v[44:47], v215
    buffer_load_dwordx4 v[132:135], v217, s[56:59], s100 offen sc1
    s_add_u32 s100, s100, 16384
    s_cmp_eq_u32 s100, 360448
    s_cselect_b32 s100, 196608, s100
    v_mfma_f32_16x16x32_bf16 v[20:23], v[56:59], v[140:143], v[20:23]
    v_mfma_f32_16x16x32_bf16 v[24:27], v[60:63], v[136:139], v[24:27]
    v_mfma_f32_16x16x32_bf16 v[28:31], v[60:63], v[140:143], v[28:31]
    s_waitcnt lgkmcnt(6)
    s_waitcnt vmcnt(8)
    v_mfma_f32_16x16x32_bf16 v[0:3], v[64:67], v[144:147], v[0:3]
    ds_write_b32 v253, v234 offset:144
    buffer_load_dwordx4 v[136:139], v216, s[56:59], s100 offen sc1
    v_mfma_f32_16x16x32_bf16 v[4:7], v[64:67], v[148:151], v[4:7]
    v_add_u32 v212, 114688, v208
    v_add_u32 v213, 114688, v209
    v_add_u32 v214, 114688, v210
    v_add_u32 v215, 114688, v211
    s_waitcnt lgkmcnt(5)
    v_cmp_ne_u32 vcc, s3, v235
    s_cbranch_vccnz L_sw_185
L_bk_186:
    v_mfma_f32_16x16x32_bf16 v[8:11], v[68:71], v[144:147], v[8:11]
    ds_read_b32 v235, v233 offset:156
    v_mfma_f32_16x16x32_bf16 v[12:15], v[68:71], v[148:151], v[12:15]
    ds_read_b128 v[48:51], v212
    ds_read_b128 v[52:55], v213
    v_mfma_f32_16x16x32_bf16 v[16:19], v[72:75], v[144:147], v[16:19]
    ds_read_b128 v[56:59], v214
    ds_read_b128 v[60:63], v215
    buffer_load_dwordx4 v[140:143], v217, s[56:59], s100 offen sc1
    s_add_u32 s100, s100, 16384
    s_cmp_eq_u32 s100, 360448
    s_cselect_b32 s100, 196608, s100
    v_mfma_f32_16x16x32_bf16 v[20:23], v[72:75], v[148:151], v[20:23]
    v_mfma_f32_16x16x32_bf16 v[24:27], v[76:79], v[144:147], v[24:27]
    v_mfma_f32_16x16x32_bf16 v[28:31], v[76:79], v[148:151], v[28:31]
    s_waitcnt lgkmcnt(6)
    s_waitcnt vmcnt(8)
    v_mfma_f32_16x16x32_bf16 v[0:3], v[32:35], v[152:155], v[0:3]
    ds_write_b32 v253, v234 offset:148
    buffer_load_dwordx4 v[144:147], v216, s[56:59], s100 offen sc1
    v_mfma_f32_16x16x32_bf16 v[4:7], v[32:35], v[156:159], v[4:7]
    v_add_u32 v212, 131072, v208
    v_add_u32 v213, 131072, v209
    v_add_u32 v214, 131072, v210
    v_add_u32 v215, 131072, v211
    s_waitcnt lgkmcnt(5)
    v_cmp_ne_u32 vcc, s3, v235
    s_cbranch_vccnz L_sw_188
L_bk_189:
    v_mfma_f32_16x16x32_bf16 v[8:11], v[36:39], v[152:155], v[8:11]
    ds_read_b32 v235, v233 offset:160
    v_mfma_f32_16x16x32_bf16 v[12:15], v[36:39], v[156:159], v[12:15]
    ds_read_b128 v[64:67], v212
    ds_read_b128 v[68:71], v213
    v_mfma_f32_16x16x32_bf16 v[16:19], v[40:43], v[152:155], v[16:19]
    ds_read_b128 v[72:75], v214
    ds_read_b128 v[76:79], v215
    buffer_load_dwordx4 v[148:151], v217, s[56:59], s100 offen sc1
    s_add_u32 s100, s100, 16384
    s_cmp_eq_u32 s100, 360448
    s_cselect_b32 s100, 196608, s100
    v_mfma_f32_16x16x32_bf16 v[20:23], v[40:43], v[156:159], v[20:23]
    v_mfma_f32_16x16x32_bf16 v[24:27], v[44:47], v[152:155], v[24:27]
    v_mfma_f32_16x16x32_bf16 v[28:31], v[44:47], v[156:159], v[28:31]
    s_waitcnt lgkmcnt(6)
    s_waitcnt vmcnt(8)
    v_mfma_f32_16x16x32_bf16 v[0:3], v[48:51], v[160:163], v[0:3]
    ds_write_b32 v253, v234 offset:152
    buffer_load_dwordx4 v[152:155], v216, s[56:59], s100 offen sc1
    v_mfma_f32_16x16x32_bf16 v[4:7], v[48:51], v[164:167], v[4:7]
    v_add_u32 v212, 0, v208
    v_add_u32 v213, 0, v209
    v_add_u32 v214, 0, v210
    v_add_u32 v215, 0, v211
    s_waitcnt lgkmcnt(5)
    v_cmp_ne_u32 vcc, s3, v235
    s_cbranch_vccnz L_sw_191
L_bk_192:
    v_mfma_f32_16x16x32_bf16 v[8:11], v[52:55], v[160:163], v[8:11]
    ds_read_b32 v235, v233 offset:164
    v_mfma_f32_16x16x32_bf16 v[12:15], v[52:55], v[164:167], v[12:15]
    ds_read_b128 v[32:35], v212
    ds_read_b128 v[36:39], v213
    v_mfma_f32_16x16x32_bf16 v[16:19], v[56:59], v[160:163], v[16:19]
    ds_read_b128 v[40:43], v214
    ds_read_b128 v[44:47], v215
    buffer_load_dwordx4 v[156:159], v217, s[56:59], s100 offen sc1
    v_mfma_f32_16x16x32_bf16 v[20:23], v[56:59], v[164:167], v[20:23]
    v_mfma_f32_16x16x32_bf16 v[24:27], v[60:63], v[160:163], v[24:27]
    v_mfma_f32_16x16x32_bf16 v[28:31], v[60:63], v[164:167], v[28:31]
    s_waitcnt lgkmcnt(6)
    s_waitcnt vmcnt(8)
    v_mfma_f32_16x16x32_bf16 v[0:3], v[64:67], v[168:171], v[0:3]
    ds_write_b32 v253, v234 offset:156
    v_mfma_f32_16x16x32_bf16 v[4:7], v[64:67], v[172:175], v[4:7]
    v_add_u32 v212, 16384, v208
    v_add_u32 v213, 16384, v209
    v_add_u32 v214, 16384, v210
    v_add_u32 v215, 16384, v211
    s_waitcnt lgkmcnt(5)
    v_cmp_ne_u32 vcc, s3, v235
    s_cbranch_vccnz L_sw_194
L_bk_195:
    v_mfma_f32_16x16x32_bf16 v[8:11], v[68:71], v[168:171], v[8:11]
    ds_read_b32 v235, v233 offset:168
    v_mfma_f32_16x16x32_bf16 v[12:15], v[68:71], v[172:175], v[12:15]
    ds_read_b128 v[48:51], v212
    ds_read_b128 v[52:55], v213
    v_mfma_f32_16x16x32_bf16 v[16:19], v[72:75], v[168:171], v[16:19]
    ds_read_b128 v[56:59], v214
    ds_read_b128 v[60:63], v215
    v_mfma_f32_16x16x32_bf16 v[20:23], v[72:75], v[172:175], v[20:23]
    v_mfma_f32_16x16x32_bf16 v[24:27], v[76:79], v[168:171], v[24:27]
    v_mfma_f32_16x16x32_bf16 v[28:31], v[76:79], v[172:175], v[28:31]
    s_waitcnt lgkmcnt(6)
    s_waitcnt vmcnt(6)
    v_mfma_f32_16x16x32_bf16 v[0:3], v[32:35], v[128:131], v[0:3]
    ds_write_b32 v253, v234 offset:160
    v_mfma_f32_16x16x32_bf16 v[4:7], v[32:35], v[132:135], v[4:7]
    v_add_u32 v212, 32768, v208
    v_add_u32 v213, 32768, v209
    v_add_u32 v214, 32768, v210
    v_add_u32 v215, 32768, v211
    s_waitcnt lgkmcnt(5)
    v_cmp_ne_u32 vcc, s3, v235
    s_cbranch_vccnz L_sw_197
L_bk_198:
    v_mfma_f32_16x16x32_bf16 v[8:11], v[36:39], v[128:131], v[8:11]
    ds_read_b32 v235, v233 offset:172
    v_mfma_f32_16x16x32_bf16 v[12:15], v[36:39], v[132:135], v[12:15]
    ds_read_b128 v[64:67], v212
    ds_read_b128 v[68:71], v213
    v_mfma_f32_16x16x32_bf16 v[16:19], v[40:43], v[128:131], v[16:19]
    ds_read_b128 v[72:75], v214
    ds_read_b128 v[76:79], v215
    v_mfma_f32_16x16x32_bf16 v[20:23], v[40:43], v[132:135], v[20:23]
    v_mfma_f32_16x16x32_bf16 v[24:27], v[44:47], v[128:131], v[24:27]
    v_mfma_f32_16x16x32_bf16 v[28:31], v[44:47], v[132:135], v[28:31]
    s_waitcnt lgkmcnt(6)
    s_waitcnt vmcnt(4)
    v_mfma_f32_16x16x32_bf16 v[0:3], v[48:51], v[136:139], v[0:3]
    ds_write_b32 v253, v234 offset:164
    v_mfma_f32_16x16x32_bf16 v[4:7], v[48:51], v[140:143], v[4:7]
    v_add_u32 v212, 49152, v208
    v_add_u32 v213, 49152, v209
    v_add_u32 v214, 49152, v210
    v_add_u32 v215, 49152, v211
    s_waitcnt lgkmcnt(5)
    v_cmp_ne_u32 vcc, s3, v235
    s_cbranch_vccnz L_sw_200
L_bk_201:
    v_mfma_f32_16x16x32_bf16 v[8:11], v[52:55], v[136:139], v[8:11]
    ds_read_b128 v[32:35], v212
    ds_read_b128 v[36:39], v213
    v_mfma_f32_16x16x32_bf16 v[12:15], v[52:55], v[140:143], v[12:15]
    ds_read_b128 v[40:43], v214
    ds_read_b128 v[44:47], v215
    v_mfma_f32_16x16x32_bf16 v[16:19], v[56:59], v[136:139], v[16:19]
    v_mfma_f32_16x16x32_bf16 v[20:23], v[56:59], v[140:143], v[20:23]
    v_mfma_f32_16x16x32_bf16 v[24:27], v[60:63], v[136:139], v[24:27]
    v_mfma_f32_16x16x32_bf16 v[28:31], v[60:63], v[140:143], v[28:31]
    s_waitcnt lgkmcnt(5)
    s_waitcnt vmcnt(2)
    v_mfma_f32_16x16x32_bf16 v[0:3], v[64:67], v[144:147], v[0:3]
    ds_write_b32 v253, v234 offset:168
    v_mfma_f32_16x16x32_bf16 v[4:7], v[64:67], v[148:151], v[4:7]
    v_mfma_f32_16x16x32_bf16 v[8:11], v[68:71], v[144:147], v[8:11]
    v_mfma_f32_16x16x32_bf16 v[12:15], v[68:71], v[148:151], v[12:15]
    v_mfma_f32_16x16x32_bf16 v[16:19], v[72:75], v[144:147], v[16:19]
    v_mfma_f32_16x16x32_bf16 v[20:23], v[72:75], v[148:151], v[20:23]
    v_mfma_f32_16x16x32_bf16 v[24:27], v[76:79], v[144:147], v[24:27]
    v_mfma_f32_16x16x32_bf16 v[28:31], v[76:79], v[148:151], v[28:31]
    s_waitcnt lgkmcnt(1)
    s_waitcnt vmcnt(0)
    v_mfma_f32_16x16x32_bf16 v[0:3], v[32:35], v[152:155], v[0:3]
    ds_write_b32 v253, v234 offset:172
    v_mfma_f32_16x16x32_bf16 v[4:7], v[32:35], v[156:159], v[4:7]
    v_mfma_f32_16x16x32_bf16 v[8:11], v[36:39], v[152:155], v[8:11]
    v_mfma_f32_16x16x32_bf16 v[12:15], v[36:39], v[156:159], v[12:15]
    v_mfma_f32_16x16x32_bf16 v[16:19], v[40:43], v[152:155], v[16:19]
    v_mfma_f32_16x16x32_bf16 v[20:23], v[40:43], v[156:159], v[20:23]
    v_mfma_f32_16x16x32_bf16 v[24:27], v[44:47], v[152:155], v[24:27]
    v_mfma_f32_16x16x32_bf16 v[28:31], v[44:47], v[156:159], v[28:31]
    ds_read_b32 v235, v233 offset:2192
    s_waitcnt lgkmcnt(0)
    v_cmp_ne_u32 vcc, s3, v235
    s_cbranch_vccnz L_sw_203
L_bk_204:
    v_lshlrev_b32 v212, 4, v254
    s_add_u32 s70, s65, 1
    s_and_b32 s70, s70, 3
    s_mul_i32 s70, s70, 6144
    s_add_u32 s70, s70, 65536
    v_add_u32 v213, s70, v212
    s_add_u32 s70, s65, 2
    s_and_b32 s70, s70, 3
    s_mul_i32 s70, s70, 6144
    s_add_u32 s70, s70, 67584
    v_add_u32 v214, s70, v212
    s_add_u32 s70, s65, 3
    s_and_b32 s70, s70, 3
    s_mul_i32 s70, s70, 6144
    s_add_u32 s70, s70, 69632
    v_add_u32 v215, s70, v212
    s_mul_i32 s70, s65, 6144
    s_add_u32 s70, s70, 65536
    v_add_u32 v212, s70, v212
    ds_write_b128 v213, v[8:11] offset:0
    ds_write_b128 v214, v[16:19] offset:0
    ds_write_b128 v215, v[24:27] offset:0
    ds_write_b128 v213, v[12:15] offset:1024
    ds_write_b128 v214, v[20:23] offset:1024
    ds_write_b128 v215, v[28:31] offset:1024
    s_waitcnt lgkmcnt(0)
    s_barrier
    ds_read_b128 v[8:11], v212 offset:0
    ds_read_b128 v[16:19], v212 offset:2048
    ds_read_b128 v[24:27], v212 offset:4096
    ds_read_b128 v[12:15], v212 offset:1024
    ds_read_b128 v[20:23], v212 offset:3072
    ds_read_b128 v[28:31], v212 offset:5120
    s_waitcnt lgkmcnt(3)
    v_pk_add_f32 v[0:1], v[0:1], v[8:9]
    v_pk_add_f32 v[16:17], v[16:17], v[24:25]
    v_pk_add_f32 v[2:3], v[2:3], v[10:11]
    v_pk_add_f32 v[18:19], v[18:19], v[26:27]
    v_pk_add_f32 v[0:1], v[0:1], v[16:17]
    v_pk_add_f32 v[2:3], v[2:3], v[18:19]
    global_store_dwordx4 v227, v[0:3], s[30:31] nt
    v_add_u32 v227, 40960, v227
    s_waitcnt lgkmcnt(0)
    v_pk_add_f32 v[4:5], v[4:5], v[12:13]
    v_pk_add_f32 v[20:21], v[20:21], v[28:29]
    v_pk_add_f32 v[6:7], v[6:7], v[14:15]
    v_pk_add_f32 v[22:23], v[22:23], v[30:31]
    v_pk_add_f32 v[4:5], v[4:5], v[20:21]
    v_pk_add_f32 v[6:7], v[6:7], v[22:23]
    global_store_dwordx4 v227, v[4:7], s[30:31] nt
    s_endpgm
L_sw_103:
L_sr_105:
    ds_read_b32 v250, v248 offset:4
    s_waitcnt lgkmcnt(0)
    v_cmp_ne_u32 vcc, s3, v250
    s_cbranch_vccz L_bk_104
    s_sub_u32 s94, s94, 1
    s_cmp_lg_u32 s94, 0
    s_cbranch_scc1 L_sr_105
    s_mov_b32 s94, 1
    s_branch L_bk_104
L_sw_106:
L_sr_108:
    ds_read_b32 v250, v248 offset:0
    s_waitcnt lgkmcnt(0)
    v_cmp_ne_u32 vcc, s3, v250
    s_cbranch_vccz L_bk_107
    s_sub_u32 s94, s94, 1
    s_cmp_lg_u32 s94, 0
    s_cbranch_scc1 L_sr_108
    s_mov_b32 s94, 1
    s_branch L_bk_107
L_sw_109:
L_sr_111:
    ds_read_b32 v250, v248 offset:0
    s_waitcnt lgkmcnt(0)
    v_cmp_ne_u32 vcc, s3, v250
    s_cbranch_vccz L_bk_110
    s_sub_u32 s94, s94, 1
    s_cmp_lg_u32 s94, 0
    s_cbranch_scc1 L_sr_111
    s_mov_b32 s94, 1
    s_branch L_bk_110
L_sw_114:
L_sr_116:
    ds_read_b32 v250, v248 offset:72
    s_waitcnt lgkmcnt(0)
    v_cmp_ne_u32 vcc, s3, v250
    s_cbranch_vccz L_bk_115
    s_sub_u32 s94, s94, 1
    s_cmp_lg_u32 s94, 0
    s_cbranch_scc1 L_sr_116
    s_mov_b32 s94, 1
    s_branch L_bk_115
L_sw_121:
L_sr_123:
    ds_read_b32 v235, v233 offset:92
    s_waitcnt lgkmcnt(0)
    v_cmp_ne_u32 vcc, s3, v235
    s_cbranch_vccz L_bk_122
    s_sub_u32 s94, s94, 1
    s_cmp_lg_u32 s94, 0
    s_cbranch_scc1 L_sr_123
    s_mov_b32 s94, 1
    s_branch L_bk_122
L_sw_126:
L_sr_128:
    ds_read_b32 v235, v233 offset:96
    s_waitcnt lgkmcnt(0)
    v_cmp_ne_u32 vcc, s3, v235
    s_cbranch_vccz L_bk_127
    s_sub_u32 s94, s94, 1
    s_cmp_lg_u32 s94, 0
    s_cbranch_scc1 L_sr_128
    s_mov_b32 s94, 1
    s_branch L_bk_127
L_sw_129:
L_sr_131:
    ds_read_b32 v235, v233 offset:100
    s_waitcnt lgkmcnt(0)
    v_cmp_ne_u32 vcc, s3, v235
    s_cbranch_vccz L_bk_130
    s_sub_u32 s94, s94, 1
    s_cmp_lg_u32 s94, 0
    s_cbranch_scc1 L_sr_131
    s_mov_b32 s94, 1
    s_branch L_bk_130
L_sw_132:
L_sr_134:
    ds_read_b32 v235, v233 offset:104
    s_waitcnt lgkmcnt(0)
    v_cmp_ne_u32 vcc, s3, v235
    s_cbranch_vccz L_bk_133
    s_sub_u32 s94, s94, 1
    s_cmp_lg_u32 s94, 0
    s_cbranch_scc1 L_sr_134
    s_mov_b32 s94, 1
    s_branch L_bk_133
L_sw_135:
L_sr_137:
    ds_read_b32 v235, v233 offset:108
    s_waitcnt lgkmcnt(0)
    v_cmp_ne_u32 vcc, s3, v235
    s_cbranch_vccz L_bk_136
    s_sub_u32 s94, s94, 1
    s_cmp_lg_u32 s94, 0
    s_cbranch_scc1 L_sr_137
    s_mov_b32 s94, 1
    s_branch L_bk_136
L_sw_138:
L_sr_140:
    ds_read_b32 v235, v233 offset:112
    s_waitcnt lgkmcnt(0)
    v_cmp_ne_u32 vcc, s3, v235
    s_cbranch_vccz L_bk_139
    s_sub_u32 s94, s94, 1
    s_cmp_lg_u32 s94, 0
    s_cbranch_scc1 L_sr_140
    s_mov_b32 s94, 1
    s_branch L_bk_139
L_sw_141:
L_sr_143:
    ds_read_b32 v235, v233 offset:116
    s_waitcnt lgkmcnt(0)
    v_cmp_ne_u32 vcc, s3, v235
    s_cbranch_vccz L_bk_142
    s_sub_u32 s94, s94, 1
    s_cmp_lg_u32 s94, 0
    s_cbranch_scc1 L_sr_143
    s_mov_b32 s94, 1
    s_branch L_bk_142
L_sw_144:
L_sr_146:
    ds_read_b32 v235, v233 offset:120
    s_waitcnt lgkmcnt(0)
    v_cmp_ne_u32 vcc, s3, v235
    s_cbranch_vccz L_bk_145
    s_sub_u32 s94, s94, 1
    s_cmp_lg_u32 s94, 0
    s_cbranch_scc1 L_sr_146
    s_mov_b32 s94, 1
    s_branch L_bk_145
L_sw_147:
L_sr_149:
    ds_read_b32 v235, v233 offset:124
    s_waitcnt lgkmcnt(0)
    v_cmp_ne_u32 vcc, s3, v235
    s_cbranch_vccz L_bk_148
    s_sub_u32 s94, s94, 1
    s_cmp_lg_u32 s94, 0
    s_cbranch_scc1 L_sr_149
    s_mov_b32 s94, 1
    s_branch L_bk_148
L_sw_150:
L_sr_152:
    ds_read_b32 v235, v233 offset:128
    s_waitcnt lgkmcnt(0)
    v_cmp_ne_u32 vcc, s3, v235
    s_cbranch_vccz L_bk_151
    s_sub_u32 s94, s94, 1
    s_cmp_lg_u32 s94, 0
    s_cbranch_scc1 L_sr_152
    s_mov_b32 s94, 1
    s_branch L_bk_151
L_sw_153:
L_sr_155:
    ds_read_b32 v235, v233 offset:132
    s_waitcnt lgkmcnt(0)
    v_cmp_ne_u32 vcc, s3, v235
    s_cbranch_vccz L_bk_154
    s_sub_u32 s94, s94, 1
    s_cmp_lg_u32 s94, 0
    s_cbranch_scc1 L_sr_155
    s_mov_b32 s94, 1
    s_branch L_bk_154
L_sw_156:
L_sr_158:
    ds_read_b32 v235, v233 offset:136
    s_waitcnt lgkmcnt(0)
    v_cmp_ne_u32 vcc, s3, v235
    s_cbranch_vccz L_bk_157
    s_sub_u32 s94, s94, 1
    s_cmp_lg_u32 s94, 0
    s_cbranch_scc1 L_sr_158
    s_mov_b32 s94, 1
    s_branch L_bk_157
L_sw_159:
L_sr_161:
    ds_read_b32 v235, v233 offset:140
    s_waitcnt lgkmcnt(0)
    v_cmp_ne_u32 vcc, s3, v235
    s_cbranch_vccz L_bk_160
    s_sub_u32 s94, s94, 1
    s_cmp_lg_u32 s94, 0
    s_cbranch_scc1 L_sr_161
    s_mov_b32 s94, 1
    s_branch L_bk_160
L_late_124:
    s_waitcnt vmcnt(8)
    v_mfma_f32_16x16x32_bf16 v[0:3], v[48:51], v[136:139], v[0:3]
    ds_write_b32 v253, v234 offset:116
    v_mfma_f32_16x16x32_bf16 v[4:7], v[48:51], v[140:143], v[4:7]
    v_add_u32 v212, 0, v204
    v_add_u32 v213, 0, v205
    v_add_u32 v214, 0, v206
    v_add_u32 v215, 0, v207
    v_cmp_ne_u32 vcc, s3, v235
    s_cbranch_vccnz L_sw_147
L_bk_148:
    v_mfma_f32_16x16x32_bf16 v[8:11], v[52:55], v[136:139], v[8:11]
    ds_read_b32 v235, v233 offset:128
    v_mfma_f32_16x16x32_bf16 v[12:15], v[52:55], v[140:143], v[12:15]
    ds_read_b64_tr_b16 v[32:33], v212
    ds_read_b64_tr_b16 v[34:35], v212 offset:2048
    ds_read_b64_tr_b16 v[36:37], v213
    ds_read_b64_tr_b16 v[38:39], v213 offset:2048
    v_mfma_f32_16x16x32_bf16 v[16:19], v[56:59], v[136:139], v[16:19]
    ds_read_b64_tr_b16 v[40:41], v214
    ds_read_b64_tr_b16 v[42:43], v214 offset:2048
    ds_read_b64_tr_b16 v[44:45], v215
    ds_read_b64_tr_b16 v[46:47], v215 offset:2048
    v_mfma_f32_16x16x32_bf16 v[20:23], v[56:59], v[140:143], v[20:23]
    v_mfma_f32_16x16x32_bf16 v[24:27], v[60:63], v[136:139], v[24:27]
    v_mfma_f32_16x16x32_bf16 v[28:31], v[60:63], v[140:143], v[28:31]
    s_waitcnt vmcnt(6)
    v_mfma_f32_16x16x32_bf16 v[0:3], v[64:67], v[144:147], v[0:3]
    ds_write_b32 v253, v234 offset:120
    v_mfma_f32_16x16x32_bf16 v[4:7], v[64:67], v[148:151], v[4:7]
    v_add_u32 v212, 16384, v204
    v_add_u32 v213, 16384, v205
    v_add_u32 v214, 16384, v206
    v_add_u32 v215, 16384, v207
    s_waitcnt lgkmcnt(9)
    v_cmp_ne_u32 vcc, s3, v235
    s_cbranch_vccnz L_sw_150
L_bk_151:
    v_mfma_f32_16x16x32_bf16 v[8:11], v[68:71], v[144:147], v[8:11]
    ds_read_b32 v235, v233 offset:132
    v_mfma_f32_16x16x32_bf16 v[12:15], v[68:71], v[148:151], v[12:15]
    ds_read_b64_tr_b16 v[48:49], v212
    ds_read_b64_tr_b16 v[50:51], v212 offset:2048
    ds_read_b64_tr_b16 v[52:53], v213
    ds_read_b64_tr_b16 v[54:55], v213 offset:2048
    v_mfma_f32_16x16x32_bf16 v[16:19], v[72:75], v[144:147], v[16:19]
    ds_read_b64_tr_b16 v[56:57], v214
    ds_read_b64_tr_b16 v[58:59], v214 offset:2048
    ds_read_b64_tr_b16 v[60:61], v215
    ds_read_b64_tr_b16 v[62:63], v215 offset:2048
    v_mfma_f32_16x16x32_bf16 v[20:23], v[72:75], v[148:151], v[20:23]
    v_mfma_f32_16x16x32_bf16 v[24:27], v[76:79], v[144:147], v[24:27]
    v_mfma_f32_16x16x32_bf16 v[28:31], v[76:79], v[148:151], v[28:31]
    s_waitcnt lgkmcnt(10)
    s_waitcnt vmcnt(4)
    v_mfma_f32_16x16x32_bf16 v[0:3], v[32:35], v[152:155], v[0:3]
    ds_write_b32 v253, v234 offset:124
    v_mfma_f32_16x16x32_bf16 v[4:7], v[32:35], v[156:159], v[4:7]
    v_add_u32 v212, 32768, v204
    v_add_u32 v213, 32768, v205
    v_add_u32 v214, 32768, v206
    v_add_u32 v215, 32768, v207
    s_waitcnt lgkmcnt(9)
    v_cmp_ne_u32 vcc, s3, v235
    s_cbranch_vccnz L_sw_153
L_bk_154:
    v_mfma_f32_16x16x32_bf16 v[8:11], v[36:39], v[152:155], v[8:11]
    ds_read_b32 v235, v233 offset:136
    v_mfma_f32_16x16x32_bf16 v[12:15], v[36:39], v[156:159], v[12:15]
    ds_read_b64_tr_b16 v[64:65], v212
    ds_read_b64_tr_b16 v[66:67], v212 offset:2048
    ds_read_b64_tr_b16 v[68:69], v213
    ds_read_b64_tr_b16 v[70:71], v213 offset:2048
    v_mfma_f32_16x16x32_bf16 v[16:19], v[40:43], v[152:155], v[16:19]
    ds_read_b64_tr_b16 v[72:73], v214
    ds_read_b64_tr_b16 v[74:75], v214 offset:2048
    ds_read_b64_tr_b16 v[76:77], v215
    ds_read_b64_tr_b16 v[78:79], v215 offset:2048
    v_mfma_f32_16x16x32_bf16 v[20:23], v[40:43], v[156:159], v[20:23]
    v_mfma_f32_16x16x32_bf16 v[24:27], v[44:47], v[152:155], v[24:27]
    v_mfma_f32_16x16x32_bf16 v[28:31], v[44:47], v[156:159], v[28:31]
    s_waitcnt lgkmcnt(10)
    s_waitcnt vmcnt(2)
    v_mfma_f32_16x16x32_bf16 v[0:3], v[48:51], v[160:163], v[0:3]
    ds_write_b32 v253, v234 offset:128
    v_mfma_f32_16x16x32_bf16 v[4:7], v[48:51], v[164:167], v[4:7]
    v_add_u32 v212, 49152, v208
    v_add_u32 v213, 49152, v209
    v_add_u32 v214, 49152, v210
    v_add_u32 v215, 49152, v211
    s_waitcnt lgkmcnt(9)
    v_cmp_ne_u32 vcc, s3, v235
    s_cbranch_vccnz L_sw_156
L_bk_157:
    v_mfma_f32_16x16x32_bf16 v[8:11], v[52:55], v[160:163], v[8:11]
    ds_read_b32 v235, v233 offset:140
    v_mfma_f32_16x16x32_bf16 v[12:15], v[52:55], v[164:167], v[12:15]
    ds_read_b128 v[32:35], v212
    ds_read_b128 v[36:39], v213
    v_mfma_f32_16x16x32_bf16 v[16:19], v[56:59], v[160:163], v[16:19]
    ds_read_b128 v[40:43], v214
    ds_read_b128 v[44:47], v215
    v_mfma_f32_16x16x32_bf16 v[20:23], v[56:59], v[164:167], v[20:23]
    v_mfma_f32_16x16x32_bf16 v[24:27], v[60:63], v[160:163], v[24:27]
    v_mfma_f32_16x16x32_bf16 v[28:31], v[60:63], v[164:167], v[28:31]
    s_waitcnt lgkmcnt(6)
    s_waitcnt vmcnt(0)
    v_mfma_f32_16x16x32_bf16 v[0:3], v[64:67], v[168:171], v[0:3]
    ds_write_b32 v253, v234 offset:132
    v_mfma_f32_16x16x32_bf16 v[4:7], v[64:67], v[172:175], v[4:7]
    v_add_u32 v212, 65536, v208
    v_add_u32 v213, 65536, v209
    v_add_u32 v214, 65536, v210
    v_add_u32 v215, 65536, v211
    s_waitcnt lgkmcnt(5)
    v_cmp_ne_u32 vcc, s3, v235
    s_cbranch_vccnz L_sw_159
L_bk_160:
    v_mfma_f32_16x16x32_bf16 v[8:11], v[68:71], v[168:171], v[8:11]
    ds_read_b32 v235, v233 offset:144
    v_mfma_f32_16x16x32_bf16 v[12:15], v[68:71], v[172:175], v[12:15]
    ds_read_b128 v[48:51], v212
    ds_read_b128 v[52:55], v213
    v_mfma_f32_16x16x32_bf16 v[16:19], v[72:75], v[168:171], v[16:19]
    ds_read_b128 v[56:59], v214
    ds_read_b128 v[60:63], v215
    v_mfma_f32_16x16x32_bf16 v[20:23], v[72:75], v[172:175], v[20:23]
    v_mfma_f32_16x16x32_bf16 v[24:27], v[76:79], v[168:171], v[24:27]
    v_mfma_f32_16x16x32_bf16 v[28:31], v[76:79], v[172:175], v[28:31]
L_fs_162:
    ds_read_b32 v236, v232
    s_waitcnt lgkmcnt(0)
    v_cmp_le_u32 vcc, 3, v236
    s_cbranch_vccnz L_fs_163
    s_sleep 1
    s_sub_u32 s94, s94, 1
    s_cmp_lg_u32 s94, 0
    s_cbranch_scc1 L_fs_162
    s_mov_b32 s94, 1
L_fs_163:
    buffer_load_dwordx4 v[128:131], v216, s[56:59], s100 offen sc1
    buffer_load_dwordx4 v[132:135], v217, s[56:59], s100 offen sc1
    s_add_u32 s100, s100, 16384
    s_cmp_eq_u32 s100, 360448
    s_cselect_b32 s100, 196608, s100
    buffer_load_dwordx4 v[136:139], v216, s[56:59], s100 offen sc1
    buffer_load_dwordx4 v[140:143], v217, s[56:59], s100 offen sc1
    s_add_u32 s100, s100, 16384
    s_cmp_eq_u32 s100, 360448
    s_cselect_b32 s100, 196608, s100
    buffer_load_dwordx4 v[144:147], v216, s[56:59], s100 offen sc1
    buffer_load_dwordx4 v[148:151], v217, s[56:59], s100 offen sc1
    s_add_u32 s100, s100, 16384
    s_cmp_eq_u32 s100, 360448
    s_cselect_b32 s100, 196608, s100
    buffer_load_dwordx4 v[152:155], v216, s[56:59], s100 offen sc1
    buffer_load_dwordx4 v[156:159], v217, s[56:59], s100 offen sc1
    s_add_u32 s100, s100, 16384
    s_cmp_eq_u32 s100, 360448
    s_cselect_b32 s100, 196608, s100
    buffer_load_dwordx4 v[160:163], v216, s[56:59], s100 offen sc1
    buffer_load_dwordx4 v[164:167], v217, s[56:59], s100 offen sc1
    s_add_u32 s100, s100, 16384
    s_cmp_eq_u32 s100, 360448
    s_cselect_b32 s100, 196608, s100
    s_branch L_join_125
L_sw_164:
L_sr_166:
    ds_read_b32 v235, v233 offset:124
    s_waitcnt lgkmcnt(0)
    v_cmp_ne_u32 vcc, s3, v235
    s_cbranch_vccz L_bk_165
    s_sub_u32 s94, s94, 1
    s_cmp_lg_u32 s94, 0
    s_cbranch_scc1 L_sr_166
    s_mov_b32 s94, 1
    s_branch L_bk_165
L_sw_167:
L_sr_169:
    ds_read_b32 v235, v233 offset:128
    s_waitcnt lgkmcnt(0)
    v_cmp_ne_u32 vcc, s3, v235
    s_cbranch_vccz L_bk_168
    s_sub_u32 s94, s94, 1
    s_cmp_lg_u32 s94, 0
    s_cbranch_scc1 L_sr_169
    s_mov_b32 s94, 1
    s_branch L_bk_168
L_sw_170:
L_sr_172:
    ds_read_b32 v235, v233 offset:132
    s_waitcnt lgkmcnt(0)
    v_cmp_ne_u32 vcc, s3, v235
    s_cbranch_vccz L_bk_171
    s_sub_u32 s94, s94, 1
    s_cmp_lg_u32 s94, 0
    s_cbranch_scc1 L_sr_172
    s_mov_b32 s94, 1
    s_branch L_bk_171
L_sw_173:
L_sr_175:
    ds_read_b32 v235, v233 offset:136
    s_waitcnt lgkmcnt(0)
    v_cmp_ne_u32 vcc, s3, v235
    s_cbranch_vccz L_bk_174
    s_sub_u32 s94, s94, 1
    s_cmp_lg_u32 s94, 0
    s_cbranch_scc1 L_sr_175
    s_mov_b32 s94, 1
    s_branch L_bk_174
L_sw_176:
L_sr_178:
    ds_read_b32 v235, v233 offset:140
    s_waitcnt lgkmcnt(0)
    v_cmp_ne_u32 vcc, s3, v235
    s_cbranch_vccz L_bk_177
    s_sub_u32 s94, s94, 1
    s_cmp_lg_u32 s94, 0
    s_cbranch_scc1 L_sr_178
    s_mov_b32 s94, 1
    s_branch L_bk_177
L_sw_179:
L_sr_181:
    ds_read_b32 v235, v233 offset:144
    s_waitcnt lgkmcnt(0)
    v_cmp_ne_u32 vcc, s3, v235
    s_cbranch_vccz L_bk_180
    s_sub_u32 s94, s94, 1
    s_cmp_lg_u32 s94, 0
    s_cbranch_scc1 L_sr_181
    s_mov_b32 s94, 1
    s_branch L_bk_180
L_sw_182:
L_sr_184:
    ds_read_b32 v235, v233 offset:148
    s_waitcnt lgkmcnt(0)
    v_cmp_ne_u32 vcc, s3, v235
    s_cbranch_vccz L_bk_183
    s_sub_u32 s94, s94, 1
    s_cmp_lg_u32 s94, 0
    s_cbranch_scc1 L_sr_184
    s_mov_b32 s94, 1
    s_branch L_bk_183
L_sw_185:
L_sr_187:
    ds_read_b32 v235, v233 offset:152
    s_waitcnt lgkmcnt(0)
    v_cmp_ne_u32 vcc, s3, v235
    s_cbranch_vccz L_bk_186
    s_sub_u32 s94, s94, 1
    s_cmp_lg_u32 s94, 0
    s_cbranch_scc1 L_sr_187
    s_mov_b32 s94, 1
    s_branch L_bk_186
L_sw_188:
L_sr_190:
    ds_read_b32 v235, v233 offset:156
    s_waitcnt lgkmcnt(0)
    v_cmp_ne_u32 vcc, s3, v235
    s_cbranch_vccz L_bk_189
    s_sub_u32 s94, s94, 1
    s_cmp_lg_u32 s94, 0
    s_cbranch_scc1 L_sr_190
    s_mov_b32 s94, 1
    s_branch L_bk_189
L_sw_191:
L_sr_193:
    ds_read_b32 v235, v233 offset:160
    s_waitcnt lgkmcnt(0)
    v_cmp_ne_u32 vcc, s3, v235
    s_cbranch_vccz L_bk_192
    s_sub_u32 s94, s94, 1
    s_cmp_lg_u32 s94, 0
    s_cbranch_scc1 L_sr_193
    s_mov_b32 s94, 1
    s_branch L_bk_192
L_sw_194:
L_sr_196:
    ds_read_b32 v235, v233 offset:164
    s_waitcnt lgkmcnt(0)
    v_cmp_ne_u32 vcc, s3, v235
    s_cbranch_vccz L_bk_195
    s_sub_u32 s94, s94, 1
    s_cmp_lg_u32 s94, 0
    s_cbranch_scc1 L_sr_196
    s_mov_b32 s94, 1
    s_branch L_bk_195
L_sw_197:
L_sr_199:
    ds_read_b32 v235, v233 offset:168
    s_waitcnt lgkmcnt(0)
    v_cmp_ne_u32 vcc, s3, v235
    s_cbranch_vccz L_bk_198
    s_sub_u32 s94, s94, 1
    s_cmp_lg_u32 s94, 0
    s_cbranch_scc1 L_sr_199
    s_mov_b32 s94, 1
    s_branch L_bk_198
L_sw_200:
L_sr_202:
    ds_read_b32 v235, v233 offset:172
    s_waitcnt lgkmcnt(0)
    v_cmp_ne_u32 vcc, s3, v235
    s_cbranch_vccz L_bk_201
    s_sub_u32 s94, s94, 1
    s_cmp_lg_u32 s94, 0
    s_cbranch_scc1 L_sr_202
    s_mov_b32 s94, 1
    s_branch L_bk_201
L_sw_203:
L_sr_205:
    ds_read_b32 v235, v233 offset:2192
    s_waitcnt lgkmcnt(0)
    v_cmp_ne_u32 vcc, s3, v235
    s_cbranch_vccz L_bk_204
    s_sub_u32 s94, s94, 1
    s_cmp_lg_u32 s94, 0
    s_cbranch_scc1 L_sr_205
    s_mov_b32 s94, 1
    s_branch L_bk_204
L_mlp_loader:
    s_waitcnt lgkmcnt(0)
    s_add_u32 s66, s66, 1
    s_swappc_b64 s[90:91], s[30:31]
    s_swappc_b64 s[90:91], s[30:31]
    s_setprio 3
    s_lshr_b32 s76, s85, 1
    s_and_b32 s70, s61, 3
    s_lshl_b32 s71, s64, 2
    s_add_u32 s71, s71, s70
    s_bitcmp1_b32 s61, 2
    s_cselect_b32 s70, 48, 0
    s_add_u32 s71, s71, s70
    s_and_b32 s72, s60, 1
    s_lshl_b32 s72, s72, 1
    s_sub_u32 s75, s76, 0
    s_add_u32 s72, s72, s75
    s_mul_i32 s75, s75, 10240
    s_add_u32 s75, s75, 131072
    s_and_b32 s76, s85, 1
    s_cmp_ge_u32 s71, 48
    s_cselect_b32 s56, s26, s24
    s_cselect_b32 s57, s27, s25
    s_mov_b32 s58, 1966080
    s_mov_b32 s59, 0x20000
    s_cselect_b32 s73, 3072, 0
    s_lshl_b32 s74, s71, 6
    s_sub_u32 s74, s74, s73
    s_mul_i32 s73, s72, 491520
    s_add_u32 s74, s74, s73
    v_lshrrev_b32 v232, 2, v254
    v_and_b32 v233, 3, v254
    v_mul_u32_u24 v232, 3072, v232
    v_lshl_add_u32 v232, v233, 4, v232
    s_mul_i32 s73, s76, 245760
    s_add_u32 s74, s74, s73
    s_mul_i32 s73, s76, 5120
    s_add_u32 s75, s75, s73
    s_add_u32 m0, s75, 0
    s_add_u32 s77, s74, 0
    s_waitcnt vmcnt(9)
    buffer_load_dwordx4 v232, s[56:59], s77 offen lds
    s_add_u32 m0, s75, 1024
    s_add_u32 s77, s74, 49152
    s_waitcnt vmcnt(9)
    buffer_load_dwordx4 v232, s[56:59], s77 offen lds
    s_add_u32 m0, s75, 2048
    s_add_u32 s77, s74, 98304
    s_waitcnt vmcnt(9)
    buffer_load_dwordx4 v232, s[56:59], s77 offen lds
    s_add_u32 m0, s75, 3072
    s_add_u32 s77, s74, 147456
    s_waitcnt vmcnt(9)
    buffer_load_dwordx4 v232, s[56:59], s77 offen lds
    s_add_u32 m0, s75, 4096
    s_add_u32 s77, s74, 196608
    s_waitcnt vmcnt(9)
    buffer_load_dwordx4 v232, s[56:59], s77 offen lds
    s_setprio 0
    s_swappc_b64 s[90:91], s[30:31]
    s_getpc_b64 s[30:31]
L_gq_mlp:
    s_add_u32 s30, s30, L_sub_mlp2-L_gq_mlp
    s_addc_u32 s31, s31, 0
    s_swappc_b64 s[90:91], s[30:31]
    s_setprio 3
    s_mul_i32 s70, s85, 12288
    s_lshl_b32 s71, s64, 10
    s_add_u32 s70, s70, s71
    s_add_u32 s70, s70, 65536
    s_lshl_b32 s71, s62, 10
    s_add_u32 s71, s71, 16384
    s_lshl_b32 s72, s23, 7
    s_add_u32 s72, s72, 16384
    s_cmp_eq_u32 s85, 2
    s_cselect_b32 s71, s72, s71
    s_cmp_ge_u32 s85, 2
    s_cselect_b32 s70, s71, s70
    s_cselect_b32 s71, 0, 24576
    v_lshlrev_b32 v18, 4, v254
    v_add_u32 v18, s70, v18
    v_add_u32 v19, s71, v18
    v_add_u32 v20, s71, v19
    v_add_u32 v21, s71, v20
    s_setprio 0
    s_swappc_b64 s[90:91], s[30:31]
    s_swappc_b64 s[90:91], s[30:31]
    s_setprio 3
    s_mov_b32 s48, s28
    s_mov_b32 s49, s29
    s_mov_b32 s50, 1966080
    s_mov_b32 s51, 0x20000
    s_mov_b32 s52, s14
    s_mov_b32 s53, s15
    s_mov_b32 s54, 819200
    s_mov_b32 s55, 0x20000
    s_mov_b32 s56, s16
    s_mov_b32 s57, s17
    s_mov_b32 s58, 819200
    s_mov_b32 s59, 0x20000
    s_lshl_b32 s70, s68, 1
    v_lshrrev_b32 v232, 4, v254
    v_lshlrev_b32 v232, 1, v232
    v_xor_b32 v232, v232, v254
    v_and_b32 v232, 7, v232
    v_lshrrev_b32 v233, 3, v254
    v_mul_u32_u24 v233, 1280, v233
    v_lshl_add_u32 v232, v232, 4, v233
    v_add_u32 v12, s70, v232
    v_lshrrev_b32 v232, 4, v254
    v_xor_b32 v233, v232, v254
    v_and_b32 v233, 7, v233
    v_lshrrev_b32 v232, 3, v254
    v_mul_u32_u24 v15, 1280, v232
    v_lshl_add_u32 v15, v233, 4, v15
    v_xor_b32 v16, 64, v15
    v_add_u32 v16, 9216, v16
    s_mul_i32 s70, s68, 1280
    v_add_u32 v15, s70, v15
    v_add_u32 v16, s70, v16
    s_add_u32 s87, s85, 1
    s_and_b32 s87, s87, 3
    s_add_u32 s101, s87, s98
    s_cmp_ge_u32 s101, 12
    s_cselect_b32 s70, 12, 0
    s_sub_u32 s101, s101, s70
    s_mul_i32 s101, s101, 163840
    v_lshlrev_b32 v236, 4, v254
    s_lshl_b32 s70, s67, 12
    s_add_u32 s70, s70, 12585984
    v_and_b32 v243, 7, v254
    v_lshlrev_b32 v243, 7, v243
    v_add_u32 v243, s70, v243
    v_and_b32 v244, 8, v254
    v_lshl_add_u32 v243, v244, 9, v243
    s_setprio 0
    s_swappc_b64 s[90:91], s[30:31]
    s_swappc_b64 s[90:91], s[30:31]
    s_swappc_b64 s[90:91], s[30:31]
    s_swappc_b64 s[90:91], s[30:31]
    s_swappc_b64 s[90:91], s[30:31]
    s_swappc_b64 s[90:91], s[30:31]
    s_waitcnt vmcnt(9)
    global_load_dwordx4 v[22:25], v18, s[34:35] sc1
    s_waitcnt vmcnt(9)
    global_load_dwordx4 v[26:29], v19, s[34:35] sc1
    s_waitcnt vmcnt(9)
    global_load_dwordx4 v[30:33], v20, s[34:35] sc1
    s_waitcnt vmcnt(9)
    global_load_dwordx4 v[34:37], v21, s[34:35] sc1
    s_swappc_b64 s[90:91], s[30:31]
    s_swappc_b64 s[90:91], s[30:31]
    s_setprio 3
L_gr_210:
    s_mov_b64 s[88:89], 0
    v_cmp_ne_u32 vcc, s66, v23
    s_nop 1
    s_or_b64 s[88:89], s[88:89], vcc
    v_cmp_ne_u32 vcc, s66, v25
    s_nop 1
    s_or_b64 s[88:89], s[88:89], vcc
    v_cmp_ne_u32 vcc, s66, v27
    s_nop 1
    s_or_b64 s[88:89], s[88:89], vcc
    v_cmp_ne_u32 vcc, s66, v29
    s_nop 1
    s_or_b64 s[88:89], s[88:89], vcc
    v_cmp_ne_u32 vcc, s66, v31
    s_nop 1
    s_or_b64 s[88:89], s[88:89], vcc
    v_cmp_ne_u32 vcc, s66, v33
    s_nop 1
    s_or_b64 s[88:89], s[88:89], vcc
    v_cmp_ne_u32 vcc, s66, v35
    s_nop 1
    s_or_b64 s[88:89], s[88:89], vcc
    v_cmp_ne_u32 vcc, s66, v37
    s_nop 1
    s_or_b64 s[88:89], s[88:89], vcc
    s_cmp_eq_u64 s[88:89], 0
    s_cbranch_scc1 L_gr_211
    s_waitcnt vmcnt(9)
    global_load_dwordx4 v[22:25], v18, s[34:35] sc1
    s_waitcnt vmcnt(9)
    global_load_dwordx4 v[26:29], v19, s[34:35] sc1
    s_waitcnt vmcnt(9)
    global_load_dwordx4 v[30:33], v20, s[34:35] sc1
    s_waitcnt vmcnt(9)
    global_load_dwordx4 v[34:37], v21, s[34:35] sc1
    s_waitcnt vmcnt(0)
    s_sleep 1
    s_sub_u32 s94, s94, 1
    s_cmp_lg_u32 s94, 0
    s_cbranch_scc1 L_gr_210
    s_mov_b32 s94, 1
L_gr_211:
    s_cmp_eq_u32 s85, 3
    s_cbranch_scc1 L_gr_213
    s_cmp_lg_u32 s85, 2
    s_cbranch_scc1 L_gr_213c
    v_lshlrev_b32 v23, 3, v254
    v_add_u32 v23, 144384, v23
    ds_write2_b32 v23, v22, v24 offset0:0 offset1:1
    s_branch L_gr_212
L_gr_213c:
    v_add_f32 v22, v22, v26
    v_add_f32 v24, v24, v28
    v_add_f32 v30, v30, v34
    v_add_f32 v32, v32, v36
    v_add_f32 v22, v22, v30
    v_add_f32 v23, v24, v32
    s_lshl_b32 s70, s85, 9
    s_add_u32 s70, s70, 153600
    v_lshlrev_b32 v24, 3, v254
    v_add_u32 v24, s70, v24
    ds_write_b64 v24, v[22:23]
    s_branch L_gr_212
L_gr_213:
    v_and_b32 v28, 0xffff0000, v22
    v_lshlrev_b32 v26, 16, v22
    v_rcp_f32 v27, v28
    v_mul_f32 v28, v28, v28
    v_mul_f32 v27, 3216550459, v27
    v_and_b32 v32, 0xffff0000, v24
    v_lshlrev_b32 v30, 16, v24
    v_rcp_f32 v31, v32
    v_mul_f32 v32, v32, v32
    v_mul_f32 v31, 3216550459, v31
    v_lshlrev_b32 v24, 5, v254
    v_add_u32 v24, 151552, v24
    ds_write_b128 v24, v[26:29]
    ds_write_b128 v24, v[30:33] offset:16
L_gr_212:
    s_waitcnt lgkmcnt(0)
    s_lshl_b32 s70, s23, 4
    s_mul_i32 s71, s85, 24
    s_add_u32 s70, s70, s71
    s_mul_i32 s70, s70, 1280
    s_lshl_b32 s71, s68, 1
    s_add_u32 s70, s70, s71
    v_lshrrev_b32 v232, 3, v254
    v_mul_u32_u24 v232, 1280, v232
    v_and_b32 v233, 7, v254
    v_lshl_add_u32 v232, v233, 4, v232
    s_mul_i32 s72, s85, 3072
    s_add_u32 m0, s72, 131072
    s_add_u32 s77, s70, 0
    s_waitcnt vmcnt(9)
    buffer_load_dwordx4 v232, s[36:39], s77 offen lds
    s_add_u32 m0, s72, 132096
    s_add_u32 s77, s70, 10240
    s_waitcnt vmcnt(9)
    buffer_load_dwordx4 v232, s[36:39], s77 offen lds
    s_add_u32 m0, s72, 133120
    s_add_u32 s77, s70, 20480
    s_waitcnt vmcnt(9)
    buffer_load_dwordx4 v232, s[36:39], s77 offen lds
    s_mov_b32 s88, s20
    s_mov_b32 s89, s21
    s_mov_b32 s90, 1280
    s_mov_b32 s91, 0x20000
    s_mov_b32 m0, 143360
    v_lshlrev_b32 v233, 4, v254
    buffer_load_dwordx4 v233, s[88:91], s71 offen lds
    s_setprio 0
    s_swappc_b64 s[90:91], s[30:31]
    s_add_u32 s76, s87, 1
    s_lshl_b32 s76, s76, 2
    s_add_u32 s22, s22, s76
    s_mov_b32 m0, s22
    s_waitcnt vmcnt(9)
    buffer_load_dword v252, s[36:39], 0 offen lds
    s_add_u32 s77, s101, 0
    s_waitcnt vmcnt(9)
    buffer_load_dwordx4 v[40:43], v12, s[48:51], s77 offen offset:0
    s_add_u32 s77, s101, 10240
    s_waitcnt vmcnt(9)
    buffer_load_dwordx4 v[44:47], v12, s[48:51], s77 offen offset:0
    s_add_u32 s77, s101, 20480
    s_waitcnt vmcnt(9)
    buffer_load_dwordx4 v[48:51], v12, s[48:51], s77 offen offset:0
    s_add_u32 s77, s101, 30720
    s_waitcnt vmcnt(9)
    buffer_load_dwordx4 v[52:55], v12, s[48:51], s77 offen offset:0
    s_add_u32 s77, s101, 40960
    s_waitcnt vmcnt(9)
    buffer_load_dwordx4 v[56:59], v12, s[48:51], s77 offen offset:0
    s_add_u32 s77, s101, 51200
    s_waitcnt vmcnt(9)
    buffer_load_dwordx4 v[60:63], v12, s[48:51], s77 offen offset:0
    s_add_u32 s77, s101, 61440
    s_waitcnt vmcnt(9)
    buffer_load_dwordx4 v[64:67], v12, s[48:51], s77 offen offset:0
    s_add_u32 s77, s101, 71680
    s_waitcnt vmcnt(9)
    buffer_load_dwordx4 v[68:71], v12, s[48:51], s77 offen offset:0
    s_add_u32 s77, s101, 81920
    s_waitcnt vmcnt(9)
    buffer_load_dwordx4 v[72:75], v12, s[48:51], s77 offen offset:0
    s_add_u32 s77, s101, 92160
    s_waitcnt vmcnt(9)
    buffer_load_dwordx4 v[76:79], v12, s[48:51], s77 offen offset:0
    s_add_u32 s77, s101, 102400
    s_waitcnt vmcnt(9)
    buffer_load_dwordx4 v[80:83], v12, s[48:51], s77 offen offset:0
    s_add_u32 s77, s101, 112640
    s_waitcnt vmcnt(9)
    buffer_load_dwordx4 v[84:87], v12, s[48:51], s77 offen offset:0
    s_add_u32 s77, s101, 122880
    s_waitcnt vmcnt(9)
    buffer_load_dwordx4 v[88:91], v12, s[48:51], s77 offen offset:0
    s_add_u32 s77, s101, 133120
    s_waitcnt vmcnt(9)
    buffer_load_dwordx4 v[92:95], v12, s[48:51], s77 offen offset:0
    s_add_u32 s77, s101, 143360
    s_waitcnt vmcnt(9)
    buffer_load_dwordx4 v[96:99], v12, s[48:51], s77 offen offset:0
    s_add_u32 s77, s101, 153600
    s_waitcnt vmcnt(9)
    buffer_load_dwordx4 v[100:103], v12, s[48:51], s77 offen offset:0
    s_add_u32 s101, s101, 655360
    s_cmp_ge_u32 s101, 1966080
    s_cselect_b32 s70, 1966080, 0
    s_sub_u32 s101, s101, s70
    s_add_u32 s77, s101, 0
    s_waitcnt vmcnt(9)
    buffer_load_dwordx4 v[104:107], v12, s[48:51], s77 offen offset:0
    s_add_u32 s77, s101, 10240
    s_waitcnt vmcnt(9)
    buffer_load_dwordx4 v[108:111], v12, s[48:51], s77 offen offset:0
    s_add_u32 s77, s101, 20480
    s_waitcnt vmcnt(9)
    buffer_load_dwordx4 v[112:115], v12, s[48:51], s77 offen offset:0
    s_add_u32 s77, s101, 30720
    s_waitcnt vmcnt(9)
    buffer_load_dwordx4 v[116:119], v12, s[48:51], s77 offen offset:0
    s_add_u32 s77, s101, 40960
    s_waitcnt vmcnt(9)
    buffer_load_dwordx4 v[120:123], v12, s[48:51], s77 offen offset:0
    s_add_u32 s77, s101, 51200
    s_waitcnt vmcnt(9)
    buffer_load_dwordx4 v[124:127], v12, s[48:51], s77 offen offset:0
    s_add_u32 s77, s101, 61440
    s_waitcnt vmcnt(9)
    buffer_load_dwordx4 v[128:131], v12, s[48:51], s77 offen offset:0
    s_add_u32 s77, s101, 71680
    s_waitcnt vmcnt(9)
    buffer_load_dwordx4 v[132:135], v12, s[48:51], s77 offen offset:0
    s_add_u32 s77, s101, 81920
    s_waitcnt vmcnt(9)
    buffer_load_dwordx4 v[136:139], v12, s[48:51], s77 offen offset:0
    s_add_u32 s77, s101, 92160
    s_waitcnt vmcnt(9)
    buffer_load_dwordx4 v[140:143], v12, s[48:51], s77 offen offset:0
    s_add_u32 s77, s101, 102400
    s_waitcnt vmcnt(9)
    buffer_load_dwordx4 v[144:147], v12, s[48:51], s77 offen offset:0
    s_add_u32 s77, s101, 112640
    s_waitcnt vmcnt(9)
    buffer_load_dwordx4 v[148:151], v12, s[48:51], s77 offen offset:0
    s_add_u32 s77, s101, 122880
    s_waitcnt vmcnt(9)
    buffer_load_dwordx4 v[152:155], v12, s[48:51], s77 offen offset:0
    s_add_u32 s77, s101, 133120
    s_waitcnt vmcnt(9)
    buffer_load_dwordx4 v[156:159], v12, s[48:51], s77 offen offset:0
    s_add_u32 s77, s101, 143360
    s_waitcnt vmcnt(9)
    buffer_load_dwordx4 v[160:163], v12, s[48:51], s77 offen offset:0
    s_add_u32 s77, s101, 153600
    s_waitcnt vmcnt(9)
    buffer_load_dwordx4 v[164:167], v12, s[48:51], s77 offen offset:0
    s_add_u32 s101, s101, 655360
    s_cmp_ge_u32 s101, 1966080
    s_cselect_b32 s70, 1966080, 0
    s_sub_u32 s101, s101, s70
    s_lshl_b32 s80, s87, 14
    s_add_u32 s76, s87, 13
    s_max_u32 s76, s76, 20
    s_lshl_b32 s76, s76, 2
    v_add_u32 v246, s76, v240
    ds_read_b32 v242, v246 offset:0
    s_waitcnt lgkmcnt(0)
    v_cmp_ne_u32 vcc, s3, v242
    s_cbranch_vccnz L_sw_214
L_bk_215:
    s_waitcnt vmcnt(16)
    v_add_u32 v237, s80, v236
    ds_write_b128 v237, v[40:43] offset:0
    ds_write_b128 v237, v[44:47] offset:1024
    s_add_u32 s77, s101, 0
    s_waitcnt vmcnt(9)
    buffer_load_dwordx4 v[168:171], v12, s[48:51], s77 offen offset:0
    ds_write_b128 v237, v[48:51] offset:2048
    ds_write_b128 v237, v[52:55] offset:3072
    s_add_u32 s77, s101, 10240
    s_waitcnt vmcnt(9)
    buffer_load_dwordx4 v[172:175], v12, s[48:51], s77 offen offset:0
    ds_write_b128 v237, v[56:59] offset:4096
    ds_write_b128 v237, v[60:63] offset:5120
    s_add_u32 s77, s101, 20480
    s_waitcnt vmcnt(9)
    buffer_load_dwordx4 v[176:179], v12, s[48:51], s77 offen offset:0
    ds_write_b128 v237, v[64:67] offset:6144
    ds_write_b128 v237, v[68:71] offset:7168
    s_add_u32 s77, s101, 30720
    s_waitcnt vmcnt(9)
    buffer_load_dwordx4 v[180:183], v12, s[48:51], s77 offen offset:0
    ds_write_b128 v237, v[72:75] offset:8192
    ds_write_b128 v237, v[76:79] offset:9216
    s_add_u32 s77, s101, 40960
    s_waitcnt vmcnt(9)
    buffer_load_dwordx4 v[184:187], v12, s[48:51], s77 offen offset:0
    ds_write_b128 v237, v[80:83] offset:10240
    ds_write_b128 v237, v[84:87] offset:11264
    s_add_u32 s77, s101, 51200
    s_waitcnt vmcnt(9)
    buffer_load_dwordx4 v[188:191], v12, s[48:51], s77 offen offset:0
    ds_write_b128 v237, v[88:91] offset:12288
    ds_write_b128 v237, v[92:95] offset:13312
    s_add_u32 s77, s101, 61440
    s_waitcnt vmcnt(9)
    buffer_load_dwordx4 v[192:195], v12, s[48:51], s77 offen offset:0
    ds_write_b128 v237, v[96:99] offset:14336
    ds_write_b128 v237, v[100:103] offset:15360
    s_add_u32 s77, s101, 71680
    s_waitcnt vmcnt(9)
    buffer_load_dwordx4 v[196:199], v12, s[48:51], s77 offen offset:0
    s_add_u32 s87, s87, 4
    s_add_u32 s76, s87, 21
    s_lshl_b32 s76, s76, 2
    v_add_u32 v246, s76, v253
    v_mov_b32 v241, s3
    ds_write_b32 v246, v241
    s_add_u32 s80, s80, 65536
    s_cmp_ge_u32 s80, 147456
    s_cselect_b32 s70, 147456, 0
    s_sub_u32 s80, s80, s70
    s_add_u32 s77, s101, 81920
    s_waitcnt vmcnt(9)
    buffer_load_dwordx4 v[200:203], v12, s[48:51], s77 offen offset:0
    s_add_u32 s77, s101, 92160
    s_waitcnt vmcnt(9)
    buffer_load_dwordx4 v[204:207], v12, s[48:51], s77 offen offset:0
    s_add_u32 s77, s101, 102400
    s_waitcnt vmcnt(9)
    buffer_load_dwordx4 v[208:211], v12, s[48:51], s77 offen offset:0
    s_add_u32 s77, s101, 112640
    s_waitcnt vmcnt(9)
    buffer_load_dwordx4 v[212:215], v12, s[48:51], s77 offen offset:0
    s_add_u32 s77, s101, 122880
    s_waitcnt vmcnt(9)
    buffer_load_dwordx4 v[216:219], v12, s[48:51], s77 offen offset:0
    s_add_u32 s77, s101, 133120
    s_waitcnt vmcnt(9)
    buffer_load_dwordx4 v[220:223], v12, s[48:51], s77 offen offset:0
    s_add_u32 s77, s101, 143360
    s_waitcnt vmcnt(9)
    buffer_load_dwordx4 v[224:227], v12, s[48:51], s77 offen offset:0
    s_add_u32 s77, s101, 153600
    s_waitcnt vmcnt(9)
    buffer_load_dwordx4 v[228:231], v12, s[48:51], s77 offen offset:0
    s_and_b32 s101, s87, 3
    s_add_u32 s101, s101, s99
    s_cmp_ge_u32 s101, 10
    s_cselect_b32 s70, 10, 0
    s_sub_u32 s101, s101, s70
    s_lshl_b32 s101, s101, 7
    s_waitcnt lgkmcnt(0)
    s_add_u32 s76, s87, 13
    s_max_u32 s76, s76, 20
    s_lshl_b32 s76, s76, 2
    v_add_u32 v246, s76, v240
    ds_read_b32 v242, v246 offset:0
    s_waitcnt lgkmcnt(0)
    v_cmp_ne_u32 vcc, s3, v242
    s_cbranch_vccnz L_sw_217
L_bk_218:
    s_waitcnt vmcnt(16)
    v_add_u32 v237, s80, v236
    ds_write_b128 v237, v[104:107] offset:0
    ds_write_b128 v237, v[108:111] offset:1024
    s_add_u32 s77, s101, 0
    s_waitcnt vmcnt(9)
    buffer_load_dwordx4 v[40:43], v15, s[52:55], s77 offen offset:0
    ds_write_b128 v237, v[112:115] offset:2048
    ds_write_b128 v237, v[116:119] offset:3072
    s_add_u32 s77, s101, 0
    s_waitcnt vmcnt(9)
    buffer_load_dwordx4 v[44:47], v16, s[52:55], s77 offen offset:1024
    ds_write_b128 v237, v[120:123] offset:4096
    ds_write_b128 v237, v[124:127] offset:5120
    s_add_u32 s77, s101, 20480
    s_waitcnt vmcnt(9)
    buffer_load_dwordx4 v[48:51], v15, s[52:55], s77 offen offset:0
    ds_write_b128 v237, v[128:131] offset:6144
    ds_write_b128 v237, v[132:135] offset:7168
    s_add_u32 s77, s101, 20480
    s_waitcnt vmcnt(9)
    buffer_load_dwordx4 v[52:55], v16, s[52:55], s77 offen offset:1024
    ds_write_b128 v237, v[136:139] offset:8192
    ds_write_b128 v237, v[140:143] offset:9216
    s_add_u32 s77, s101, 40960
    s_waitcnt vmcnt(9)
    buffer_load_dwordx4 v[56:59], v15, s[52:55], s77 offen offset:0
    ds_write_b128 v237, v[144:147] offset:10240
    ds_write_b128 v237, v[148:151] offset:11264
    s_add_u32 s77, s101, 40960
    s_waitcnt vmcnt(9)
    buffer_load_dwordx4 v[60:63], v16, s[52:55], s77 offen offset:1024
    ds_write_b128 v237, v[152:155] offset:12288
    ds_write_b128 v237, v[156:159] offset:13312
    s_add_u32 s77, s101, 61440
    s_waitcnt vmcnt(9)
    buffer_load_dwordx4 v[64:67], v15, s[52:55], s77 offen offset:0
    ds_write_b128 v237, v[160:163] offset:14336
    ds_write_b128 v237, v[164:167] offset:15360
    s_add_u32 s77, s101, 61440
    s_waitcnt vmcnt(9)
    buffer_load_dwordx4 v[68:71], v16, s[52:55], s77 offen offset:1024
    s_add_u32 s87, s87, 4
    s_add_u32 s76, s87, 21
    s_lshl_b32 s76, s76, 2
    v_add_u32 v246, s76, v253
    v_mov_b32 v241, s3
    ds_write_b32 v246, v241
    s_add_u32 s80, s80, 65536
    s_cmp_ge_u32 s80, 147456
    s_cselect_b32 s70, 147456, 0
    s_sub_u32 s80, s80, s70
    s_add_u32 s77, s101, 0
    s_waitcnt vmcnt(9)
    buffer_load_dwordx4 v[72:75], v15, s[56:59], s77 offen offset:0
    s_add_u32 s77, s101, 0
    s_waitcnt vmcnt(9)
    buffer_load_dwordx4 v[76:79], v16, s[56:59], s77 offen offset:1024
    s_add_u32 s77, s101, 20480
    s_waitcnt vmcnt(9)
    buffer_load_dwordx4 v[80:83], v15, s[56:59], s77 offen offset:0
    s_add_u32 s77, s101, 20480
    s_waitcnt vmcnt(9)
    buffer_load_dwordx4 v[84:87], v16, s[56:59], s77 offen offset:1024
    s_add_u32 s77, s101, 40960
    s_waitcnt vmcnt(9)
    buffer_load_dwordx4 v[88:91], v15, s[56:59], s77 offen offset:0
    s_add_u32 s77, s101, 40960
    s_waitcnt vmcnt(9)
    buffer_load_dwordx4 v[92:95], v16, s[56:59], s77 offen offset:1024
    s_add_u32 s77, s101, 61440
    s_waitcnt vmcnt(9)
    buffer_load_dwordx4 v[96:99], v15, s[56:59], s77 offen offset:0
    s_add_u32 s77, s101, 61440
    s_waitcnt vmcnt(9)
    buffer_load_dwordx4 v[100:103], v16, s[56:59], s77 offen offset:1024
    s_add_u32 s101, s101, 512
    s_cmp_ge_u32 s101, 1280
    s_cselect_b32 s70, 1280, 0
    s_sub_u32 s101, s101, s70
    s_waitcnt lgkmcnt(0)
    s_add_u32 s77, s101, 0
    s_waitcnt vmcnt(8)
    buffer_load_dwordx4 v[104:107], v15, s[52:55], s77 offen offset:0
    s_add_u32 s77, s101, 0
    s_waitcnt vmcnt(8)
    buffer_load_dwordx4 v[108:111], v16, s[52:55], s77 offen offset:1024
    s_add_u32 s77, s101, 20480
    s_waitcnt vmcnt(8)
    buffer_load_dwordx4 v[112:115], v15, s[52:55], s77 offen offset:0
    s_add_u32 s77, s101, 20480
    s_waitcnt vmcnt(8)
    buffer_load_dwordx4 v[116:119], v16, s[52:55], s77 offen offset:1024
    s_add_u32 s77, s101, 40960
    s_waitcnt vmcnt(8)
    buffer_load_dwordx4 v[120:123], v15, s[52:55], s77 offen offset:0
    s_add_u32 s77, s101, 40960
    s_waitcnt vmcnt(8)
    buffer_load_dwordx4 v[124:127], v16, s[52:55], s77 offen offset:1024
    s_add_u32 s77, s101, 61440
    s_waitcnt vmcnt(8)
    buffer_load_dwordx4 v[128:131], v15, s[52:55], s77 offen offset:0
    s_add_u32 s77, s101, 61440
    s_waitcnt vmcnt(8)
    buffer_load_dwordx4 v[132:135], v16, s[52:55], s77 offen offset:1024
    s_add_u32 s77, s101, 0
    s_waitcnt vmcnt(8)
    buffer_load_dwordx4 v[136:139], v15, s[56:59], s77 offen offset:0
    s_add_u32 s77, s101, 0
    s_waitcnt vmcnt(8)
    buffer_load_dwordx4 v[140:143], v16, s[56:59], s77 offen offset:1024
    s_add_u32 s77, s101, 20480
    s_waitcnt vmcnt(8)
    buffer_load_dwordx4 v[144:147], v15, s[56:59], s77 offen offset:0
    s_add_u32 s77, s101, 20480
    s_waitcnt vmcnt(8)
    buffer_load_dwordx4 v[148:151], v16, s[56:59], s77 offen offset:1024
    s_add_u32 s77, s101, 40960
    s_waitcnt vmcnt(8)
    buffer_load_dwordx4 v[152:155], v15, s[56:59], s77 offen offset:0
    s_add_u32 s77, s101, 40960
    s_waitcnt vmcnt(8)
    buffer_load_dwordx4 v[156:159], v16, s[56:59], s77 offen offset:1024
    s_add_u32 s77, s101, 61440
    s_waitcnt vmcnt(8)
    buffer_load_dwordx4 v[160:163], v15, s[56:59], s77 offen offset:0
    s_add_u32 s77, s101, 61440
    s_waitcnt vmcnt(8)
    buffer_load_dwordx4 v[164:167], v16, s[56:59], s77 offen offset:1024
    s_add_u32 s101, s101, 512
    s_cmp_ge_u32 s101, 1280
    s_cselect_b32 s70, 1280, 0
    s_sub_u32 s101, s101, s70
    s_add_u32 s76, s87, 13
    s_max_u32 s76, s76, 21
    s_lshl_b32 s76, s76, 2
    v_add_u32 v246, s76, v240
    ds_read_b32 v242, v246 offset:0
    s_waitcnt lgkmcnt(0)
    v_cmp_ne_u32 vcc, s3, v242
    s_cbranch_vccnz L_sw_220
L_bk_221:
    s_waitcnt vmcnt(32)
    v_add_u32 v237, s80, v236
    ds_write_b128 v237, v[168:171] offset:0
    ds_write_b128 v237, v[172:175] offset:1024
    ds_write_b128 v237, v[176:179] offset:2048
    ds_write_b128 v237, v[180:183] offset:3072
    ds_write_b128 v237, v[184:187] offset:4096
    ds_write_b128 v237, v[188:191] offset:5120
    ds_write_b128 v237, v[192:195] offset:6144
    ds_write_b128 v237, v[196:199] offset:7168
    ds_write_b128 v237, v[200:203] offset:8192
    ds_write_b128 v237, v[204:207] offset:9216
    ds_write_b128 v237, v[208:211] offset:10240
    ds_write_b128 v237, v[212:215] offset:11264
    ds_write_b128 v237, v[216:219] offset:12288
    ds_write_b128 v237, v[220:223] offset:13312
    ds_write_b128 v237, v[224:227] offset:14336
    ds_write_b128 v237, v[228:231] offset:15360
    s_add_u32 s87, s87, 4
    s_add_u32 s76, s87, 21
    s_lshl_b32 s76, s76, 2
    v_add_u32 v246, s76, v253
    v_mov_b32 v241, s3
    ds_write_b32 v246, v241
    s_add_u32 s80, s80, 65536
    s_cmp_ge_u32 s80, 147456
    s_cselect_b32 s70, 147456, 0
    s_sub_u32 s80, s80, s70
    s_waitcnt lgkmcnt(0)
    s_cmp_ge_u32 s87, 14
    s_cbranch_scc1 L_k_223
    s_add_u32 s76, s87, 13
    s_max_u32 s76, s76, 20
    s_lshl_b32 s76, s76, 2
    v_add_u32 v246, s76, v240
    ds_read_b32 v242, v246 offset:0
    s_waitcnt lgkmcnt(0)
    v_cmp_ne_u32 vcc, s3, v242
    s_cbranch_vccnz L_sw_224
L_bk_225:
    s_waitcnt vmcnt(16)
    v_add_u32 v237, s80, v236
    ds_write_b128 v237, v[40:43] offset:0
    ds_write_b128 v237, v[44:47] offset:1024
    s_add_u32 s77, s101, 0
    s_waitcnt vmcnt(8)
    buffer_load_dwordx4 v[168:171], v15, s[52:55], s77 offen offset:0
    ds_write_b128 v237, v[48:51] offset:2048
    ds_write_b128 v237, v[52:55] offset:3072
    s_add_u32 s77, s101, 0
    s_waitcnt vmcnt(8)
    buffer_load_dwordx4 v[172:175], v16, s[52:55], s77 offen offset:1024
    ds_write_b128 v237, v[56:59] offset:4096
    ds_write_b128 v237, v[60:63] offset:5120
    s_add_u32 s77, s101, 20480
    s_waitcnt vmcnt(8)
    buffer_load_dwordx4 v[176:179], v15, s[52:55], s77 offen offset:0
    ds_write_b128 v237, v[64:67] offset:6144
    ds_write_b128 v237, v[68:71] offset:7168
    s_add_u32 s77, s101, 20480
    s_waitcnt vmcnt(8)
    buffer_load_dwordx4 v[180:183], v16, s[52:55], s77 offen offset:1024
    ds_write_b128 v237, v[72:75] offset:8192
    ds_write_b128 v237, v[76:79] offset:9216
    s_add_u32 s77, s101, 40960
    s_waitcnt vmcnt(8)
    buffer_load_dwordx4 v[184:187], v15, s[52:55], s77 offen offset:0
    ds_write_b128 v237, v[80:83] offset:10240
    ds_write_b128 v237, v[84:87] offset:11264
    s_add_u32 s77, s101, 40960
    s_waitcnt vmcnt(8)
    buffer_load_dwordx4 v[188:191], v16, s[52:55], s77 offen offset:1024
    ds_write_b128 v237, v[88:91] offset:12288
    ds_write_b128 v237, v[92:95] offset:13312
    s_add_u32 s77, s101, 61440
    s_waitcnt vmcnt(8)
    buffer_load_dwordx4 v[192:195], v15, s[52:55], s77 offen offset:0
    ds_write_b128 v237, v[96:99] offset:14336
    ds_write_b128 v237, v[100:103] offset:15360
    s_add_u32 s77, s101, 61440
    s_waitcnt vmcnt(8)
    buffer_load_dwordx4 v[196:199], v16, s[52:55], s77 offen offset:1024
    s_add_u32 s87, s87, 4
    s_add_u32 s76, s87, 21
    s_lshl_b32 s76, s76, 2
    v_add_u32 v246, s76, v253
    v_mov_b32 v241, s3
    ds_write_b32 v246, v241
    s_add_u32 s80, s80, 65536
    s_cmp_ge_u32 s80, 147456
    s_cselect_b32 s70, 147456, 0
    s_sub_u32 s80, s80, s70
    s_add_u32 s77, s101, 0
    s_waitcnt vmcnt(8)
    buffer_load_dwordx4 v[200:203], v15, s[56:59], s77 offen offset:0
    s_add_u32 s77, s101, 0
    s_waitcnt vmcnt(8)
    buffer_load_dwordx4 v[204:207], v16, s[56:59], s77 offen offset:1024
    s_add_u32 s77, s101, 20480
    s_waitcnt vmcnt(8)
    buffer_load_dwordx4 v[208:211], v15, s[56:59], s77 offen offset:0
    s_add_u32 s77, s101, 20480
    s_waitcnt vmcnt(8)
    buffer_load_dwordx4 v[212:215], v16, s[56:59], s77 offen offset:1024
    s_add_u32 s77, s101, 40960
    s_waitcnt vmcnt(8)
    buffer_load_dwordx4 v[216:219], v15, s[56:59], s77 offen offset:0
    s_add_u32 s77, s101, 40960
    s_waitcnt vmcnt(8)
    buffer_load_dwordx4 v[220:223], v16, s[56:59], s77 offen offset:1024
    s_add_u32 s77, s101, 61440
    s_waitcnt vmcnt(8)
    buffer_load_dwordx4 v[224:227], v15, s[56:59], s77 offen offset:0
    s_add_u32 s77, s101, 61440
    s_waitcnt vmcnt(8)
    buffer_load_dwordx4 v[228:231], v16, s[56:59], s77 offen offset:1024
    s_add_u32 s101, s101, 512
    s_cmp_ge_u32 s101, 1280
    s_cselect_b32 s70, 1280, 0
    s_sub_u32 s101, s101, s70
    s_waitcnt lgkmcnt(0)
    s_branch L_k_223b
L_k_223:
    s_add_u32 s76, s87, 13
    s_max_u32 s76, s76, 20
    s_lshl_b32 s76, s76, 2
    v_add_u32 v246, s76, v240
    ds_read_b32 v242, v246 offset:0
    s_waitcnt lgkmcnt(0)
    v_cmp_ne_u32 vcc, s3, v242
    s_cbranch_vccnz L_sw_227
L_bk_228:
    s_waitcnt vmcnt(16)
    v_add_u32 v237, s80, v236
    ds_write_b128 v237, v[40:43] offset:0
    ds_write_b128 v237, v[44:47] offset:1024
    ds_write_b128 v237, v[48:51] offset:2048
    ds_write_b128 v237, v[52:55] offset:3072
    ds_write_b128 v237, v[56:59] offset:4096
    ds_write_b128 v237, v[60:63] offset:5120
    ds_write_b128 v237, v[64:67] offset:6144
    ds_write_b128 v237, v[68:71] offset:7168
    ds_write_b128 v237, v[72:75] offset:8192
    ds_write_b128 v237, v[76:79] offset:9216
    ds_write_b128 v237, v[80:83] offset:10240
    ds_write_b128 v237, v[84:87] offset:11264
    ds_write_b128 v237, v[88:91] offset:12288
    ds_write_b128 v237, v[92:95] offset:13312
    ds_write_b128 v237, v[96:99] offset:14336
    ds_write_b128 v237, v[100:103] offset:15360
    s_add_u32 s87, s87, 4
    s_add_u32 s76, s87, 21
    s_lshl_b32 s76, s76, 2
    v_add_u32 v246, s76, v253
    v_mov_b32 v241, s3
    ds_write_b32 v246, v241
    s_add_u32 s80, s80, 65536
    s_cmp_ge_u32 s80, 147456
    s_cselect_b32 s70, 147456, 0
    s_sub_u32 s80, s80, s70
    s_waitcnt lgkmcnt(0)
L_k_223b:
    s_cmp_lg_u32 s87, 19
    s_cbranch_scc1 L_k_223c
    s_mov_b32 s83, 0
L_pu_230:
    global_load_dword v244, v243, s[34:35] sc1
    s_waitcnt vmcnt(0)
    v_cmp_ne_u32 vcc, s66, v244
    s_cbranch_vccz L_pu_231
    s_sleep 4
    s_sleep 1
    s_sub_u32 s94, s94, 1
    s_cmp_lg_u32 s94, 0
    s_cbranch_scc1 L_pu_230
    s_mov_b32 s94, 1
L_pu_231:
    v_mov_b32 v241, 3
    ds_write_b32 v245, v241
L_k_223c:
    s_add_u32 s76, s87, 13
    s_max_u32 s76, s76, 20
    s_lshl_b32 s76, s76, 2
    v_add_u32 v246, s76, v240
    ds_read_b32 v242, v246 offset:0
    s_waitcnt lgkmcnt(0)
    v_cmp_ne_u32 vcc, s3, v242
    s_cbranch_vccnz L_sw_232
L_bk_233:
    s_waitcnt vmcnt(0)
    v_add_u32 v237, s80, v236
    ds_write_b128 v237, v[104:107] offset:0
    ds_write_b128 v237, v[108:111] offset:1024
    ds_write_b128 v237, v[112:115] offset:2048
    ds_write_b128 v237, v[116:119] offset:3072
    ds_write_b128 v237, v[120:123] offset:4096
    ds_write_b128 v237, v[124:127] offset:5120
    ds_write_b128 v237, v[128:131] offset:6144
    ds_write_b128 v237, v[132:135] offset:7168
    ds_write_b128 v237, v[136:139] offset:8192
    ds_write_b128 v237, v[140:143] offset:9216
    ds_write_b128 v237, v[144:147] offset:10240
    ds_write_b128 v237, v[148:151] offset:11264
    ds_write_b128 v237, v[152:155] offset:12288
    ds_write_b128 v237, v[156:159] offset:13312
    ds_write_b128 v237, v[160:163] offset:14336
    ds_write_b128 v237, v[164:167] offset:15360
    s_add_u32 s87, s87, 4
    s_add_u32 s76, s87, 21
    s_lshl_b32 s76, s76, 2
    v_add_u32 v246, s76, v253
    v_mov_b32 v241, s3
    ds_write_b32 v246, v241
    s_add_u32 s80, s80, 65536
    s_cmp_ge_u32 s80, 147456
    s_cselect_b32 s70, 147456, 0
    s_sub_u32 s80, s80, s70
    s_waitcnt lgkmcnt(0)
    s_cmp_ge_u32 s87, 22
    s_cbranch_scc1 L_k_223x
    s_add_u32 s76, s87, 13
    s_max_u32 s76, s76, 20
    s_lshl_b32 s76, s76, 2
    v_add_u32 v246, s76, v240
    ds_read_b32 v242, v246 offset:0
    s_waitcnt lgkmcnt(0)
    v_cmp_ne_u32 vcc, s3, v242
    s_cbranch_vccnz L_sw_235
L_bk_236:
    s_waitcnt vmcnt(0)
    v_add_u32 v237, s80, v236
    ds_write_b128 v237, v[168:171] offset:0
    ds_write_b128 v237, v[172:175] offset:1024
    ds_write_b128 v237, v[176:179] offset:2048
    ds_write_b128 v237, v[180:183] offset:3072
    ds_write_b128 v237, v[184:187] offset:4096
    ds_write_b128 v237, v[188:191] offset:5120
    ds_write_b128 v237, v[192:195] offset:6144
    ds_write_b128 v237, v[196:199] offset:7168
    ds_write_b128 v237, v[200:203] offset:8192
    ds_write_b128 v237, v[204:207] offset:9216
    ds_write_b128 v237, v[208:211] offset:10240
    ds_write_b128 v237, v[212:215] offset:11264
    ds_write_b128 v237, v[216:219] offset:12288
    ds_write_b128 v237, v[220:223] offset:13312
    ds_write_b128 v237, v[224:227] offset:14336
    ds_write_b128 v237, v[228:231] offset:15360
    s_add_u32 s87, s87, 4
    s_add_u32 s76, s87, 21
    s_lshl_b32 s76, s76, 2
    v_add_u32 v246, s76, v253
    v_mov_b32 v241, s3
    ds_write_b32 v246, v241
    s_add_u32 s80, s80, 65536
    s_cmp_ge_u32 s80, 147456
    s_cselect_b32 s70, 147456, 0
    s_sub_u32 s80, s80, s70
    s_waitcnt lgkmcnt(0)
L_k_223x:
    s_cmp_lg_u32 s2, 0
    s_cbranch_scc1 L_ep_240
    s_cmp_lg_u32 s85, 2
    s_cbranch_scc1 L_ep_240
    v_lshrrev_b32 v200, 4, v254
    v_lshlrev_b32 v200, 6, v200
    v_and_b32 v201, 15, v254
    v_lshl_add_u32 v200, v201, 1, v200
    v_lshlrev_b32 v200, 7, v200
L_ep_238:
    v_add_u32 v201, 12582912, v200
    global_load_dword v204, v201, s[34:35] sc1
    v_add_u32 v201, 32768, v201
    global_load_dword v205, v201, s[34:35] sc1
    v_add_u32 v201, 32768, v201
    global_load_dword v206, v201, s[34:35] sc1
    v_add_u32 v201, 32768, v201
    global_load_dword v207, v201, s[34:35] sc1
    v_add_u32 v201, 32768, v201
    s_waitcnt vmcnt(0)
    s_mov_b64 s[88:89], 0
    v_cmp_ne_u32 vcc, s66, v204
    s_nop 1
    s_or_b64 s[88:89], s[88:89], vcc
    v_cmp_ne_u32 vcc, s66, v205
    s_nop 1
    s_or_b64 s[88:89], s[88:89], vcc
    v_cmp_ne_u32 vcc, s66, v206
    s_nop 1
    s_or_b64 s[88:89], s[88:89], vcc
    v_cmp_ne_u32 vcc, s66, v207
    s_nop 1
    s_or_b64 s[88:89], s[88:89], vcc
    s_cmp_eq_u64 s[88:89], 0
    s_cbranch_scc1 L_ep_239
    s_sleep 1
    s_sub_u32 s94, s94, 1
    s_cmp_lg_u32 s94, 0
    s_cbranch_scc1 L_ep_238
    s_mov_b32 s94, 1
L_ep_239:
    v_mov_b32 v200, 0
    v_mov_b32 v201, s66
    s_mov_b64 exec, 1
    global_store_dword v200, v201, s[34:35] sc1
    s_mov_b64 exec, -1
L_ep_240:
    s_endpgm
L_sw_214:
L_sr_216:
    ds_read_b32 v242, v246 offset:0
    s_waitcnt lgkmcnt(0)
    v_cmp_ne_u32 vcc, s3, v242
    s_cbranch_vccz L_bk_215
    s_sub_u32 s94, s94, 1
    s_cmp_lg_u32 s94, 0
    s_cbranch_scc1 L_sr_216
    s_mov_b32 s94, 1
    s_branch L_bk_215
L_sw_217:
L_sr_219:
    ds_read_b32 v242, v246 offset:0
    s_waitcnt lgkmcnt(0)
    v_cmp_ne_u32 vcc, s3, v242
    s_cbranch_vccz L_bk_218
    s_sub_u32 s94, s94, 1
    s_cmp_lg_u32 s94, 0
    s_cbranch_scc1 L_sr_219
    s_mov_b32 s94, 1
    s_branch L_bk_218
L_sw_220:
L_sr_222:
    ds_read_b32 v242, v246 offset:0
    s_waitcnt lgkmcnt(0)
    v_cmp_ne_u32 vcc, s3, v242
    s_cbranch_vccz L_bk_221
    s_sub_u32 s94, s94, 1
    s_cmp_lg_u32 s94, 0
    s_cbranch_scc1 L_sr_222
    s_mov_b32 s94, 1
    s_branch L_bk_221
L_sw_224:
L_sr_226:
    ds_read_b32 v242, v246 offset:0
    s_waitcnt lgkmcnt(0)
    v_cmp_ne_u32 vcc, s3, v242
    s_cbranch_vccz L_bk_225
    s_sub_u32 s94, s94, 1
    s_cmp_lg_u32 s94, 0
    s_cbranch_scc1 L_sr_226
    s_mov_b32 s94, 1
    s_branch L_bk_225
L_sw_227:
L_sr_229:
    ds_read_b32 v242, v246 offset:0
    s_waitcnt lgkmcnt(0)
    v_cmp_ne_u32 vcc, s3, v242
    s_cbranch_vccz L_bk_228
    s_sub_u32 s94, s94, 1
    s_cmp_lg_u32 s94, 0
    s_cbranch_scc1 L_sr_229
    s_mov_b32 s94, 1
    s_branch L_bk_228
L_sw_232:
L_sr_234:
    ds_read_b32 v242, v246 offset:0
    s_waitcnt lgkmcnt(0)
    v_cmp_ne_u32 vcc, s3, v242
    s_cbranch_vccz L_bk_233
    s_sub_u32 s94, s94, 1
    s_cmp_lg_u32 s94, 0
    s_cbranch_scc1 L_sr_234
    s_mov_b32 s94, 1
    s_branch L_bk_233
L_sw_235:
L_sr_237:
    ds_read_b32 v242, v246 offset:0
    s_waitcnt lgkmcnt(0)
    v_cmp_ne_u32 vcc, s3, v242
    s_cbranch_vccz L_bk_236
    s_sub_u32 s94, s94, 1
    s_cmp_lg_u32 s94, 0
    s_cbranch_scc1 L_sr_237
    s_mov_b32 s94, 1
    s_branch L_bk_236
L_sub_mlp2:
    s_waitcnt lgkmcnt(0)
    v_cmp_ne_u32 vcc, s3, v242
    s_cbranch_vccnz L_sw_241
L_bk_242:
L_subn_mlp2:
    s_bitcmp1_b32 s83, 0
    s_cbranch_scc1 L_is_244
    s_add_u32 m0, s84, s79
    s_waitcnt vmcnt(8)
    buffer_load_dwordx4 v2, s[36:39], s81 offen offset:0 lds
    s_waitcnt vmcnt(8)
    buffer_load_dwordx4 v3, s[36:39], s81 offen offset:1024 lds
    s_waitcnt vmcnt(8)
    buffer_load_dwordx4 v4, s[36:39], s81 offen offset:2048 lds
    s_waitcnt vmcnt(8)
    buffer_load_dwordx4 v5, s[36:39], s81 offen offset:3072 lds
    s_add_u32 s84, s84, 16384
    s_cmp_eq_u32 s84, 49152
    s_cselect_b32 s84, 0, s84
L_is_244:
    s_add_u32 m0, s80, s78
    s_waitcnt vmcnt(8)
    buffer_load_dwordx4 v6, s[40:43], s82 offen offset:0 lds
    s_waitcnt vmcnt(8)
    buffer_load_dwordx4 v7, s[40:43], s82 offen offset:1024 lds
    s_add_u32 m0, m0, 8192
    s_waitcnt vmcnt(8)
    buffer_load_dwordx4 v6, s[44:47], s82 offen offset:0 lds
    s_waitcnt vmcnt(8)
    buffer_load_dwordx4 v7, s[44:47], s82 offen offset:1024 lds
    s_add_u32 s82, s82, 98304
    s_cmp_eq_u32 s82, 1966080
    s_cselect_b32 s82, 0, s82
    s_bitcmp1_b32 s83, 0
    s_cbranch_scc0 L_is_244b
    s_add_u32 s81, s81, 128
    s_cmp_eq_u32 s81, 1280
    s_cselect_b32 s81, 0, s81
L_is_244b:
    s_add_u32 s83, s83, 1
    s_add_u32 s22, s22, 4
    v_add_u32 v246, 4, v246
    s_mov_b32 m0, s22
    ds_read_b32 v242, v246
    s_add_u32 s80, s80, 16384
    s_cmp_eq_u32 s80, 81920
    s_cselect_b32 s80, 0, s80
    s_waitcnt vmcnt(8)
    buffer_load_dword v252, s[36:39], 0 offen lds
    s_setpc_b64 s[90:91]
L_sw_241:
L_sr_243:
    ds_read_b32 v242, v246 offset:0
    s_waitcnt lgkmcnt(0)
    v_cmp_ne_u32 vcc, s3, v242
    s_cbranch_vccz L_bk_242
    s_sub_u32 s94, s94, 1
    s_cmp_lg_u32 s94, 0
    s_cbranch_scc1 L_sr_243
    s_mov_b32 s94, 1
    s_branch L_bk_242
L_ssm_loader:
    s_waitcnt lgkmcnt(0)
    s_add_u32 s66, s66, 1
    s_lshl_b32 s70, s85, 6
    v_add_u32 v212, s70, v254
    v_min_u32 v212, 159, v212
    s_mul_i32 s70, s64, 160
    v_add_u32 v110, s70, v212
    v_lshlrev_b32 v110, 1, v110
    global_load_ushort v111, v110, s[6:7]
    global_load_ushort v112, v110, s[8:9]
    global_load_ushort v113, v110, s[18:19]
    s_swappc_b64 s[90:91], s[30:31]
    s_swappc_b64 s[90:91], s[30:31]
    s_setprio 3
    s_setprio 0
    s_swappc_b64 s[90:91], s[30:31]
    s_getpc_b64 s[30:31]
L_gq_ssm:
    s_add_u32 s30, s30, L_sub_ssm2-L_gq_ssm
    s_addc_u32 s31, s31, 0
    s_swappc_b64 s[90:91], s[30:31]
    s_setprio 3
    v_lshlrev_b32 v111, 16, v111
    v_lshlrev_b32 v112, 16, v112
    v_lshlrev_b32 v113, 16, v113
    v_mul_f32 v113, 1069066811, v113
    v_exp_f32 v113, v113
    v_mul_f32 v114, v111, v111
    v_fma_f32 v114, v112, v112, v114
    v_cvt_pk_bf16_f32 v113, v113, v113
    v_lshlrev_b32 v113, 16, v113
    v_rcp_f32 v114, v114
    v_mul_f32 v115, v113, v111
    v_mul_f32 v116, v113, v112
    v_mul_f32 v115, 1069066811, v115
    v_mul_f32 v116, 0.15915494, v116
    v_exp_f32 v115, v115
    v_rndne_f32 v117, v116
    v_sub_f32 v116, v116, v117
    v_cos_f32 v117, v116
    v_sin_f32 v116, v116
    v_add_f32 v114, v114, v114
    v_mul_f32 v214, v115, v117
    v_mul_f32 v215, v115, v116
    v_add_f32 v115, -1.0, v214
    v_mul_f32 v116, v215, v112
    v_fma_f32 v116, v115, v111, v116
    v_mul_f32 v117, v115, v112
    v_fma_f32 v117, v215, v111, -v117
    v_mul_f32 v118, v116, v114
    v_mul_f32 v119, -v117, v114
    v_lshlrev_b32 v120, 3, v212
    v_add_u32 v120, 155136, v120
    ds_write_b64 v120, v[214:215]
    ds_write_b64 v120, v[118:119] offset:1280
    v_mul_f32 v220, v118, v214
    v_fma_f32 v220, v119, v215, v220
    v_mul_f32 v221, v119, v214
    v_fma_f32 v221, -v118, v215, v221
    s_setprio 0
    s_swappc_b64 s[90:91], s[30:31]
    s_swappc_b64 s[90:91], s[30:31]
    s_setprio 3
    v_mul_f32 v114, v215, v215
    v_mul_f32 v115, v215, v214
    v_fma_f32 v114, v214, v214, -v114
    v_fma_f32 v217, v214, v215, v115
    v_mov_b32 v216, v114
    v_mul_f32 v114, v217, v217
    v_mul_f32 v115, v217, v216
    v_fma_f32 v114, v216, v216, -v114
    v_fma_f32 v217, v216, v217, v115
    v_mov_b32 v216, v114
    v_mul_f32 v114, v217, v217
    v_mul_f32 v115, v217, v216
    v_fma_f32 v114, v216, v216, -v114
    v_fma_f32 v217, v216, v217, v115
    v_mov_b32 v216, v114
    v_mul_f32 v114, v217, v217
    v_mul_f32 v115, v217, v216
    v_fma_f32 v114, v216, v216, -v114
    v_fma_f32 v219, v216, v217, v115
    v_mov_b32 v218, v114
    v_mul_f32 v114, v219, v219
    v_mul_f32 v115, v219, v218
    v_fma_f32 v114, v218, v218, -v114
    v_fma_f32 v219, v218, v219, v115
    v_mov_b32 v218, v114
    v_mul_f32 v114, v219, v219
    v_mul_f32 v115, v219, v218
    v_fma_f32 v114, v218, v218, -v114
    v_fma_f32 v219, v218, v219, v115
    v_mov_b32 v218, v114
    v_mul_f32 v114, v219, v219
    v_mul_f32 v115, v219, v218
    v_fma_f32 v114, v218, v218, -v114
    v_fma_f32 v219, v218, v219, v115
    v_mov_b32 v218, v114
    s_setprio 0
    s_swappc_b64 s[90:91], s[30:31]
    s_setprio 3
    v_cmp_le_u32 vcc, 80, v212
    v_mov_b32 v41, 0
    v_mov_b32 v42, 480
    v_cndmask_b32 v41, v41, v42, vcc
    v_lshl_add_u32 v41, v212, 1, v41
    s_mul_i32 s70, s64, 160
    v_add_u32 v41, s70, v41
    v_lshlrev_b32 v41, 3, v41
    v_add_u32 v41, 32768, v41
    s_lshl_b32 s71, s62, 10
    s_add_u32 s71, s71, 16384
    v_lshlrev_b32 v40, 4, v254
    v_add_u32 v40, s71, v40
    s_cmp_eq_u32 s85, 3
    s_cselect_b64 vcc, -1, 0
    s_nop 1
    v_cndmask_b32 v40, v41, v40, vcc
    s_setprio 0
    s_swappc_b64 s[90:91], s[30:31]
    s_setprio 3
    s_mov_b32 s48, s28
    s_mov_b32 s49, s29
    s_mov_b32 s50, 1966080
    s_mov_b32 s51, 0x20000
    s_mov_b32 s52, s14
    s_mov_b32 s53, s15
    s_mov_b32 s54, 819200
    s_mov_b32 s55, 0x20000
    s_mov_b32 s56, s16
    s_mov_b32 s57, s17
    s_mov_b32 s58, 819200
    s_mov_b32 s59, 0x20000
    s_lshl_b32 s70, s68, 1
    v_lshrrev_b32 v232, 4, v254
    v_lshlrev_b32 v232, 1, v232
    v_xor_b32 v232, v232, v254
    v_and_b32 v232, 7, v232
    v_lshrrev_b32 v233, 3, v254
    v_mul_u32_u24 v233, 1280, v233
    v_lshl_add_u32 v232, v232, 4, v233
    v_add_u32 v12, s70, v232
    v_lshrrev_b32 v232, 4, v254
    v_xor_b32 v233, v232, v254
    v_and_b32 v233, 7, v233
    v_lshrrev_b32 v232, 3, v254
    v_mul_u32_u24 v15, 1280, v232
    v_lshl_add_u32 v15, v233, 4, v15
    v_xor_b32 v16, 64, v15
    v_add_u32 v16, 9216, v16
    s_mul_i32 s70, s68, 1280
    v_add_u32 v15, s70, v15
    v_add_u32 v16, s70, v16
    s_add_u32 s87, s85, 1
    s_and_b32 s87, s87, 3
    s_add_u32 s101, s87, s98
    s_cmp_ge_u32 s101, 12
    s_cselect_b32 s70, 12, 0
    s_sub_u32 s101, s101, s70
    s_mul_i32 s101, s101, 163840
    v_lshlrev_b32 v236, 4, v254
    s_lshl_b32 s70, s67, 12
    s_add_u32 s70, s70, 12585984
    v_and_b32 v243, 7, v254
    v_lshlrev_b32 v243, 7, v243
    v_add_u32 v243, s70, v243
    s_setprio 0
    s_swappc_b64 s[90:91], s[30:31]
    s_swappc_b64 s[90:91], s[30:31]
    s_swappc_b64 s[90:91], s[30:31]
    s_swappc_b64 s[90:91], s[30:31]
    global_load_dwordx4 v[44:47], v40, s[34:35] sc1
    s_swappc_b64 s[90:91], s[30:31]
    s_swappc_b64 s[90:91], s[30:31]
    s_setprio 3
L_gr_249:
    v_cmp_ne_u32 vcc, s66, v45
    v_cmp_ne_u32 s[88:89], s66, v47
    s_nop 1
    s_or_b64 s[88:89], s[88:89], vcc
    s_cmp_eq_u64 s[88:89], 0
    s_cbranch_scc1 L_gr_250
    global_load_dwordx4 v[44:47], v40, s[34:35] sc1
    s_waitcnt vmcnt(0)
    s_sleep 1
    s_sub_u32 s94, s94, 1
    s_cmp_lg_u32 s94, 0
    s_cbranch_scc1 L_gr_249
    s_mov_b32 s94, 1
L_gr_250:
    s_cmp_eq_u32 s85, 3
    s_cbranch_scc1 L_gr_252
    v_mov_b32 v45, v46
    v_lshlrev_b32 v46, 3, v212
    v_add_u32 v46, 153600, v46
    ds_write_b64 v46, v[44:45]
    s_branch L_gr_251
L_gr_252:
    v_and_b32 v48, 0xffff0000, v44
    v_and_b32 v49, 0xffff0000, v46
    v_rcp_f32 v48, v48
    v_rcp_f32 v49, v49
    v_lshlrev_b32 v44, 16, v44
    v_lshlrev_b32 v46, 16, v46
    v_and_b32 v50, 32, v254
    v_lshlrev_b32 v50, 1, v50
    v_and_b32 v51, 3, v254
    v_lshl_add_u32 v50, v51, 4, v50
    v_bfe_u32 v51, v254, 3, 2
    v_lshl_add_u32 v50, v51, 2, v50
    v_bfe_u32 v51, v254, 2, 1
    v_add_u32 v50, v50, v51
    v_lshlrev_b32 v50, 2, v50
    v_add_u32 v50, 151552, v50
    ds_write2_b32 v50, v44, v46 offset0:0 offset1:2
    ds_write2_b32 v50, v48, v49 offset0:128 offset1:130
L_gr_251:
    s_waitcnt lgkmcnt(0)
    s_setprio 0
    s_swappc_b64 s[90:91], s[30:31]
    s_add_u32 s76, s87, 1
    s_lshl_b32 s76, s76, 2
    s_add_u32 s22, s22, s76
    s_mov_b32 m0, s22
    s_waitcnt vmcnt(9)
    buffer_load_dword v252, s[36:39], 0 offen lds
    s_lshl_b32 s80, s87, 14
    s_add_u32 s77, s101, 0
    s_waitcnt vmcnt(9)
    buffer_load_dwordx4 v[44:47], v12, s[48:51], s77 offen offset:0
    s_add_u32 s77, s101, 10240
    s_waitcnt vmcnt(9)
    buffer_load_dwordx4 v[48:51], v12, s[48:51], s77 offen offset:0
    s_add_u32 s77, s101, 20480
    s_waitcnt vmcnt(9)
    buffer_load_dwordx4 v[52:55], v12, s[48:51], s77 offen offset:0
    s_add_u32 s77, s101, 30720
    s_waitcnt vmcnt(9)
    buffer_load_dwordx4 v[56:59], v12, s[48:51], s77 offen offset:0
    s_add_u32 s77, s101, 40960
    s_waitcnt vmcnt(9)
    buffer_load_dwordx4 v[60:63], v12, s[48:51], s77 offen offset:0
    s_add_u32 s77, s101, 51200
    s_waitcnt vmcnt(9)
    buffer_load_dwordx4 v[64:67], v12, s[48:51], s77 offen offset:0
    s_add_u32 s77, s101, 61440
    s_waitcnt vmcnt(9)
    buffer_load_dwordx4 v[68:71], v12, s[48:51], s77 offen offset:0
    s_add_u32 s77, s101, 71680
    s_waitcnt vmcnt(9)
    buffer_load_dwordx4 v[72:75], v12, s[48:51], s77 offen offset:0
    s_add_u32 s77, s101, 81920
    s_waitcnt vmcnt(9)
    buffer_load_dwordx4 v[76:79], v12, s[48:51], s77 offen offset:0
    s_add_u32 s77, s101, 92160
    s_waitcnt vmcnt(9)
    buffer_load_dwordx4 v[80:83], v12, s[48:51], s77 offen offset:0
    s_add_u32 s77, s101, 102400
    s_waitcnt vmcnt(9)
    buffer_load_dwordx4 v[84:87], v12, s[48:51], s77 offen offset:0
    s_add_u32 s77, s101, 112640
    s_waitcnt vmcnt(9)
    buffer_load_dwordx4 v[88:91], v12, s[48:51], s77 offen offset:0
    s_add_u32 s77, s101, 122880
    s_waitcnt vmcnt(9)
    buffer_load_dwordx4 v[92:95], v12, s[48:51], s77 offen offset:0
    s_add_u32 s77, s101, 133120
    s_waitcnt vmcnt(9)
    buffer_load_dwordx4 v[96:99], v12, s[48:51], s77 offen offset:0
    s_add_u32 s77, s101, 143360
    s_waitcnt vmcnt(9)
    buffer_load_dwordx4 v[100:103], v12, s[48:51], s77 offen offset:0
    s_add_u32 s77, s101, 153600
    s_waitcnt vmcnt(9)
    buffer_load_dwordx4 v[104:107], v12, s[48:51], s77 offen offset:0
    s_add_u32 s101, s101, 655360
    s_cmp_ge_u32 s101, 1966080
    s_cselect_b32 s70, 1966080, 0
    s_sub_u32 s101, s101, s70
    s_add_u32 s76, s87, 13
    s_max_u32 s76, s76, 20
    s_lshl_b32 s76, s76, 2
    v_add_u32 v246, s76, v240
    ds_read_b32 v242, v246 offset:0
    s_waitcnt lgkmcnt(0)
    v_cmp_ne_u32 vcc, s3, v242
    s_cbranch_vccnz L_sw_253
L_bk_254:
    s_waitcnt vmcnt(0)
    v_add_u32 v237, s80, v236
    ds_write_b128 v237, v[44:47] offset:0
    ds_write_b128 v237, v[48:51] offset:1024
    ds_write_b128 v237, v[52:55] offset:2048
    ds_write_b128 v237, v[56:59] offset:3072
    ds_write_b128 v237, v[60:63] offset:4096
    ds_write_b128 v237, v[64:67] offset:5120
    ds_write_b128 v237, v[68:71] offset:6144
    ds_write_b128 v237, v[72:75] offset:7168
    ds_write_b128 v237, v[76:79] offset:8192
    ds_write_b128 v237, v[80:83] offset:9216
    ds_write_b128 v237, v[84:87] offset:10240
    ds_write_b128 v237, v[88:91] offset:11264
    ds_write_b128 v237, v[92:95] offset:12288
    ds_write_b128 v237, v[96:99] offset:13312
    ds_write_b128 v237, v[100:103] offset:14336
    ds_write_b128 v237, v[104:107] offset:15360
    s_add_u32 s87, s87, 4
    s_add_u32 s76, s87, 21
    s_lshl_b32 s76, s76, 2
    v_add_u32 v246, s76, v253
    v_mov_b32 v241, s3
    ds_write_b32 v246, v241
    s_add_u32 s80, s80, 65536
    s_cmp_ge_u32 s80, 147456
    s_cselect_b32 s70, 147456, 0
    s_sub_u32 s80, s80, s70
    s_waitcnt lgkmcnt(0)
    s_add_u32 s77, s101, 0
    s_waitcnt vmcnt(16)
    buffer_load_dwordx4 v[44:47], v12, s[48:51], s77 offen offset:0
    s_add_u32 s77, s101, 10240
    s_waitcnt vmcnt(16)
    buffer_load_dwordx4 v[48:51], v12, s[48:51], s77 offen offset:0
    s_add_u32 s77, s101, 20480
    s_waitcnt vmcnt(16)
    buffer_load_dwordx4 v[52:55], v12, s[48:51], s77 offen offset:0
    s_add_u32 s77, s101, 30720
    s_waitcnt vmcnt(16)
    buffer_load_dwordx4 v[56:59], v12, s[48:51], s77 offen offset:0
    s_add_u32 s77, s101, 40960
    s_waitcnt vmcnt(16)
    buffer_load_dwordx4 v[60:63], v12, s[48:51], s77 offen offset:0
    s_add_u32 s77, s101, 51200
    s_waitcnt vmcnt(16)
    buffer_load_dwordx4 v[64:67], v12, s[48:51], s77 offen offset:0
    s_add_u32 s77, s101, 61440
    s_waitcnt vmcnt(16)
    buffer_load_dwordx4 v[68:71], v12, s[48:51], s77 offen offset:0
    s_add_u32 s77, s101, 71680
    s_waitcnt vmcnt(16)
    buffer_load_dwordx4 v[72:75], v12, s[48:51], s77 offen offset:0
    s_add_u32 s77, s101, 81920
    s_waitcnt vmcnt(16)
    buffer_load_dwordx4 v[76:79], v12, s[48:51], s77 offen offset:0
    s_add_u32 s77, s101, 92160
    s_waitcnt vmcnt(16)
    buffer_load_dwordx4 v[80:83], v12, s[48:51], s77 offen offset:0
    s_add_u32 s77, s101, 102400
    s_waitcnt vmcnt(16)
    buffer_load_dwordx4 v[84:87], v12, s[48:51], s77 offen offset:0
    s_add_u32 s77, s101, 112640
    s_waitcnt vmcnt(16)
    buffer_load_dwordx4 v[88:91], v12, s[48:51], s77 offen offset:0
    s_add_u32 s77, s101, 122880
    s_waitcnt vmcnt(16)
    buffer_load_dwordx4 v[92:95], v12, s[48:51], s77 offen offset:0
    s_add_u32 s77, s101, 133120
    s_waitcnt vmcnt(16)
    buffer_load_dwordx4 v[96:99], v12, s[48:51], s77 offen offset:0
    s_add_u32 s77, s101, 143360
    s_waitcnt vmcnt(16)
    buffer_load_dwordx4 v[100:103], v12, s[48:51], s77 offen offset:0
    s_add_u32 s77, s101, 153600
    s_waitcnt vmcnt(16)
    buffer_load_dwordx4 v[104:107], v12, s[48:51], s77 offen offset:0
    s_add_u32 s101, s101, 655360
    s_cmp_ge_u32 s101, 1966080
    s_cselect_b32 s70, 1966080, 0
    s_sub_u32 s101, s101, s70
    s_setprio 3
    s_barrier
    s_cmp_eq_u32 s85, 3
    s_cbranch_scc1 L_mid_256
    v_lshlrev_b32 v204, 3, v212
    v_add_u32 v204, 81920, v204
    ds_read_b64 v[112:113], v204 offset:0
    ds_read_b64 v[114:115], v204 offset:1280
    ds_read_b64 v[116:117], v204 offset:2560
    ds_read_b64 v[118:119], v204 offset:3840
    ds_read_b64 v[120:121], v204 offset:5120
    ds_read_b64 v[122:123], v204 offset:6400
    ds_read_b64 v[124:125], v204 offset:7680
    ds_read_b64 v[126:127], v204 offset:8960
    ds_read_b64 v[128:129], v204 offset:10240
    ds_read_b64 v[130:131], v204 offset:11520
    ds_read_b64 v[132:133], v204 offset:12800
    ds_read_b64 v[134:135], v204 offset:14080
    ds_read_b64 v[136:137], v204 offset:15360
    ds_read_b64 v[138:139], v204 offset:16640
    ds_read_b64 v[140:141], v204 offset:17920
    ds_read_b64 v[142:143], v204 offset:19200
    s_lshl_b32 s70, s64, 4
    s_mul_i32 s70, s70, 2560
    s_add_u32 s70, s70, 13631488
    v_lshlrev_b32 v205, 4, v212
    v_add_u32 v205, s70, v205
    s_mul_i32 s70, s62, 2560
    v_add_u32 v206, s70, v205
    v_mov_b32 v209, s66
    v_mov_b32 v211, s66
    s_waitcnt lgkmcnt(11)
    v_pk_fma_f32 v[114:115], v[216:217], v[112:113], v[114:115] op_sel_hi:[0,1,1]
    v_pk_fma_f32 v[114:115], v[216:217], v[112:113], v[114:115] op_sel:[1,1,0] op_sel_hi:[1,0,1] neg_lo:[1,0,0] neg_hi:[0,0,0]
    v_pk_fma_f32 v[116:117], v[216:217], v[114:115], v[116:117] op_sel_hi:[0,1,1]
    v_pk_fma_f32 v[116:117], v[216:217], v[114:115], v[116:117] op_sel:[1,1,0] op_sel_hi:[1,0,1] neg_lo:[1,0,0] neg_hi:[0,0,0]
    v_pk_fma_f32 v[118:119], v[216:217], v[116:117], v[118:119] op_sel_hi:[0,1,1]
    v_pk_fma_f32 v[118:119], v[216:217], v[116:117], v[118:119] op_sel:[1,1,0] op_sel_hi:[1,0,1] neg_lo:[1,0,0] neg_hi:[0,0,0]
    v_pk_fma_f32 v[120:121], v[216:217], v[118:119], v[120:121] op_sel_hi:[0,1,1]
    v_pk_fma_f32 v[120:121], v[216:217], v[118:119], v[120:121] op_sel:[1,1,0] op_sel_hi:[1,0,1] neg_lo:[1,0,0] neg_hi:[0,0,0]
    s_waitcnt lgkmcnt(7)
    v_pk_fma_f32 v[122:123], v[216:217], v[120:121], v[122:123] op_sel_hi:[0,1,1]
    v_pk_fma_f32 v[122:123], v[216:217], v[120:121], v[122:123] op_sel:[1,1,0] op_sel_hi:[1,0,1] neg_lo:[1,0,0] neg_hi:[0,0,0]
    v_pk_fma_f32 v[124:125], v[216:217], v[122:123], v[124:125] op_sel_hi:[0,1,1]
    v_pk_fma_f32 v[124:125], v[216:217], v[122:123], v[124:125] op_sel:[1,1,0] op_sel_hi:[1,0,1] neg_lo:[1,0,0] neg_hi:[0,0,0]
    v_pk_fma_f32 v[126:127], v[216:217], v[124:125], v[126:127] op_sel_hi:[0,1,1]
    v_pk_fma_f32 v[126:127], v[216:217], v[124:125], v[126:127] op_sel:[1,1,0] op_sel_hi:[1,0,1] neg_lo:[1,0,0] neg_hi:[0,0,0]
    v_pk_fma_f32 v[128:129], v[216:217], v[126:127], v[128:129] op_sel_hi:[0,1,1]
    v_pk_fma_f32 v[128:129], v[216:217], v[126:127], v[128:129] op_sel:[1,1,0] op_sel_hi:[1,0,1] neg_lo:[1,0,0] neg_hi:[0,0,0]
    s_waitcnt lgkmcnt(3)
    v_pk_fma_f32 v[130:131], v[216:217], v[128:129], v[130:131] op_sel_hi:[0,1,1]
    v_pk_fma_f32 v[130:131], v[216:217], v[128:129], v[130:131] op_sel:[1,1,0] op_sel_hi:[1,0,1] neg_lo:[1,0,0] neg_hi:[0,0,0]
    v_pk_fma_f32 v[132:133], v[216:217], v[130:131], v[132:133] op_sel_hi:[0,1,1]
    v_pk_fma_f32 v[132:133], v[216:217], v[130:131], v[132:133] op_sel:[1,1,0] op_sel_hi:[1,0,1] neg_lo:[1,0,0] neg_hi:[0,0,0]
    v_pk_fma_f32 v[134:135], v[216:217], v[132:133], v[134:135] op_sel_hi:[0,1,1]
    v_pk_fma_f32 v[134:135], v[216:217], v[132:133], v[134:135] op_sel:[1,1,0] op_sel_hi:[1,0,1] neg_lo:[1,0,0] neg_hi:[0,0,0]
    v_pk_fma_f32 v[136:137], v[216:217], v[134:135], v[136:137] op_sel_hi:[0,1,1]
    v_pk_fma_f32 v[136:137], v[216:217], v[134:135], v[136:137] op_sel:[1,1,0] op_sel_hi:[1,0,1] neg_lo:[1,0,0] neg_hi:[0,0,0]
    s_waitcnt lgkmcnt(0)
    v_pk_fma_f32 v[138:139], v[216:217], v[136:137], v[138:139] op_sel_hi:[0,1,1]
    v_pk_fma_f32 v[138:139], v[216:217], v[136:137], v[138:139] op_sel:[1,1,0] op_sel_hi:[1,0,1] neg_lo:[1,0,0] neg_hi:[0,0,0]
    v_pk_fma_f32 v[140:141], v[216:217], v[138:139], v[140:141] op_sel_hi:[0,1,1]
    v_pk_fma_f32 v[140:141], v[216:217], v[138:139], v[140:141] op_sel:[1,1,0] op_sel_hi:[1,0,1] neg_lo:[1,0,0] neg_hi:[0,0,0]
    v_pk_fma_f32 v[142:143], v[216:217], v[140:141], v[142:143] op_sel_hi:[0,1,1]
    v_pk_fma_f32 v[142:143], v[216:217], v[140:141], v[142:143] op_sel:[1,1,0] op_sel_hi:[1,0,1] neg_lo:[1,0,0] neg_hi:[0,0,0]
    v_mov_b32 v208, v142
    v_mov_b32 v210, v143
    s_mov_b32 s83, 0
    global_store_dwordx4 v206, v[208:211], s[34:35] sc1
    v_pk_mul_f32 v[142:143], v[220:221], v[140:141] op_sel_hi:[0,1] neg_hi:[0,1]
    v_pk_fma_f32 v[142:143], v[220:221], v[140:141], v[142:143] op_sel:[1,1,0] op_sel_hi:[1,0,1] neg_lo:[0,0,0] neg_hi:[0,0,0]
    v_pk_mul_f32 v[140:141], v[220:221], v[138:139] op_sel_hi:[0,1] neg_hi:[0,1]
    v_pk_fma_f32 v[140:141], v[220:221], v[138:139], v[140:141] op_sel:[1,1,0] op_sel_hi:[1,0,1] neg_lo:[0,0,0] neg_hi:[0,0,0]
    v_pk_mul_f32 v[138:139], v[220:221], v[136:137] op_sel_hi:[0,1] neg_hi:[0,1]
    v_pk_fma_f32 v[138:139], v[220:221], v[136:137], v[138:139] op_sel:[1,1,0] op_sel_hi:[1,0,1] neg_lo:[0,0,0] neg_hi:[0,0,0]
    v_pk_mul_f32 v[136:137], v[220:221], v[134:135] op_sel_hi:[0,1] neg_hi:[0,1]
    v_pk_fma_f32 v[136:137], v[220:221], v[134:135], v[136:137] op_sel:[1,1,0] op_sel_hi:[1,0,1] neg_lo:[0,0,0] neg_hi:[0,0,0]
    v_pk_mul_f32 v[134:135], v[220:221], v[132:133] op_sel_hi:[0,1] neg_hi:[0,1]
    v_pk_fma_f32 v[134:135], v[220:221], v[132:133], v[134:135] op_sel:[1,1,0] op_sel_hi:[1,0,1] neg_lo:[0,0,0] neg_hi:[0,0,0]
    v_pk_mul_f32 v[132:133], v[220:221], v[130:131] op_sel_hi:[0,1] neg_hi:[0,1]
    v_pk_fma_f32 v[132:133], v[220:221], v[130:131], v[132:133] op_sel:[1,1,0] op_sel_hi:[1,0,1] neg_lo:[0,0,0] neg_hi:[0,0,0]
    v_pk_mul_f32 v[130:131], v[220:221], v[128:129] op_sel_hi:[0,1] neg_hi:[0,1]
    v_pk_fma_f32 v[130:131], v[220:221], v[128:129], v[130:131] op_sel:[1,1,0] op_sel_hi:[1,0,1] neg_lo:[0,0,0] neg_hi:[0,0,0]
    v_pk_mul_f32 v[128:129], v[220:221], v[126:127] op_sel_hi:[0,1] neg_hi:[0,1]
    v_pk_fma_f32 v[128:129], v[220:221], v[126:127], v[128:129] op_sel:[1,1,0] op_sel_hi:[1,0,1] neg_lo:[0,0,0] neg_hi:[0,0,0]
    v_pk_mul_f32 v[126:127], v[220:221], v[124:125] op_sel_hi:[0,1] neg_hi:[0,1]
    v_pk_fma_f32 v[126:127], v[220:221], v[124:125], v[126:127] op_sel:[1,1,0] op_sel_hi:[1,0,1] neg_lo:[0,0,0] neg_hi:[0,0,0]
    v_pk_mul_f32 v[124:125], v[220:221], v[122:123] op_sel_hi:[0,1] neg_hi:[0,1]
    v_pk_fma_f32 v[124:125], v[220:221], v[122:123], v[124:125] op_sel:[1,1,0] op_sel_hi:[1,0,1] neg_lo:[0,0,0] neg_hi:[0,0,0]
    v_pk_mul_f32 v[122:123], v[220:221], v[120:121] op_sel_hi:[0,1] neg_hi:[0,1]
    v_pk_fma_f32 v[122:123], v[220:221], v[120:121], v[122:123] op_sel:[1,1,0] op_sel_hi:[1,0,1] neg_lo:[0,0,0] neg_hi:[0,0,0]
    v_pk_mul_f32 v[120:121], v[220:221], v[118:119] op_sel_hi:[0,1] neg_hi:[0,1]
    v_pk_fma_f32 v[120:121], v[220:221], v[118:119], v[120:121] op_sel:[1,1,0] op_sel_hi:[1,0,1] neg_lo:[0,0,0] neg_hi:[0,0,0]
    v_pk_mul_f32 v[118:119], v[220:221], v[116:117] op_sel_hi:[0,1] neg_hi:[0,1]
    v_pk_fma_f32 v[118:119], v[220:221], v[116:117], v[118:119] op_sel:[1,1,0] op_sel_hi:[1,0,1] neg_lo:[0,0,0] neg_hi:[0,0,0]
    v_pk_mul_f32 v[116:117], v[220:221], v[114:115] op_sel_hi:[0,1] neg_hi:[0,1]
    v_pk_fma_f32 v[116:117], v[220:221], v[114:115], v[116:117] op_sel:[1,1,0] op_sel_hi:[1,0,1] neg_lo:[0,0,0] neg_hi:[0,0,0]
    v_pk_mul_f32 v[114:115], v[220:221], v[112:113] op_sel_hi:[0,1] neg_hi:[0,1]
    v_pk_fma_f32 v[114:115], v[220:221], v[112:113], v[114:115] op_sel:[1,1,0] op_sel_hi:[1,0,1] neg_lo:[0,0,0] neg_hi:[0,0,0]
    v_mov_b32 v18, v216
    v_sub_f32 v19, 0, v217
    v_pk_mul_f32 v[20:21], v[18:19], v[18:19] op_sel_hi:[0,1]
    v_pk_fma_f32 v[20:21], v[18:19], v[18:19], v[20:21] op_sel:[1,1,0] op_sel_hi:[1,0,1] neg_lo:[1,0,0] neg_hi:[0,0,0]
    v_pk_mul_f32 v[22:23], v[18:19], v[20:21] op_sel_hi:[0,1]
    v_pk_fma_f32 v[22:23], v[18:19], v[20:21], v[22:23] op_sel:[1,1,0] op_sel_hi:[1,0,1] neg_lo:[1,0,0] neg_hi:[0,0,0]
    v_pk_mul_f32 v[24:25], v[18:19], v[22:23] op_sel_hi:[0,1]
    v_pk_fma_f32 v[24:25], v[18:19], v[22:23], v[24:25] op_sel:[1,1,0] op_sel_hi:[1,0,1] neg_lo:[1,0,0] neg_hi:[0,0,0]
    v_pk_mul_f32 v[26:27], v[18:19], v[24:25] op_sel_hi:[0,1]
    v_pk_fma_f32 v[26:27], v[18:19], v[24:25], v[26:27] op_sel:[1,1,0] op_sel_hi:[1,0,1] neg_lo:[1,0,0] neg_hi:[0,0,0]
    v_pk_mul_f32 v[28:29], v[18:19], v[26:27] op_sel_hi:[0,1]
    v_pk_fma_f32 v[28:29], v[18:19], v[26:27], v[28:29] op_sel:[1,1,0] op_sel_hi:[1,0,1] neg_lo:[1,0,0] neg_hi:[0,0,0]
    v_pk_mul_f32 v[30:31], v[18:19], v[28:29] op_sel_hi:[0,1]
    v_pk_fma_f32 v[30:31], v[18:19], v[28:29], v[30:31] op_sel:[1,1,0] op_sel_hi:[1,0,1] neg_lo:[1,0,0] neg_hi:[0,0,0]
    v_pk_mul_f32 v[32:33], v[18:19], v[30:31] op_sel_hi:[0,1]
    v_pk_fma_f32 v[32:33], v[18:19], v[30:31], v[32:33] op_sel:[1,1,0] op_sel_hi:[1,0,1] neg_lo:[1,0,0] neg_hi:[0,0,0]
    v_pk_mul_f32 v[34:35], v[18:19], v[32:33] op_sel_hi:[0,1]
    v_pk_fma_f32 v[34:35], v[18:19], v[32:33], v[34:35] op_sel:[1,1,0] op_sel_hi:[1,0,1] neg_lo:[1,0,0] neg_hi:[0,0,0]
    v_pk_mul_f32 v[36:37], v[18:19], v[34:35] op_sel_hi:[0,1]
    v_pk_fma_f32 v[36:37], v[18:19], v[34:35], v[36:37] op_sel:[1,1,0] op_sel_hi:[1,0,1] neg_lo:[1,0,0] neg_hi:[0,0,0]
    v_pk_mul_f32 v[38:39], v[18:19], v[36:37] op_sel_hi:[0,1]
    v_pk_fma_f32 v[38:39], v[18:19], v[36:37], v[38:39] op_sel:[1,1,0] op_sel_hi:[1,0,1] neg_lo:[1,0,0] neg_hi:[0,0,0]
    v_pk_mul_f32 v[40:41], v[18:19], v[38:39] op_sel_hi:[0,1]
    v_pk_fma_f32 v[40:41], v[18:19], v[38:39], v[40:41] op_sel:[1,1,0] op_sel_hi:[1,0,1] neg_lo:[1,0,0] neg_hi:[0,0,0]
    v_pk_mul_f32 v[42:43], v[18:19], v[40:41] op_sel_hi:[0,1]
    v_pk_fma_f32 v[42:43], v[18:19], v[40:41], v[42:43] op_sel:[1,1,0] op_sel_hi:[1,0,1] neg_lo:[1,0,0] neg_hi:[0,0,0]
    v_mov_b32 v112, 0
    v_mov_b32 v113, 0
    v_mov_b32 v207, v205
    s_cmp_le_u32 s62, 0
    s_cbranch_scc1 L_lb_259
    global_load_dwordx4 v[144:147], v207, s[34:35] sc1
    v_add_u32 v207, 2560, v207
    s_cmp_le_u32 s62, 1
    s_cbranch_scc1 L_lb_259
    global_load_dwordx4 v[148:151], v207, s[34:35] sc1
    v_add_u32 v207, 2560, v207
    s_cmp_le_u32 s62, 2
    s_cbranch_scc1 L_lb_259
    global_load_dwordx4 v[152:155], v207, s[34:35] sc1
    v_add_u32 v207, 2560, v207
    s_cmp_le_u32 s62, 3
    s_cbranch_scc1 L_lb_259
    global_load_dwordx4 v[156:159], v207, s[34:35] sc1
    v_add_u32 v207, 2560, v207
    s_cmp_le_u32 s62, 4
    s_cbranch_scc1 L_lb_259
    global_load_dwordx4 v[160:163], v207, s[34:35] sc1
    v_add_u32 v207, 2560, v207
    s_cmp_le_u32 s62, 5
    s_cbranch_scc1 L_lb_259
    global_load_dwordx4 v[164:167], v207, s[34:35] sc1
    v_add_u32 v207, 2560, v207
    s_cmp_le_u32 s62, 6
    s_cbranch_scc1 L_lb_259
    global_load_dwordx4 v[168:171], v207, s[34:35] sc1
    v_add_u32 v207, 2560, v207
    s_cmp_le_u32 s62, 7
    s_cbranch_scc1 L_lb_259
    global_load_dwordx4 v[172:175], v207, s[34:35] sc1
    v_add_u32 v207, 2560, v207
    s_cmp_le_u32 s62, 8
    s_cbranch_scc1 L_lb_259
    global_load_dwordx4 v[176:179], v207, s[34:35] sc1
    v_add_u32 v207, 2560, v207
    s_cmp_le_u32 s62, 9
    s_cbranch_scc1 L_lb_259
    global_load_dwordx4 v[180:183], v207, s[34:35] sc1
    v_add_u32 v207, 2560, v207
    s_cmp_le_u32 s62, 10
    s_cbranch_scc1 L_lb_259
    global_load_dwordx4 v[184:187], v207, s[34:35] sc1
    v_add_u32 v207, 2560, v207
    s_cmp_le_u32 s62, 11
    s_cbranch_scc1 L_lb_259
    global_load_dwordx4 v[188:191], v207, s[34:35] sc1
    v_add_u32 v207, 2560, v207
    s_cmp_le_u32 s62, 12
    s_cbranch_scc1 L_lb_259
    global_load_dwordx4 v[192:195], v207, s[34:35] sc1
    v_add_u32 v207, 2560, v207
    s_cmp_le_u32 s62, 13
    s_cbranch_scc1 L_lb_259
    global_load_dwordx4 v[196:199], v207, s[34:35] sc1
    v_add_u32 v207, 2560, v207
    s_cmp_le_u32 s62, 14
    s_cbranch_scc1 L_lb_259
    global_load_dwordx4 v[200:203], v207, s[34:35] sc1
    v_add_u32 v207, 2560, v207
L_lb_259:
L_lb_257:
    s_waitcnt vmcnt(0)
    s_mov_b64 s[88:89], 0
    s_cmp_le_u32 s62, 0
    s_cbranch_scc1 L_lb_260
    v_cmp_ne_u32 vcc, s66, v145
    v_cmp_ne_u32 s[90:91], s66, v147
    s_nop 1
    s_or_b64 s[88:89], s[88:89], vcc
    s_or_b64 s[88:89], s[88:89], s[90:91]
    s_cmp_le_u32 s62, 1
    s_cbranch_scc1 L_lb_260
    v_cmp_ne_u32 vcc, s66, v149
    v_cmp_ne_u32 s[90:91], s66, v151
    s_nop 1
    s_or_b64 s[88:89], s[88:89], vcc
    s_or_b64 s[88:89], s[88:89], s[90:91]
    s_cmp_le_u32 s62, 2
    s_cbranch_scc1 L_lb_260
    v_cmp_ne_u32 vcc, s66, v153
    v_cmp_ne_u32 s[90:91], s66, v155
    s_nop 1
    s_or_b64 s[88:89], s[88:89], vcc
    s_or_b64 s[88:89], s[88:89], s[90:91]
    s_cmp_le_u32 s62, 3
    s_cbranch_scc1 L_lb_260
    v_cmp_ne_u32 vcc, s66, v157
    v_cmp_ne_u32 s[90:91], s66, v159
    s_nop 1
    s_or_b64 s[88:89], s[88:89], vcc
    s_or_b64 s[88:89], s[88:89], s[90:91]
    s_cmp_le_u32 s62, 4
    s_cbranch_scc1 L_lb_260
    v_cmp_ne_u32 vcc, s66, v161
    v_cmp_ne_u32 s[90:91], s66, v163
    s_nop 1
    s_or_b64 s[88:89], s[88:89], vcc
    s_or_b64 s[88:89], s[88:89], s[90:91]
    s_cmp_le_u32 s62, 5
    s_cbranch_scc1 L_lb_260
    v_cmp_ne_u32 vcc, s66, v165
    v_cmp_ne_u32 s[90:91], s66, v167
    s_nop 1
    s_or_b64 s[88:89], s[88:89], vcc
    s_or_b64 s[88:89], s[88:89], s[90:91]
    s_cmp_le_u32 s62, 6
    s_cbranch_scc1 L_lb_260
    v_cmp_ne_u32 vcc, s66, v169
    v_cmp_ne_u32 s[90:91], s66, v171
    s_nop 1
    s_or_b64 s[88:89], s[88:89], vcc
    s_or_b64 s[88:89], s[88:89], s[90:91]
    s_cmp_le_u32 s62, 7
    s_cbranch_scc1 L_lb_260
    v_cmp_ne_u32 vcc, s66, v173
    v_cmp_ne_u32 s[90:91], s66, v175
    s_nop 1
    s_or_b64 s[88:89], s[88:89], vcc
    s_or_b64 s[88:89], s[88:89], s[90:91]
    s_cmp_le_u32 s62, 8
    s_cbranch_scc1 L_lb_260
    v_cmp_ne_u32 vcc, s66, v177
    v_cmp_ne_u32 s[90:91], s66, v179
    s_nop 1
    s_or_b64 s[88:89], s[88:89], vcc
    s_or_b64 s[88:89], s[88:89], s[90:91]
    s_cmp_le_u32 s62, 9
    s_cbranch_scc1 L_lb_260
    v_cmp_ne_u32 vcc, s66, v181
    v_cmp_ne_u32 s[90:91], s66, v183
    s_nop 1
    s_or_b64 s[88:89], s[88:89], vcc
    s_or_b64 s[88:89], s[88:89], s[90:91]
    s_cmp_le_u32 s62, 10
    s_cbranch_scc1 L_lb_260
    v_cmp_ne_u32 vcc, s66, v185
    v_cmp_ne_u32 s[90:91], s66, v187
    s_nop 1
    s_or_b64 s[88:89], s[88:89], vcc
    s_or_b64 s[88:89], s[88:89], s[90:91]
    s_cmp_le_u32 s62, 11
    s_cbranch_scc1 L_lb_260
    v_cmp_ne_u32 vcc, s66, v189
    v_cmp_ne_u32 s[90:91], s66, v191
    s_nop 1
    s_or_b64 s[88:89], s[88:89], vcc
    s_or_b64 s[88:89], s[88:89], s[90:91]
    s_cmp_le_u32 s62, 12
    s_cbranch_scc1 L_lb_260
    v_cmp_ne_u32 vcc, s66, v193
    v_cmp_ne_u32 s[90:91], s66, v195
    s_nop 1
    s_or_b64 s[88:89], s[88:89], vcc
    s_or_b64 s[88:89], s[88:89], s[90:91]
    s_cmp_le_u32 s62, 13
    s_cbranch_scc1 L_lb_260
    v_cmp_ne_u32 vcc, s66, v197
    v_cmp_ne_u32 s[90:91], s66, v199
    s_nop 1
    s_or_b64 s[88:89], s[88:89], vcc
    s_or_b64 s[88:89], s[88:89], s[90:91]
    s_cmp_le_u32 s62, 14
    s_cbranch_scc1 L_lb_260
    v_cmp_ne_u32 vcc, s66, v201
    v_cmp_ne_u32 s[90:91], s66, v203
    s_nop 1
    s_or_b64 s[88:89], s[88:89], vcc
    s_or_b64 s[88:89], s[88:89], s[90:91]
L_lb_260:
    s_cmp_eq_u64 s[88:89], 0
    s_cbranch_scc1 L_lb_258
    v_mov_b32 v207, v205
    s_cmp_le_u32 s62, 0
    s_cbranch_scc1 L_lb_262
    global_load_dwordx4 v[144:147], v207, s[34:35] sc1
    v_add_u32 v207, 2560, v207
    s_cmp_le_u32 s62, 1
    s_cbranch_scc1 L_lb_262
    global_load_dwordx4 v[148:151], v207, s[34:35] sc1
    v_add_u32 v207, 2560, v207
    s_cmp_le_u32 s62, 2
    s_cbranch_scc1 L_lb_262
    global_load_dwordx4 v[152:155], v207, s[34:35] sc1
    v_add_u32 v207, 2560, v207
    s_cmp_le_u32 s62, 3
    s_cbranch_scc1 L_lb_262
    global_load_dwordx4 v[156:159], v207, s[34:35] sc1
    v_add_u32 v207, 2560, v207
    s_cmp_le_u32 s62, 4
    s_cbranch_scc1 L_lb_262
    global_load_dwordx4 v[160:163], v207, s[34:35] sc1
    v_add_u32 v207, 2560, v207
    s_cmp_le_u32 s62, 5
    s_cbranch_scc1 L_lb_262
    global_load_dwordx4 v[164:167], v207, s[34:35] sc1
    v_add_u32 v207, 2560, v207
    s_cmp_le_u32 s62, 6
    s_cbranch_scc1 L_lb_262
    global_load_dwordx4 v[168:171], v207, s[34:35] sc1
    v_add_u32 v207, 2560, v207
    s_cmp_le_u32 s62, 7
    s_cbranch_scc1 L_lb_262
    global_load_dwordx4 v[172:175], v207, s[34:35] sc1
    v_add_u32 v207, 2560, v207
    s_cmp_le_u32 s62, 8
    s_cbranch_scc1 L_lb_262
    global_load_dwordx4 v[176:179], v207, s[34:35] sc1
    v_add_u32 v207, 2560, v207
    s_cmp_le_u32 s62, 9
    s_cbranch_scc1 L_lb_262
    global_load_dwordx4 v[180:183], v207, s[34:35] sc1
    v_add_u32 v207, 2560, v207
    s_cmp_le_u32 s62, 10
    s_cbranch_scc1 L_lb_262
    global_load_dwordx4 v[184:187], v207, s[34:35] sc1
    v_add_u32 v207, 2560, v207
    s_cmp_le_u32 s62, 11
    s_cbranch_scc1 L_lb_262
    global_load_dwordx4 v[188:191], v207, s[34:35] sc1
    v_add_u32 v207, 2560, v207
    s_cmp_le_u32 s62, 12
    s_cbranch_scc1 L_lb_262
    global_load_dwordx4 v[192:195], v207, s[34:35] sc1
    v_add_u32 v207, 2560, v207
    s_cmp_le_u32 s62, 13
    s_cbranch_scc1 L_lb_262
    global_load_dwordx4 v[196:199], v207, s[34:35] sc1
    v_add_u32 v207, 2560, v207
    s_cmp_le_u32 s62, 14
    s_cbranch_scc1 L_lb_262
    global_load_dwordx4 v[200:203], v207, s[34:35] sc1
    v_add_u32 v207, 2560, v207
L_lb_262:
    s_sleep 1
    s_sub_u32 s94, s94, 1
    s_cmp_lg_u32 s94, 0
    s_cbranch_scc1 L_lb_257
    s_mov_b32 s94, 1
L_lb_258:
    v_mov_b32 v208, 0
    v_mov_b32 v209, 0
    s_cmp_le_u32 s62, 0
    s_cbranch_scc1 L_lb_261
    v_mov_b32 v145, v146
    v_pk_fma_f32 v[144:145], v[218:219], v[208:209], v[144:145] op_sel_hi:[0,1,1]
    v_pk_fma_f32 v[144:145], v[218:219], v[208:209], v[144:145] op_sel:[1,1,0] op_sel_hi:[1,0,1] neg_lo:[1,0,0] neg_hi:[0,0,0]
    v_mov_b64 v[208:209], v[144:145]
    s_cmp_le_u32 s62, 1
    s_cbranch_scc1 L_lb_261
    v_mov_b32 v149, v150
    v_pk_fma_f32 v[148:149], v[218:219], v[208:209], v[148:149] op_sel_hi:[0,1,1]
    v_pk_fma_f32 v[148:149], v[218:219], v[208:209], v[148:149] op_sel:[1,1,0] op_sel_hi:[1,0,1] neg_lo:[1,0,0] neg_hi:[0,0,0]
    v_mov_b64 v[208:209], v[148:149]
    s_cmp_le_u32 s62, 2
    s_cbranch_scc1 L_lb_261
    v_mov_b32 v153, v154
    v_pk_fma_f32 v[152:153], v[218:219], v[208:209], v[152:153] op_sel_hi:[0,1,1]
    v_pk_fma_f32 v[152:153], v[218:219], v[208:209], v[152:153] op_sel:[1,1,0] op_sel_hi:[1,0,1] neg_lo:[1,0,0] neg_hi:[0,0,0]
    v_mov_b64 v[208:209], v[152:153]
    s_cmp_le_u32 s62, 3
    s_cbranch_scc1 L_lb_261
    v_mov_b32 v157, v158
    v_pk_fma_f32 v[156:157], v[218:219], v[208:209], v[156:157] op_sel_hi:[0,1,1]
    v_pk_fma_f32 v[156:157], v[218:219], v[208:209], v[156:157] op_sel:[1,1,0] op_sel_hi:[1,0,1] neg_lo:[1,0,0] neg_hi:[0,0,0]
    v_mov_b64 v[208:209], v[156:157]
    s_cmp_le_u32 s62, 4
    s_cbranch_scc1 L_lb_261
    v_mov_b32 v161, v162
    v_pk_fma_f32 v[160:161], v[218:219], v[208:209], v[160:161] op_sel_hi:[0,1,1]
    v_pk_fma_f32 v[160:161], v[218:219], v[208:209], v[160:161] op_sel:[1,1,0] op_sel_hi:[1,0,1] neg_lo:[1,0,0] neg_hi:[0,0,0]
    v_mov_b64 v[208:209], v[160:161]
    s_cmp_le_u32 s62, 5
    s_cbranch_scc1 L_lb_261
    v_mov_b32 v165, v166
    v_pk_fma_f32 v[164:165], v[218:219], v[208:209], v[164:165] op_sel_hi:[0,1,1]
    v_pk_fma_f32 v[164:165], v[218:219], v[208:209], v[164:165] op_sel:[1,1,0] op_sel_hi:[1,0,1] neg_lo:[1,0,0] neg_hi:[0,0,0]
    v_mov_b64 v[208:209], v[164:165]
    s_cmp_le_u32 s62, 6
    s_cbranch_scc1 L_lb_261
    v_mov_b32 v169, v170
    v_pk_fma_f32 v[168:169], v[218:219], v[208:209], v[168:169] op_sel_hi:[0,1,1]
    v_pk_fma_f32 v[168:169], v[218:219], v[208:209], v[168:169] op_sel:[1,1,0] op_sel_hi:[1,0,1] neg_lo:[1,0,0] neg_hi:[0,0,0]
    v_mov_b64 v[208:209], v[168:169]
    s_cmp_le_u32 s62, 7
    s_cbranch_scc1 L_lb_261
    v_mov_b32 v173, v174
    v_pk_fma_f32 v[172:173], v[218:219], v[208:209], v[172:173] op_sel_hi:[0,1,1]
    v_pk_fma_f32 v[172:173], v[218:219], v[208:209], v[172:173] op_sel:[1,1,0] op_sel_hi:[1,0,1] neg_lo:[1,0,0] neg_hi:[0,0,0]
    v_mov_b64 v[208:209], v[172:173]
    s_cmp_le_u32 s62, 8
    s_cbranch_scc1 L_lb_261
    v_mov_b32 v177, v178
    v_pk_fma_f32 v[176:177], v[218:219], v[208:209], v[176:177] op_sel_hi:[0,1,1]
    v_pk_fma_f32 v[176:177], v[218:219], v[208:209], v[176:177] op_sel:[1,1,0] op_sel_hi:[1,0,1] neg_lo:[1,0,0] neg_hi:[0,0,0]
    v_mov_b64 v[208:209], v[176:177]
    s_cmp_le_u32 s62, 9
    s_cbranch_scc1 L_lb_261
    v_mov_b32 v181, v182
    v_pk_fma_f32 v[180:181], v[218:219], v[208:209], v[180:181] op_sel_hi:[0,1,1]
    v_pk_fma_f32 v[180:181], v[218:219], v[208:209], v[180:181] op_sel:[1,1,0] op_sel_hi:[1,0,1] neg_lo:[1,0,0] neg_hi:[0,0,0]
    v_mov_b64 v[208:209], v[180:181]
    s_cmp_le_u32 s62, 10
    s_cbranch_scc1 L_lb_261
    v_mov_b32 v185, v186
    v_pk_fma_f32 v[184:185], v[218:219], v[208:209], v[184:185] op_sel_hi:[0,1,1]
    v_pk_fma_f32 v[184:185], v[218:219], v[208:209], v[184:185] op_sel:[1,1,0] op_sel_hi:[1,0,1] neg_lo:[1,0,0] neg_hi:[0,0,0]
    v_mov_b64 v[208:209], v[184:185]
    s_cmp_le_u32 s62, 11
    s_cbranch_scc1 L_lb_261
    v_mov_b32 v189, v190
    v_pk_fma_f32 v[188:189], v[218:219], v[208:209], v[188:189] op_sel_hi:[0,1,1]
    v_pk_fma_f32 v[188:189], v[218:219], v[208:209], v[188:189] op_sel:[1,1,0] op_sel_hi:[1,0,1] neg_lo:[1,0,0] neg_hi:[0,0,0]
    v_mov_b64 v[208:209], v[188:189]
    s_cmp_le_u32 s62, 12
    s_cbranch_scc1 L_lb_261
    v_mov_b32 v193, v194
    v_pk_fma_f32 v[192:193], v[218:219], v[208:209], v[192:193] op_sel_hi:[0,1,1]
    v_pk_fma_f32 v[192:193], v[218:219], v[208:209], v[192:193] op_sel:[1,1,0] op_sel_hi:[1,0,1] neg_lo:[1,0,0] neg_hi:[0,0,0]
    v_mov_b64 v[208:209], v[192:193]
    s_cmp_le_u32 s62, 13
    s_cbranch_scc1 L_lb_261
    v_mov_b32 v197, v198
    v_pk_fma_f32 v[196:197], v[218:219], v[208:209], v[196:197] op_sel_hi:[0,1,1]
    v_pk_fma_f32 v[196:197], v[218:219], v[208:209], v[196:197] op_sel:[1,1,0] op_sel_hi:[1,0,1] neg_lo:[1,0,0] neg_hi:[0,0,0]
    v_mov_b64 v[208:209], v[196:197]
    s_cmp_le_u32 s62, 14
    s_cbranch_scc1 L_lb_261
    v_mov_b32 v201, v202
    v_pk_fma_f32 v[200:201], v[218:219], v[208:209], v[200:201] op_sel_hi:[0,1,1]
    v_pk_fma_f32 v[200:201], v[218:219], v[208:209], v[200:201] op_sel:[1,1,0] op_sel_hi:[1,0,1] neg_lo:[1,0,0] neg_hi:[0,0,0]
    v_mov_b64 v[208:209], v[200:201]
L_lb_261:
    v_pk_mul_f32 v[210:211], v[220:221], v[208:209] op_sel_hi:[0,1] neg_hi:[0,1]
    v_pk_fma_f32 v[210:211], v[220:221], v[208:209], v[210:211] op_sel:[1,1,0] op_sel_hi:[1,0,1] neg_lo:[0,0,0] neg_hi:[0,0,0]
    v_pk_add_f32 v[112:113], v[112:113], v[210:211]
    ds_write_b64 v204, v[112:113]
    v_pk_fma_f32 v[114:115], v[18:19], v[210:211], v[114:115] op_sel_hi:[0,1,1]
    v_pk_fma_f32 v[114:115], v[18:19], v[210:211], v[114:115] op_sel:[1,1,0] op_sel_hi:[1,0,1] neg_lo:[1,0,0] neg_hi:[0,0,0]
    ds_write_b64 v204, v[114:115] offset:1280
    v_pk_fma_f32 v[116:117], v[20:21], v[210:211], v[116:117] op_sel_hi:[0,1,1]
    v_pk_fma_f32 v[116:117], v[20:21], v[210:211], v[116:117] op_sel:[1,1,0] op_sel_hi:[1,0,1] neg_lo:[1,0,0] neg_hi:[0,0,0]
    ds_write_b64 v204, v[116:117] offset:2560
    v_pk_fma_f32 v[118:119], v[22:23], v[210:211], v[118:119] op_sel_hi:[0,1,1]
    v_pk_fma_f32 v[118:119], v[22:23], v[210:211], v[118:119] op_sel:[1,1,0] op_sel_hi:[1,0,1] neg_lo:[1,0,0] neg_hi:[0,0,0]
    ds_write_b64 v204, v[118:119] offset:3840
    v_pk_fma_f32 v[120:121], v[24:25], v[210:211], v[120:121] op_sel_hi:[0,1,1]
    v_pk_fma_f32 v[120:121], v[24:25], v[210:211], v[120:121] op_sel:[1,1,0] op_sel_hi:[1,0,1] neg_lo:[1,0,0] neg_hi:[0,0,0]
    ds_write_b64 v204, v[120:121] offset:5120
    v_pk_fma_f32 v[122:123], v[26:27], v[210:211], v[122:123] op_sel_hi:[0,1,1]
    v_pk_fma_f32 v[122:123], v[26:27], v[210:211], v[122:123] op_sel:[1,1,0] op_sel_hi:[1,0,1] neg_lo:[1,0,0] neg_hi:[0,0,0]
    ds_write_b64 v204, v[122:123] offset:6400
    v_pk_fma_f32 v[124:125], v[28:29], v[210:211], v[124:125] op_sel_hi:[0,1,1]
    v_pk_fma_f32 v[124:125], v[28:29], v[210:211], v[124:125] op_sel:[1,1,0] op_sel_hi:[1,0,1] neg_lo:[1,0,0] neg_hi:[0,0,0]
    ds_write_b64 v204, v[124:125] offset:7680
    v_pk_fma_f32 v[126:127], v[30:31], v[210:211], v[126:127] op_sel_hi:[0,1,1]
    v_pk_fma_f32 v[126:127], v[30:31], v[210:211], v[126:127] op_sel:[1,1,0] op_sel_hi:[1,0,1] neg_lo:[1,0,0] neg_hi:[0,0,0]
    ds_write_b64 v204, v[126:127] offset:8960
    v_pk_fma_f32 v[128:129], v[32:33], v[210:211], v[128:129] op_sel_hi:[0,1,1]
    v_pk_fma_f32 v[128:129], v[32:33], v[210:211], v[128:129] op_sel:[1,1,0] op_sel_hi:[1,0,1] neg_lo:[1,0,0] neg_hi:[0,0,0]
    ds_write_b64 v204, v[128:129] offset:10240
    v_pk_fma_f32 v[130:131], v[34:35], v[210:211], v[130:131] op_sel_hi:[0,1,1]
    v_pk_fma_f32 v[130:131], v[34:35], v[210:211], v[130:131] op_sel:[1,1,0] op_sel_hi:[1,0,1] neg_lo:[1,0,0] neg_hi:[0,0,0]
    ds_write_b64 v204, v[130:131] offset:11520
    v_pk_fma_f32 v[132:133], v[36:37], v[210:211], v[132:133] op_sel_hi:[0,1,1]
    v_pk_fma_f32 v[132:133], v[36:37], v[210:211], v[132:133] op_sel:[1,1,0] op_sel_hi:[1,0,1] neg_lo:[1,0,0] neg_hi:[0,0,0]
    ds_write_b64 v204, v[132:133] offset:12800
    v_pk_fma_f32 v[134:135], v[38:39], v[210:211], v[134:135] op_sel_hi:[0,1,1]
    v_pk_fma_f32 v[134:135], v[38:39], v[210:211], v[134:135] op_sel:[1,1,0] op_sel_hi:[1,0,1] neg_lo:[1,0,0] neg_hi:[0,0,0]
    ds_write_b64 v204, v[134:135] offset:14080
    v_pk_fma_f32 v[136:137], v[40:41], v[210:211], v[136:137] op_sel_hi:[0,1,1]
    v_pk_fma_f32 v[136:137], v[40:41], v[210:211], v[136:137] op_sel:[1,1,0] op_sel_hi:[1,0,1] neg_lo:[1,0,0] neg_hi:[0,0,0]
    ds_write_b64 v204, v[136:137] offset:15360
    v_pk_fma_f32 v[138:139], v[42:43], v[210:211], v[138:139] op_sel_hi:[0,1,1]
    v_pk_fma_f32 v[138:139], v[42:43], v[210:211], v[138:139] op_sel:[1,1,0] op_sel_hi:[1,0,1] neg_lo:[1,0,0] neg_hi:[0,0,0]
    ds_write_b64 v204, v[138:139] offset:16640
    v_pk_mul_f32 v[208:209], v[20:21], v[210:211] op_sel_hi:[0,1]
    v_pk_fma_f32 v[208:209], v[20:21], v[210:211], v[208:209] op_sel:[1,1,0] op_sel_hi:[1,0,1] neg_lo:[1,0,0] neg_hi:[0,0,0]
    v_pk_fma_f32 v[140:141], v[40:41], v[208:209], v[140:141] op_sel_hi:[0,1,1]
    v_pk_fma_f32 v[140:141], v[40:41], v[208:209], v[140:141] op_sel:[1,1,0] op_sel_hi:[1,0,1] neg_lo:[1,0,0] neg_hi:[0,0,0]
    ds_write_b64 v204, v[140:141] offset:17920
    v_pk_fma_f32 v[142:143], v[42:43], v[208:209], v[142:143] op_sel_hi:[0,1,1]
    v_pk_fma_f32 v[142:143], v[42:43], v[208:209], v[142:143] op_sel:[1,1,0] op_sel_hi:[1,0,1] neg_lo:[1,0,0] neg_hi:[0,0,0]
    ds_write_b64 v204, v[142:143] offset:19200
    s_waitcnt lgkmcnt(0)
L_mid_256:
    s_setprio 0
    s_barrier
    s_add_u32 s77, s101, 0
    s_waitcnt vmcnt(4)
    buffer_load_dwordx4 v[108:111], v12, s[48:51], s77 offen offset:0
    s_add_u32 s77, s101, 10240
    s_waitcnt vmcnt(4)
    buffer_load_dwordx4 v[112:115], v12, s[48:51], s77 offen offset:0
    s_add_u32 s77, s101, 20480
    s_waitcnt vmcnt(4)
    buffer_load_dwordx4 v[116:119], v12, s[48:51], s77 offen offset:0
    s_add_u32 s77, s101, 30720
    s_waitcnt vmcnt(4)
    buffer_load_dwordx4 v[120:123], v12, s[48:51], s77 offen offset:0
    s_add_u32 s77, s101, 40960
    s_waitcnt vmcnt(4)
    buffer_load_dwordx4 v[124:127], v12, s[48:51], s77 offen offset:0
    s_add_u32 s77, s101, 51200
    s_waitcnt vmcnt(4)
    buffer_load_dwordx4 v[128:131], v12, s[48:51], s77 offen offset:0
    s_add_u32 s77, s101, 61440
    s_waitcnt vmcnt(4)
    buffer_load_dwordx4 v[132:135], v12, s[48:51], s77 offen offset:0
    s_add_u32 s77, s101, 71680
    s_waitcnt vmcnt(4)
    buffer_load_dwordx4 v[136:139], v12, s[48:51], s77 offen offset:0
    s_add_u32 s77, s101, 81920
    s_waitcnt vmcnt(4)
    buffer_load_dwordx4 v[140:143], v12, s[48:51], s77 offen offset:0
    s_add_u32 s77, s101, 92160
    s_waitcnt vmcnt(4)
    buffer_load_dwordx4 v[144:147], v12, s[48:51], s77 offen offset:0
    s_add_u32 s77, s101, 102400
    s_waitcnt vmcnt(4)
    buffer_load_dwordx4 v[148:151], v12, s[48:51], s77 offen offset:0
    s_add_u32 s77, s101, 112640
    s_waitcnt vmcnt(4)
    buffer_load_dwordx4 v[152:155], v12, s[48:51], s77 offen offset:0
    s_add_u32 s77, s101, 122880
    s_waitcnt vmcnt(4)
    buffer_load_dwordx4 v[156:159], v12, s[48:51], s77 offen offset:0
    s_add_u32 s77, s101, 133120
    s_waitcnt vmcnt(4)
    buffer_load_dwordx4 v[160:163], v12, s[48:51], s77 offen offset:0
    s_add_u32 s77, s101, 143360
    s_waitcnt vmcnt(4)
    buffer_load_dwordx4 v[164:167], v12, s[48:51], s77 offen offset:0
    s_add_u32 s77, s101, 153600
    s_waitcnt vmcnt(4)
    buffer_load_dwordx4 v[168:171], v12, s[48:51], s77 offen offset:0
    s_and_b32 s101, s87, 3
    s_add_u32 s101, s101, s99
    s_cmp_ge_u32 s101, 10
    s_cselect_b32 s70, 10, 0
    s_sub_u32 s101, s101, s70
    s_lshl_b32 s101, s101, 7
    s_add_u32 s77, s101, 0
    s_waitcnt vmcnt(8)
    buffer_load_dwordx4 v[172:175], v15, s[52:55], s77 offen offset:0
    s_add_u32 s77, s101, 0
    s_waitcnt vmcnt(8)
    buffer_load_dwordx4 v[176:179], v16, s[52:55], s77 offen offset:1024
    s_add_u32 s77, s101, 20480
    s_waitcnt vmcnt(8)
    buffer_load_dwordx4 v[180:183], v15, s[52:55], s77 offen offset:0
    s_add_u32 s77, s101, 20480
    s_waitcnt vmcnt(8)
    buffer_load_dwordx4 v[184:187], v16, s[52:55], s77 offen offset:1024
    s_add_u32 s77, s101, 40960
    s_waitcnt vmcnt(8)
    buffer_load_dwordx4 v[188:191], v15, s[52:55], s77 offen offset:0
    s_add_u32 s77, s101, 40960
    s_waitcnt vmcnt(8)
    buffer_load_dwordx4 v[192:195], v16, s[52:55], s77 offen offset:1024
    s_add_u32 s77, s101, 61440
    s_waitcnt vmcnt(8)
    buffer_load_dwordx4 v[196:199], v15, s[52:55], s77 offen offset:0
    s_add_u32 s77, s101, 61440
    s_waitcnt vmcnt(8)
    buffer_load_dwordx4 v[200:203], v16, s[52:55], s77 offen offset:1024
    s_add_u32 s77, s101, 0
    s_waitcnt vmcnt(8)
    buffer_load_dwordx4 v[204:207], v15, s[56:59], s77 offen offset:0
    s_add_u32 s77, s101, 0
    s_waitcnt vmcnt(8)
    buffer_load_dwordx4 v[208:211], v16, s[56:59], s77 offen offset:1024
    s_add_u32 s77, s101, 20480
    s_waitcnt vmcnt(8)
    buffer_load_dwordx4 v[212:215], v15, s[56:59], s77 offen offset:0
    s_add_u32 s77, s101, 20480
    s_waitcnt vmcnt(8)
    buffer_load_dwordx4 v[216:219], v16, s[56:59], s77 offen offset:1024
    s_add_u32 s77, s101, 40960
    s_waitcnt vmcnt(8)
    buffer_load_dwordx4 v[220:223], v15, s[56:59], s77 offen offset:0
    s_add_u32 s77, s101, 40960
    s_waitcnt vmcnt(8)
    buffer_load_dwordx4 v[224:227], v16, s[56:59], s77 offen offset:1024
    s_add_u32 s77, s101, 61440
    s_waitcnt vmcnt(8)
    buffer_load_dwordx4 v[228:231], v15, s[56:59], s77 offen offset:0
    s_add_u32 s77, s101, 61440
    s_waitcnt vmcnt(8)
    buffer_load_dwordx4 v[232:235], v16, s[56:59], s77 offen offset:1024
    s_add_u32 s101, s101, 512
    s_cmp_ge_u32 s101, 1280
    s_cselect_b32 s70, 1280, 0
    s_sub_u32 s101, s101, s70
    s_cmp_lt_u32 s87, 5
    s_cselect_b32 s75, 20, 21
    s_add_u32 s76, s87, 13
    s_max_u32 s76, s76, s75
    s_lshl_b32 s76, s76, 2
    v_add_u32 v246, s76, v240
    ds_read_b32 v242, v246 offset:0
    s_waitcnt lgkmcnt(0)
    v_cmp_ne_u32 vcc, s3, v242
    s_cbranch_vccnz L_sw_263
L_bk_264:
    s_waitcnt vmcnt(32)
    v_add_u32 v237, s80, v236
    ds_write_b128 v237, v[44:47] offset:0
    ds_write_b128 v237, v[48:51] offset:1024
    ds_write_b128 v237, v[52:55] offset:2048
    ds_write_b128 v237, v[56:59] offset:3072
    ds_write_b128 v237, v[60:63] offset:4096
    ds_write_b128 v237, v[64:67] offset:5120
    ds_write_b128 v237, v[68:71] offset:6144
    ds_write_b128 v237, v[72:75] offset:7168
    ds_write_b128 v237, v[76:79] offset:8192
    ds_write_b128 v237, v[80:83] offset:9216
    ds_write_b128 v237, v[84:87] offset:10240
    ds_write_b128 v237, v[88:91] offset:11264
    ds_write_b128 v237, v[92:95] offset:12288
    ds_write_b128 v237, v[96:99] offset:13312
    ds_write_b128 v237, v[100:103] offset:14336
    ds_write_b128 v237, v[104:107] offset:15360
    s_add_u32 s87, s87, 4
    s_add_u32 s76, s87, 21
    s_lshl_b32 s76, s76, 2
    v_add_u32 v246, s76, v253
    v_mov_b32 v241, s3
    ds_write_b32 v246, v241
    s_add_u32 s80, s80, 65536
    s_cmp_ge_u32 s80, 147456
    s_cselect_b32 s70, 147456, 0
    s_sub_u32 s80, s80, s70
    s_waitcnt lgkmcnt(0)
    s_add_u32 s77, s101, 0
    s_waitcnt vmcnt(24)
    buffer_load_dwordx4 v[44:47], v15, s[52:55], s77 offen offset:0
    s_add_u32 s77, s101, 0
    s_waitcnt vmcnt(24)
    buffer_load_dwordx4 v[48:51], v16, s[52:55], s77 offen offset:1024
    s_add_u32 s77, s101, 20480
    s_waitcnt vmcnt(24)
    buffer_load_dwordx4 v[52:55], v15, s[52:55], s77 offen offset:0
    s_add_u32 s77, s101, 20480
    s_waitcnt vmcnt(24)
    buffer_load_dwordx4 v[56:59], v16, s[52:55], s77 offen offset:1024
    s_add_u32 s77, s101, 40960
    s_waitcnt vmcnt(24)
    buffer_load_dwordx4 v[60:63], v15, s[52:55], s77 offen offset:0
    s_add_u32 s77, s101, 40960
    s_waitcnt vmcnt(24)
    buffer_load_dwordx4 v[64:67], v16, s[52:55], s77 offen offset:1024
    s_add_u32 s77, s101, 61440
    s_waitcnt vmcnt(24)
    buffer_load_dwordx4 v[68:71], v15, s[52:55], s77 offen offset:0
    s_add_u32 s77, s101, 61440
    s_waitcnt vmcnt(24)
    buffer_load_dwordx4 v[72:75], v16, s[52:55], s77 offen offset:1024
    s_add_u32 s77, s101, 0
    s_waitcnt vmcnt(24)
    buffer_load_dwordx4 v[76:79], v15, s[56:59], s77 offen offset:0
    s_add_u32 s77, s101, 0
    s_waitcnt vmcnt(24)
    buffer_load_dwordx4 v[80:83], v16, s[56:59], s77 offen offset:1024
    s_add_u32 s77, s101, 20480
    s_waitcnt vmcnt(24)
    buffer_load_dwordx4 v[84:87], v15, s[56:59], s77 offen offset:0
    s_add_u32 s77, s101, 20480
    s_waitcnt vmcnt(24)
    buffer_load_dwordx4 v[88:91], v16, s[56:59], s77 offen offset:1024
    s_add_u32 s77, s101, 40960
    s_waitcnt vmcnt(24)
    buffer_load_dwordx4 v[92:95], v15, s[56:59], s77 offen offset:0
    s_add_u32 s77, s101, 40960
    s_waitcnt vmcnt(24)
    buffer_load_dwordx4 v[96:99], v16, s[56:59], s77 offen offset:1024
    s_add_u32 s77, s101, 61440
    s_waitcnt vmcnt(24)
    buffer_load_dwordx4 v[100:103], v15, s[56:59], s77 offen offset:0
    s_add_u32 s77, s101, 61440
    s_waitcnt vmcnt(24)
    buffer_load_dwordx4 v[104:107], v16, s[56:59], s77 offen offset:1024
    s_add_u32 s101, s101, 512
    s_cmp_ge_u32 s101, 1280
    s_cselect_b32 s70, 1280, 0
    s_sub_u32 s101, s101, s70
    s_add_u32 s76, s87, 13
    s_max_u32 s76, s76, 21
    s_lshl_b32 s76, s76, 2
    v_add_u32 v246, s76, v240
    ds_read_b32 v242, v246 offset:0
    s_waitcnt lgkmcnt(0)
    v_cmp_ne_u32 vcc, s3, v242
    s_cbranch_vccnz L_sw_266
L_bk_267:
    s_waitcnt vmcnt(32)
    v_add_u32 v237, s80, v236
    ds_write_b128 v237, v[108:111] offset:0
    ds_write_b128 v237, v[112:115] offset:1024
    ds_write_b128 v237, v[116:119] offset:2048
    ds_write_b128 v237, v[120:123] offset:3072
    ds_write_b128 v237, v[124:127] offset:4096
    ds_write_b128 v237, v[128:131] offset:5120
    ds_write_b128 v237, v[132:135] offset:6144
    ds_write_b128 v237, v[136:139] offset:7168
    ds_write_b128 v237, v[140:143] offset:8192
    ds_write_b128 v237, v[144:147] offset:9216
    ds_write_b128 v237, v[148:151] offset:10240
    ds_write_b128 v237, v[152:155] offset:11264
    ds_write_b128 v237, v[156:159] offset:12288
    ds_write_b128 v237, v[160:163] offset:13312
    ds_write_b128 v237, v[164:167] offset:14336
    ds_write_b128 v237, v[168:171] offset:15360
    s_add_u32 s87, s87, 4
    s_add_u32 s76, s87, 21
    s_lshl_b32 s76, s76, 2
    v_add_u32 v246, s76, v253
    v_mov_b32 v241, s3
    ds_write_b32 v246, v241
    s_add_u32 s80, s80, 65536
    s_cmp_ge_u32 s80, 147456
    s_cselect_b32 s70, 147456, 0
    s_sub_u32 s80, s80, s70
    s_waitcnt lgkmcnt(0)
    s_cmp_ge_u32 s87, 14
    s_cbranch_scc1 L_k_269
    s_add_u32 s77, s101, 0
    s_waitcnt vmcnt(24)
    buffer_load_dwordx4 v[108:111], v15, s[52:55], s77 offen offset:0
    s_add_u32 s77, s101, 0
    s_waitcnt vmcnt(24)
    buffer_load_dwordx4 v[112:115], v16, s[52:55], s77 offen offset:1024
    s_add_u32 s77, s101, 20480
    s_waitcnt vmcnt(24)
    buffer_load_dwordx4 v[116:119], v15, s[52:55], s77 offen offset:0
    s_add_u32 s77, s101, 20480
    s_waitcnt vmcnt(24)
    buffer_load_dwordx4 v[120:123], v16, s[52:55], s77 offen offset:1024
    s_add_u32 s77, s101, 40960
    s_waitcnt vmcnt(24)
    buffer_load_dwordx4 v[124:127], v15, s[52:55], s77 offen offset:0
    s_add_u32 s77, s101, 40960
    s_waitcnt vmcnt(24)
    buffer_load_dwordx4 v[128:131], v16, s[52:55], s77 offen offset:1024
    s_add_u32 s77, s101, 61440
    s_waitcnt vmcnt(24)
    buffer_load_dwordx4 v[132:135], v15, s[52:55], s77 offen offset:0
    s_add_u32 s77, s101, 61440
    s_waitcnt vmcnt(24)
    buffer_load_dwordx4 v[136:139], v16, s[52:55], s77 offen offset:1024
    s_add_u32 s77, s101, 0
    s_waitcnt vmcnt(24)
    buffer_load_dwordx4 v[140:143], v15, s[56:59], s77 offen offset:0
    s_add_u32 s77, s101, 0
    s_waitcnt vmcnt(24)
    buffer_load_dwordx4 v[144:147], v16, s[56:59], s77 offen offset:1024
    s_add_u32 s77, s101, 20480
    s_waitcnt vmcnt(24)
    buffer_load_dwordx4 v[148:151], v15, s[56:59], s77 offen offset:0
    s_add_u32 s77, s101, 20480
    s_waitcnt vmcnt(24)
    buffer_load_dwordx4 v[152:155], v16, s[56:59], s77 offen offset:1024
    s_add_u32 s77, s101, 40960
    s_waitcnt vmcnt(24)
    buffer_load_dwordx4 v[156:159], v15, s[56:59], s77 offen offset:0
    s_add_u32 s77, s101, 40960
    s_waitcnt vmcnt(24)
    buffer_load_dwordx4 v[160:163], v16, s[56:59], s77 offen offset:1024
    s_add_u32 s77, s101, 61440
    s_waitcnt vmcnt(24)
    buffer_load_dwordx4 v[164:167], v15, s[56:59], s77 offen offset:0
    s_add_u32 s77, s101, 61440
    s_waitcnt vmcnt(24)
    buffer_load_dwordx4 v[168:171], v16, s[56:59], s77 offen offset:1024
    s_add_u32 s101, s101, 512
    s_cmp_ge_u32 s101, 1280
    s_cselect_b32 s70, 1280, 0
    s_sub_u32 s101, s101, s70
    s_add_u32 s76, s87, 13
    s_max_u32 s76, s76, 21
    s_lshl_b32 s76, s76, 2
    v_add_u32 v246, s76, v240
    ds_read_b32 v242, v246 offset:0
    s_waitcnt lgkmcnt(0)
    v_cmp_ne_u32 vcc, s3, v242
    s_cbranch_vccnz L_sw_270
L_bk_271:
    s_waitcnt vmcnt(32)
    v_add_u32 v237, s80, v236
    ds_write_b128 v237, v[172:175] offset:0
    ds_write_b128 v237, v[176:179] offset:1024
    ds_write_b128 v237, v[180:183] offset:2048
    ds_write_b128 v237, v[184:187] offset:3072
    ds_write_b128 v237, v[188:191] offset:4096
    ds_write_b128 v237, v[192:195] offset:5120
    ds_write_b128 v237, v[196:199] offset:6144
    ds_write_b128 v237, v[200:203] offset:7168
    ds_write_b128 v237, v[204:207] offset:8192
    ds_write_b128 v237, v[208:211] offset:9216
    ds_write_b128 v237, v[212:215] offset:10240
    ds_write_b128 v237, v[216:219] offset:11264
    ds_write_b128 v237, v[220:223] offset:12288
    ds_write_b128 v237, v[224:227] offset:13312
    ds_write_b128 v237, v[228:231] offset:14336
    ds_write_b128 v237, v[232:235] offset:15360
    s_add_u32 s87, s87, 4
    s_add_u32 s76, s87, 21
    s_lshl_b32 s76, s76, 2
    v_add_u32 v246, s76, v253
    v_mov_b32 v241, s3
    ds_write_b32 v246, v241
    s_add_u32 s80, s80, 65536
    s_cmp_ge_u32 s80, 147456
    s_cselect_b32 s70, 147456, 0
    s_sub_u32 s80, s80, s70
    s_waitcnt lgkmcnt(0)
    s_add_u32 s76, s87, 13
    s_max_u32 s76, s76, 21
    s_lshl_b32 s76, s76, 2
    v_add_u32 v246, s76, v240
    ds_read_b32 v242, v246 offset:0
    s_waitcnt lgkmcnt(0)
    v_cmp_ne_u32 vcc, s3, v242
    s_cbranch_vccnz L_sw_273
L_bk_274:
    s_waitcnt vmcnt(16)
    v_add_u32 v237, s80, v236
    ds_write_b128 v237, v[44:47] offset:0
    ds_write_b128 v237, v[48:51] offset:1024
    ds_write_b128 v237, v[52:55] offset:2048
    ds_write_b128 v237, v[56:59] offset:3072
    ds_write_b128 v237, v[60:63] offset:4096
    ds_write_b128 v237, v[64:67] offset:5120
    ds_write_b128 v237, v[68:71] offset:6144
    ds_write_b128 v237, v[72:75] offset:7168
    ds_write_b128 v237, v[76:79] offset:8192
    ds_write_b128 v237, v[80:83] offset:9216
    ds_write_b128 v237, v[84:87] offset:10240
    ds_write_b128 v237, v[88:91] offset:11264
    ds_write_b128 v237, v[92:95] offset:12288
    ds_write_b128 v237, v[96:99] offset:13312
    ds_write_b128 v237, v[100:103] offset:14336
    ds_write_b128 v237, v[104:107] offset:15360
    s_add_u32 s87, s87, 4
    s_add_u32 s76, s87, 21
    s_lshl_b32 s76, s76, 2
    v_add_u32 v246, s76, v253
    v_mov_b32 v241, s3
    ds_write_b32 v246, v241
    s_add_u32 s80, s80, 65536
    s_cmp_ge_u32 s80, 147456
    s_cselect_b32 s70, 147456, 0
    s_sub_u32 s80, s80, s70
    s_waitcnt lgkmcnt(0)
    s_add_u32 s76, s87, 13
    s_max_u32 s76, s76, 21
    s_lshl_b32 s76, s76, 2
    v_add_u32 v246, s76, v240
    ds_read_b32 v242, v246 offset:0
    s_waitcnt lgkmcnt(0)
    v_cmp_ne_u32 vcc, s3, v242
    s_cbranch_vccnz L_sw_276
L_bk_277:
    s_waitcnt vmcnt(0)
    v_add_u32 v237, s80, v236
    ds_write_b128 v237, v[108:111] offset:0
    ds_write_b128 v237, v[112:115] offset:1024
    ds_write_b128 v237, v[116:119] offset:2048
    ds_write_b128 v237, v[120:123] offset:3072
    ds_write_b128 v237, v[124:127] offset:4096
    ds_write_b128 v237, v[128:131] offset:5120
    ds_write_b128 v237, v[132:135] offset:6144
    ds_write_b128 v237, v[136:139] offset:7168
    ds_write_b128 v237, v[140:143] offset:8192
    ds_write_b128 v237, v[144:147] offset:9216
    ds_write_b128 v237, v[148:151] offset:10240
    ds_write_b128 v237, v[152:155] offset:11264
    ds_write_b128 v237, v[156:159] offset:12288
    ds_write_b128 v237, v[160:163] offset:13312
    ds_write_b128 v237, v[164:167] offset:14336
    ds_write_b128 v237, v[168:171] offset:15360
    s_add_u32 s87, s87, 4
    s_add_u32 s76, s87, 21
    s_lshl_b32 s76, s76, 2
    v_add_u32 v246, s76, v253
    v_mov_b32 v241, s3
    ds_write_b32 v246, v241
    s_add_u32 s80, s80, 65536
    s_cmp_ge_u32 s80, 147456
    s_cselect_b32 s70, 147456, 0
    s_sub_u32 s80, s80, s70
    s_waitcnt lgkmcnt(0)
    s_branch L_k_269x
L_k_269:
    s_cmp_lg_u32 s87, 15
    s_cbranch_scc1 L_k_269p
    s_mov_b32 s83, 0
L_pu_279:
    global_load_dword v244, v243, s[34:35] sc1
    s_waitcnt vmcnt(0)
    v_cmp_ne_u32 vcc, s66, v244
    s_cbranch_vccz L_pu_280
    s_sleep 4
    s_sleep 1
    s_sub_u32 s94, s94, 1
    s_cmp_lg_u32 s94, 0
    s_cbranch_scc1 L_pu_279
    s_mov_b32 s94, 1
L_pu_280:
    v_mov_b32 v241, 3
    ds_write_b32 v245, v241
L_k_269p:
    s_add_u32 s76, s87, 13
    s_max_u32 s76, s76, 21
    s_lshl_b32 s76, s76, 2
    v_add_u32 v246, s76, v240
    ds_read_b32 v242, v246 offset:0
    s_waitcnt lgkmcnt(0)
    v_cmp_ne_u32 vcc, s3, v242
    s_cbranch_vccnz L_sw_281
L_bk_282:
    s_waitcnt vmcnt(16)
    v_add_u32 v237, s80, v236
    ds_write_b128 v237, v[172:175] offset:0
    ds_write_b128 v237, v[176:179] offset:1024
    ds_write_b128 v237, v[180:183] offset:2048
    ds_write_b128 v237, v[184:187] offset:3072
    ds_write_b128 v237, v[188:191] offset:4096
    ds_write_b128 v237, v[192:195] offset:5120
    ds_write_b128 v237, v[196:199] offset:6144
    ds_write_b128 v237, v[200:203] offset:7168
    ds_write_b128 v237, v[204:207] offset:8192
    ds_write_b128 v237, v[208:211] offset:9216
    ds_write_b128 v237, v[212:215] offset:10240
    ds_write_b128 v237, v[216:219] offset:11264
    ds_write_b128 v237, v[220:223] offset:12288
    ds_write_b128 v237, v[224:227] offset:13312
    ds_write_b128 v237, v[228:231] offset:14336
    ds_write_b128 v237, v[232:235] offset:15360
    s_add_u32 s87, s87, 4
    s_add_u32 s76, s87, 21
    s_lshl_b32 s76, s76, 2
    v_add_u32 v246, s76, v253
    v_mov_b32 v241, s3
    ds_write_b32 v246, v241
    s_add_u32 s80, s80, 65536
    s_cmp_ge_u32 s80, 147456
    s_cselect_b32 s70, 147456, 0
    s_sub_u32 s80, s80, s70
    s_waitcnt lgkmcnt(0)
    s_add_u32 s76, s87, 13
    s_max_u32 s76, s76, 21
    s_lshl_b32 s76, s76, 2
    v_add_u32 v246, s76, v240
    ds_read_b32 v242, v246 offset:0
    s_waitcnt lgkmcnt(0)
    v_cmp_ne_u32 vcc, s3, v242
    s_cbranch_vccnz L_sw_284
L_bk_285:
    s_waitcnt vmcnt(0)
    v_add_u32 v237, s80, v236
    ds_write_b128 v237, v[44:47] offset:0
    ds_write_b128 v237, v[48:51] offset:1024
    ds_write_b128 v237, v[52:55] offset:2048
    ds_write_b128 v237, v[56:59] offset:3072
    ds_write_b128 v237, v[60:63] offset:4096
    ds_write_b128 v237, v[64:67] offset:5120
    ds_write_b128 v237, v[68:71] offset:6144
    ds_write_b128 v237, v[72:75] offset:7168
    ds_write_b128 v237, v[76:79] offset:8192
    ds_write_b128 v237, v[80:83] offset:9216
    ds_write_b128 v237, v[84:87] offset:10240
    ds_write_b128 v237, v[88:91] offset:11264
    ds_write_b128 v237, v[92:95] offset:12288
    ds_write_b128 v237, v[96:99] offset:13312
    ds_write_b128 v237, v[100:103] offset:14336
    ds_write_b128 v237, v[104:107] offset:15360
    s_add_u32 s87, s87, 4
    s_add_u32 s76, s87, 21
    s_lshl_b32 s76, s76, 2
    v_add_u32 v246, s76, v253
    v_mov_b32 v241, s3
    ds_write_b32 v246, v241
    s_add_u32 s80, s80, 65536
    s_cmp_ge_u32 s80, 147456
    s_cselect_b32 s70, 147456, 0
    s_sub_u32 s80, s80, s70
    s_waitcnt lgkmcnt(0)
L_k_269x:
    s_barrier
    s_cmp_lg_u32 s2, 0
    s_cbranch_scc1 L_ep_289
    s_cmp_lg_u32 s85, 2
    s_cbranch_scc1 L_ep_289
    v_lshrrev_b32 v200, 4, v254
    v_lshlrev_b32 v200, 6, v200
    v_and_b32 v201, 15, v254
    v_lshl_add_u32 v200, v201, 1, v200
    v_lshlrev_b32 v200, 7, v200
L_ep_287:
    v_add_u32 v201, 12582912, v200
    global_load_dword v204, v201, s[34:35] sc1
    v_add_u32 v201, 32768, v201
    global_load_dword v205, v201, s[34:35] sc1
    v_add_u32 v201, 32768, v201
    global_load_dword v206, v201, s[34:35] sc1
    v_add_u32 v201, 32768, v201
    global_load_dword v207, v201, s[34:35] sc1
    v_add_u32 v201, 32768, v201
    s_waitcnt vmcnt(0)
    s_mov_b64 s[88:89], 0
    v_cmp_ne_u32 vcc, s66, v204
    s_nop 1
    s_or_b64 s[88:89], s[88:89], vcc
    v_cmp_ne_u32 vcc, s66, v205
    s_nop 1
    s_or_b64 s[88:89], s[88:89], vcc
    v_cmp_ne_u32 vcc, s66, v206
    s_nop 1
    s_or_b64 s[88:89], s[88:89], vcc
    v_cmp_ne_u32 vcc, s66, v207
    s_nop 1
    s_or_b64 s[88:89], s[88:89], vcc
    s_cmp_eq_u64 s[88:89], 0
    s_cbranch_scc1 L_ep_288
    s_sleep 1
    s_sub_u32 s94, s94, 1
    s_cmp_lg_u32 s94, 0
    s_cbranch_scc1 L_ep_287
    s_mov_b32 s94, 1
L_ep_288:
    v_mov_b32 v200, 0
    v_mov_b32 v201, s66
    s_mov_b64 exec, 1
    global_store_dword v200, v201, s[34:35] sc1
    s_mov_b64 exec, -1
L_ep_289:
    s_endpgm
L_sw_253:
L_sr_255:
    ds_read_b32 v242, v246 offset:0
    s_waitcnt lgkmcnt(0)
    v_cmp_ne_u32 vcc, s3, v242
    s_cbranch_vccz L_bk_254
    s_sub_u32 s94, s94, 1
    s_cmp_lg_u32 s94, 0
    s_cbranch_scc1 L_sr_255
    s_mov_b32 s94, 1
    s_branch L_bk_254
L_sw_263:
L_sr_265:
    ds_read_b32 v242, v246 offset:0
    s_waitcnt lgkmcnt(0)
    v_cmp_ne_u32 vcc, s3, v242
    s_cbranch_vccz L_bk_264
    s_sub_u32 s94, s94, 1
    s_cmp_lg_u32 s94, 0
    s_cbranch_scc1 L_sr_265
    s_mov_b32 s94, 1
    s_branch L_bk_264
L_sw_266:
L_sr_268:
    ds_read_b32 v242, v246 offset:0
    s_waitcnt lgkmcnt(0)
    v_cmp_ne_u32 vcc, s3, v242
    s_cbranch_vccz L_bk_267
    s_sub_u32 s94, s94, 1
    s_cmp_lg_u32 s94, 0
    s_cbranch_scc1 L_sr_268
    s_mov_b32 s94, 1
    s_branch L_bk_267
L_sw_270:
L_sr_272:
    ds_read_b32 v242, v246 offset:0
    s_waitcnt lgkmcnt(0)
    v_cmp_ne_u32 vcc, s3, v242
    s_cbranch_vccz L_bk_271
    s_sub_u32 s94, s94, 1
    s_cmp_lg_u32 s94, 0
    s_cbranch_scc1 L_sr_272
    s_mov_b32 s94, 1
    s_branch L_bk_271
L_sw_273:
L_sr_275:
    ds_read_b32 v242, v246 offset:0
    s_waitcnt lgkmcnt(0)
    v_cmp_ne_u32 vcc, s3, v242
    s_cbranch_vccz L_bk_274
    s_sub_u32 s94, s94, 1
    s_cmp_lg_u32 s94, 0
    s_cbranch_scc1 L_sr_275
    s_mov_b32 s94, 1
    s_branch L_bk_274
L_sw_276:
L_sr_278:
    ds_read_b32 v242, v246 offset:0
    s_waitcnt lgkmcnt(0)
    v_cmp_ne_u32 vcc, s3, v242
    s_cbranch_vccz L_bk_277
    s_sub_u32 s94, s94, 1
    s_cmp_lg_u32 s94, 0
    s_cbranch_scc1 L_sr_278
    s_mov_b32 s94, 1
    s_branch L_bk_277
L_sw_281:
L_sr_283:
    ds_read_b32 v242, v246 offset:0
    s_waitcnt lgkmcnt(0)
    v_cmp_ne_u32 vcc, s3, v242
    s_cbranch_vccz L_bk_282
    s_sub_u32 s94, s94, 1
    s_cmp_lg_u32 s94, 0
    s_cbranch_scc1 L_sr_283
    s_mov_b32 s94, 1
    s_branch L_bk_282
L_sw_284:
L_sr_286:
    ds_read_b32 v242, v246 offset:0
    s_waitcnt lgkmcnt(0)
    v_cmp_ne_u32 vcc, s3, v242
    s_cbranch_vccz L_bk_285
    s_sub_u32 s94, s94, 1
    s_cmp_lg_u32 s94, 0
    s_cbranch_scc1 L_sr_286
    s_mov_b32 s94, 1
    s_branch L_bk_285
L_sub_ssm2:
    s_waitcnt lgkmcnt(0)
    v_cmp_ne_u32 vcc, s3, v242
    s_cbranch_vccnz L_sw_290
L_bk_291:
L_subn_ssm2:
    s_bitcmp1_b32 s83, 0
    s_cbranch_scc1 L_is_293
    s_add_u32 m0, s84, s79
    s_waitcnt vmcnt(8)
    buffer_load_dwordx4 v2, s[36:39], s81 offen offset:0 lds
    s_waitcnt vmcnt(8)
    buffer_load_dwordx4 v3, s[36:39], s81 offen offset:1024 lds
    s_waitcnt vmcnt(8)
    buffer_load_dwordx4 v4, s[36:39], s81 offen offset:2048 lds
    s_waitcnt vmcnt(8)
    buffer_load_dwordx4 v5, s[36:39], s81 offen offset:3072 lds
    s_add_u32 s84, s84, 16384
    s_cmp_eq_u32 s84, 49152
    s_cselect_b32 s84, 0, s84
    s_add_u32 m0, s80, s78
    s_waitcnt vmcnt(8)
    buffer_load_dwordx4 v6, s[40:43], s81 offen offset:0 lds
    s_waitcnt vmcnt(8)
    buffer_load_dwordx4 v7, s[40:43], s81 offen offset:1024 lds
    s_waitcnt vmcnt(8)
    buffer_load_dwordx4 v8, s[40:43], s81 offen offset:2048 lds
    s_waitcnt vmcnt(8)
    buffer_load_dwordx4 v9, s[40:43], s81 offen offset:3072 lds
    s_add_u32 m0, m0, 4096
    s_waitcnt vmcnt(8)
    buffer_load_dwordx4 v10, s[40:43], s81 offen lds
    s_branch L_is_293b
L_is_293:
    s_add_u32 m0, s80, s78
    s_waitcnt vmcnt(8)
    buffer_load_dwordx4 v6, s[44:47], s81 offen offset:0 lds
    s_waitcnt vmcnt(8)
    buffer_load_dwordx4 v7, s[44:47], s81 offen offset:1024 lds
    s_waitcnt vmcnt(8)
    buffer_load_dwordx4 v8, s[44:47], s81 offen offset:2048 lds
    s_waitcnt vmcnt(8)
    buffer_load_dwordx4 v9, s[44:47], s81 offen offset:3072 lds
    s_add_u32 m0, m0, 4096
    s_waitcnt vmcnt(8)
    buffer_load_dwordx4 v10, s[44:47], s81 offen lds
    s_add_u32 s81, s81, 128
    s_cmp_eq_u32 s81, 1280
    s_cselect_b32 s81, 0, s81
L_is_293b:
    s_add_u32 s83, s83, 1
    s_add_u32 s22, s22, 4
    v_add_u32 v246, 4, v246
    s_mov_b32 m0, s22
    ds_read_b32 v242, v246
    s_add_u32 s80, s80, 20480
    s_cmp_eq_u32 s80, 102400
    s_cselect_b32 s80, 0, s80
    s_waitcnt vmcnt(8)
    buffer_load_dword v252, s[36:39], 0 offen lds
    s_setpc_b64 s[90:91]
L_sw_290:
L_sr_292:
    ds_read_b32 v242, v246 offset:0
    s_waitcnt lgkmcnt(0)
    v_cmp_ne_u32 vcc, s3, v242
    s_cbranch_vccz L_bk_291
    s_sub_u32 s94, s94, 1
    s_cmp_lg_u32 s94, 0
    s_cbranch_scc1 L_sr_292
    s_mov_b32 s94, 1
    s_branch L_bk_291
L_end:
    s_endpgm
L_code_end:
.section .rodata,"a"
.p2align 6
.amdhsa_kernel parallel_sum__ssm_conv_s5__glu_gated_swiglu__prompt_kernel
  .amdhsa_next_free_vgpr 256
  .amdhsa_next_free_sgpr 102
  .amdhsa_accum_offset 256
  .amdhsa_group_segment_fixed_size 0
  .amdhsa_kernarg_size 128
  .amdhsa_user_sgpr_count 2
  .amdhsa_user_sgpr_kernarg_segment_ptr 1
  .amdhsa_system_sgpr_workgroup_id_x 1
.end_amdhsa_kernel
```
